```python
import torch

def _softmax(x, axis=-1):
    return torch.softmax(x, dim=axis)
def _gelu(x):
    return torch.nn.functional.gelu(x, approximate="tanh")
def _silu(x):
    return torch.nn.functional.silu(x)
def _sigmoid(x):
    return torch.sigmoid(x)
def _layernorm(x, axis=-1, eps=1e-5):
    m = x.mean(dim=axis, keepdim=True)
    v = x.var(dim=axis, keepdim=True, unbiased=False)
    return (x - m) / torch.sqrt(v + eps)
def _scatter_add(tgt, idx, src, axis=0):
    return tgt.clone().index_add_(axis, idx, src)
def _segment_sum(src, seg, n):
    out = torch.zeros((n,) + src.shape[1:], dtype=src.dtype)
    return out.index_add_(0, seg, src)
def _pad(x, pw):
    flat = tuple(v for pair in reversed(pw) for v in pair)
    return torch.nn.functional.pad(x, flat)

kernel_name = 'standalone__gqa_block_cached__near_ridge'

def setup_inputs():

    _w = (lambda a: (lambda t: t.to(torch.bfloat16) if t.is_floating_point() else t)(torch.as_tensor(a)))
    B, Sq, D = 8, 160, 448
    Hq, Hkv, Sk, Dh = 16, 8, 2048, 256
    assert Hq % Hkv == 0, (Hq, Hkv)
    return {
        "x": _w((lambda *s: torch.randn(*s, dtype=torch.bfloat16) * 0.8)(B, Sq, D)),
        "k_cache": _w((lambda *s: torch.randn(*s, dtype=torch.bfloat16) * 0.8)(B, Hkv, Sk, Dh)),
        "v_cache": _w((lambda *s: torch.randn(*s, dtype=torch.bfloat16) * 0.05)(B, Hkv, Sk, Dh)),
        "wq": _w((lambda *s: torch.randn(*s, dtype=torch.bfloat16) * 0.8)(D, Hq * Dh) * (D ** -0.5)),
        "wo": _w((lambda *s: torch.randn(*s, dtype=torch.bfloat16) * 0.05)(Hq * Dh, D) * ((Hq * Dh) ** -0.5)),
    }

def reference(x, k_cache, v_cache, wq, wo):
    B, Sq, D = x.shape
    Hq, Dh = 16, 256
    Hkv = k_cache.shape[1]
    rep = Hq // Hkv
    q = (lambda x, *d: x.permute(*d))((x @ wq).reshape(B, Sq, Hq, Dh), 0, 2, 1, 3)
    k = (lambda x, n, axis: torch.repeat_interleave(x, n, dim=axis))(k_cache, rep, axis=1)
    v = (lambda x, n, axis: torch.repeat_interleave(x, n, dim=axis))(v_cache, rep, axis=1)
    scores = torch.einsum("bhqd,bhkd->bhqk", q, k) * (Dh ** -0.5)
    p = _softmax(scores, axis=-1)
    o = torch.einsum("bhqk,bhkd->bhqd", p, v)
    return (lambda x, *d: x.permute(*d))(o, 0, 2, 1, 3).reshape(B, Sq, Hq * Dh) @ wo
```

```asm
; @launch grid=(256,1,1) block=(256,1,1) lds=163840
.amdgcn_target "amdgcn-amd-amdhsa--gfx950"
.text
.globl standalone__gqa_block_cached__near_ridge_kernel
.p2align 8
.type standalone__gqa_block_cached__near_ridge_kernel,@function
standalone__gqa_block_cached__near_ridge_kernel:
s_cmp_ge_u32 s2, 256
s_cbranch_scc1 L_end
s_load_dwordx16 s[64:79], s[0:1], 0
v_lshrrev_b32 v29, 6, v0
v_and_b32 v1, 63, v0
v_readfirstlane_b32 s32, v29
s_getpc_b64 s[48:49]
s_lshr_b32 s46, s2, 3
s_and_b32 s46, s46, 1
s_lshl_b32 s46, s46, 15
v_lshlrev_b32 v23, 7, v0
v_add_u32 v23, s46, v23
v_min_u32 v23, 48800, v23
global_load_dword v23, v23, s[48:49]
s_lshr_b32 s51, s2, 3
s_and_b32 s53, s2, 1
s_lshl_b32 s53, s53, 2
s_and_b32 s52, s51, 3
s_add_u32 s53, s53, s52
s_and_b32 s35, s2, 6
s_bfe_u32 s52, s51, 0x10002
s_add_u32 s35, s35, s52
s_bfe_u32 s36, s51, 0x10003
s_lshl_b32 s52, s53, 1
s_add_u32 s36, s36, s52
s_lshr_b32 s37, s51, 4
s_lshr_b32 s33, s32, 1
s_and_b32 s34, s32, 1
s_lshl_b32 s38, s35, 3
s_add_u32 s38, s38, s53
v_lshrrev_b32 v29, 3, v1
v_and_b32 v30, 7, v1
v_lshrrev_b32 v31, 1, v29
v_xor_b32 v2, v30, v31
v_lshlrev_b32 v2, 4, v2
v_lshlrev_b32 v4, 1, v31
v_xor_b32 v4, v30, v4
v_lshlrev_b32 v4, 4, v4
s_lshl_b32 s52, s34, 6
v_xor_b32 v6, s52, v2
v_mul_u32_u24 v7, 896, v29
v_add_u32 v6, v6, v7
v_and_b32 v5, 3, v29
v_lshrrev_b32 v7, 2, v29
v_lshl_add_u32 v5, v7, 3, v5
v_lshlrev_b32 v5, 13, v5
v_add_u32 v5, v5, v4
s_lshl_b32 s53, s32, 7
v_add_u32 v5, s53, v5
s_lshl_b32 s57, s36, 9
s_mul_i32 s58, s35, 143360
s_mul_i32 s52, s32, 7168
s_add_u32 s58, s58, s52
s_add_u32 s89, s58, 896
s_and_b32 s52, s35, 1
s_lshl_b32 s51, s37, 1
s_add_u32 s52, s52, s51
s_lshl_b32 s52, s52, 1
s_and_b32 s51, s36, 3
s_add_u32 s52, s52, s51
s_cmp_ge_u32 s52, 7
s_cselect_b32 s51, 7, 0
s_sub_u32 s52, s52, s51
s_lshl_b32 s51, s52, 19
s_add_u32 s57, s57, s51
s_lshl_b32 s51, s52, 7
s_add_u32 s58, s58, s51
s_lshl_b32 s42, s32, 12
s_add_u32 s59, s42, 32768
s_lshl_b32 s60, s32, 10
s_add_u32 s60, s60, 98304
s_waitcnt lgkmcnt(0)
s_lshl_b32 s51, s38, 20
s_load_dword s95, s[64:65], s58
s_load_dword s95, s[66:67], s51
s_load_dword s95, s[68:69], s51
s_load_dword s95, s[70:71], 0
s_load_dword s95, s[70:71], 0xffffc
s_mov_b32 s51, 3670012
s_load_dword s95, s[70:71], s51
s_mov_b32 s20, s70
s_mov_b32 s21, s71
s_mov_b32 s22, 3670016
s_mov_b32 s23, 0x20000
s_mov_b32 s8, s64
s_mov_b32 s9, s65
s_mov_b32 s10, 1146880
s_mov_b32 s11, 0x20000
s_add_u32 m0, s59, 0
s_add_u32 s50, s57, 0
buffer_load_dwordx4 v5, s[20:23], s50 offen offset:0 lds
v_and_b32 v7, 1, v29
v_lshl_add_u32 v7, v31, 3, v7
v_lshlrev_b32 v7, 9, v7
v_add_u32 v7, s53, v7
v_add_u32 v2, v2, v7
v_add_u32 v4, v4, v7
s_add_u32 s50, s57, 130048
buffer_load_dwordx4 v5, s[20:23], s50 offen offset:1024 lds
v_xor_b32 v3, 64, v2
s_mov_b32 s12, s66
s_mov_b32 s13, s67
s_mov_b32 s14, 67108864
s_mov_b32 s15, 0x20000
s_mov_b32 s16, s68
s_add_u32 s50, s57, 30720
buffer_load_dwordx4 v5, s[20:23], s50 offen offset:2048 lds
s_mov_b32 s17, s69
s_mov_b32 s18, 67108864
s_mov_b32 s19, 0x20000
s_mov_b32 s24, s72
s_mov_b32 s25, s73
s_mov_b32 s26, 3670016
s_add_u32 s50, s57, 160768
buffer_load_dwordx4 v5, s[20:23], s50 offen offset:3072 lds
s_mov_b32 s27, 0x20000
s_mov_b32 s28, s78
s_mov_b32 s29, s79
s_mov_b32 s30, 268435456
s_mov_b32 s31, 0x20000
s_lshl_b32 s38, s38, 20
s_add_u32 m0, s59, 16384
s_add_u32 s50, s57, 262144
buffer_load_dwordx4 v5, s[20:23], s50 offen offset:0 lds
s_lshl_b32 s39, s37, 19
s_add_u32 s38, s38, s39
s_mov_b32 s39, s38
s_lshl_b32 s3, s35, 1
s_add_u32 s3, s3, s37
s_lshl_b32 s3, s3, 4
s_add_u32 s50, s57, 392192
buffer_load_dwordx4 v5, s[20:23], s50 offen offset:1024 lds
s_add_u32 s3, s3, s36
s_mov_b32 s4, s76
s_mov_b32 s5, s77
s_mov_b32 s6, 256
s_mov_b32 s7, 0x20000
s_lshl_b32 s82, s3, 8
s_add_u32 s50, s57, 292864
buffer_load_dwordx4 v5, s[20:23], s50 offen offset:2048 lds
s_add_u32 s82, s82, 58720256
s_cmp_eq_u32 s32, 0
s_cselect_b32 s52, s82, 0x7ff00000
s_cselect_b32 s83, s3, 0x7ff00000
v_and_b32 v29, 31, v1
v_lshlrev_b32 v29, 2, v29
v_mov_b32 v21, 0
v_mov_b32 v22, 1
s_add_u32 s50, s57, 422912
buffer_load_dwordx4 v5, s[20:23], s50 offen offset:3072 lds
buffer_store_dword v21, v29, s[28:31], s52 offen offset:0 sc0 sc1
s_nop 1
v_and_b32 v29, 15, v1
v_lshrrev_b32 v30, 4, v1
v_lshrrev_b32 v31, 1, v29
v_xor_b32 v28, v30, v31
s_add_u32 s57, s57, 524288
s_cmp_ge_u32 s57, 3670016
s_cselect_b32 s51, 3670016, 0
s_sub_u32 s57, s57, s51
s_cmp_lt_u32 s59, 32768
s_cselect_b32 s51, 98304, 0
s_add_u32 s59, s59, s51
s_sub_u32 s59, s59, 32768
s_add_u32 m0, s60, 0
s_add_u32 s50, s58, 0
buffer_load_dwordx4 v6, s[8:11], s50 offen offset:0 lds
v_lshlrev_b32 v28, 4, v28
v_lshl_add_u32 v28, v29, 7, v28
v_lshrrev_b32 v29, 2, v1
v_and_b32 v30, 6, v29
v_bfe_u32 v31, v1, 1, 1
v_xor_b32 v30, v30, v31
s_add_u32 m0, s60, 4096
s_add_u32 s50, s58, 28672
buffer_load_dwordx4 v6, s[8:11], s50 offen offset:0 lds
v_lshlrev_b32 v30, 4, v30
v_lshl_add_u32 v30, v29, 7, v30
v_and_b32 v31, 1, v1
v_lshl_add_u32 v24, v31, 3, v30
v_xor_b32 v25, 32, v24
v_xor_b32 v26, 64, v24
s_add_u32 m0, s60, 8192
s_add_u32 s50, s58, 57344
buffer_load_dwordx4 v6, s[8:11], s50 offen offset:0 lds
v_xor_b32 v27, 96, v24
s_add_u32 s52, s42, 32768
v_add_u32 v12, s52, v24
v_add_u32 v13, s52, v25
v_add_u32 v14, s52, v26
v_add_u32 v15, s52, v27
s_add_u32 m0, s60, 12288
s_add_u32 s50, s58, 86016
buffer_load_dwordx4 v6, s[8:11], s50 offen offset:0 lds
v_add_u32 v10, 98304, v28
v_xor_b32 v11, 64, v10
s_mov_b32 s61, 32768
s_mov_b32 s62, 0
s_add_u32 s41, s42, 163840
s_mov_b32 s40, s42
s_add_u32 m0, s60, 16384
s_add_u32 s50, s58, 114688
buffer_load_dwordx4 v6, s[8:11], s50 offen offset:0 lds
s_lshl_b32 s43, s33, 15
s_sub_u32 s43, s43, 16384
s_sub_u32 s44, 65536, s43
s_sub_u32 s45, 4294868992, s43
s_mov_b32 s54, 0x53800000
s_mov_b32 s48, 0x6318c631
s_add_u32 s58, s58, 128
s_cmp_eq_u32 s58, s89
s_cselect_b32 s51, 896, 0
s_sub_u32 s58, s58, s51
s_cmp_ge_u32 s60, 139264
s_cselect_b32 s51, 61440, 0
s_sub_u32 s60, s60, s51
s_add_u32 s60, s60, 20480
s_add_u32 m0, s59, 0
s_add_u32 s50, s57, 0
buffer_load_dwordx4 v5, s[20:23], s50 offen offset:0 lds
s_mov_b32 s49, 0x8c
s_lshl_b32 s52, s33, 14
s_sub_u32 s52, 16384, s52
v_add_u32 v8, s52, v28
v_xor_b32 v9, 64, v8
v_and_b32 v29, 15, v1
s_add_u32 s50, s57, 130048
buffer_load_dwordx4 v5, s[20:23], s50 offen offset:1024 lds
v_lshlrev_b32 v29, 4, v29
v_lshrrev_b32 v30, 5, v1
v_lshl_add_u32 v29, v30, 8, v29
v_bfe_u32 v30, v1, 4, 1
v_lshl_add_u32 v29, v30, 3, v29
s_lshl_b32 s52, s32, 11
s_add_u32 s50, s57, 30720
buffer_load_dwordx4 v5, s[20:23], s50 offen offset:2048 lds
s_add_u32 s53, s52, 98304
v_add_u32 v19, s53, v29
s_add_u32 s53, s52, 32768
v_add_u32 v20, s53, v29
v_lshlrev_b32 v7, 4, v1
s_lshl_b32 s52, s32, 1
s_add_u32 s50, s57, 160768
buffer_load_dwordx4 v5, s[20:23], s50 offen offset:3072 lds
s_add_u32 s52, s52, s37
s_lshl_b32 s52, s52, 13
s_add_u32 s52, s52, 98304
v_add_u32 v16, s52, v7
v_xor_b32 v17, 8192, v16
s_xor_b32 s52, s34, s37
s_add_u32 m0, s59, 16384
s_add_u32 s50, s57, 262144
buffer_load_dwordx4 v5, s[20:23], s50 offen offset:0 lds
s_lshl_b32 s52, s52, 13
s_add_u32 s52, s52, 32768
v_add_u32 v18, s52, v7
s_lshl_b32 s47, s36, 2
s_add_u32 s47, s47, s32
s_mul_i32 s47, s47, 57344
s_add_u32 s50, s57, 392192
buffer_load_dwordx4 v5, s[20:23], s50 offen offset:1024 lds
s_add_u32 s90, s47, 896
s_and_b32 s88, s35, 1
s_lshl_b32 s52, s37, 1
s_add_u32 s88, s88, s52
s_mul_i32 s88, s88, 2
s_lshl_b32 s52, s88, 7
s_add_u32 s50, s57, 292864
buffer_load_dwordx4 v5, s[20:23], s50 offen offset:2048 lds
s_add_u32 s47, s47, s52
s_add_u32 s50, s57, 422912
buffer_load_dwordx4 v5, s[20:23], s50 offen offset:3072 lds
s_add_u32 s57, s57, 524288
s_cmp_ge_u32 s57, 3670016
s_cselect_b32 s51, 3670016, 0
s_sub_u32 s57, s57, s51
s_cmp_lt_u32 s59, 32768
s_cselect_b32 s51, 98304, 0
s_add_u32 s59, s59, s51
s_sub_u32 s59, s59, 32768
s_waitcnt lgkmcnt(0)
s_waitcnt vmcnt(8)
s_barrier
ds_read_b64_tr_b16 a[0:1], v12 offset:0
ds_read_b64_tr_b16 a[2:3], v12 offset:2048
ds_read_b64_tr_b16 a[4:5], v13 offset:0
ds_read_b64_tr_b16 a[6:7], v13 offset:2048
ds_read_b64_tr_b16 a[8:9], v14 offset:0
ds_read_b64_tr_b16 a[10:11], v14 offset:2048
ds_read_b64_tr_b16 a[12:13], v15 offset:0
ds_read_b64_tr_b16 a[14:15], v15 offset:2048
ds_read_b64_tr_b16 a[16:17], v12 offset:16384
ds_read_b64_tr_b16 a[18:19], v12 offset:18432
ds_read_b64_tr_b16 a[20:21], v13 offset:16384
ds_read_b64_tr_b16 a[22:23], v13 offset:18432
ds_read_b64_tr_b16 a[24:25], v14 offset:16384
ds_read_b64_tr_b16 a[26:27], v14 offset:18432
ds_read_b64_tr_b16 a[28:29], v15 offset:16384
ds_read_b64_tr_b16 a[30:31], v15 offset:18432
ds_read_b128 a[64:67], v10 offset:0
ds_read_b128 a[68:71], v11 offset:0
ds_read_b128 a[72:75], v10 offset:2048
ds_read_b128 a[76:79], v11 offset:2048
s_waitcnt lgkmcnt(3)
v_mfma_f32_16x16x32_bf16 v[96:99], a[0:3], a[64:67], 0
ds_read_b128 a[80:83], v10 offset:4096
s_waitcnt lgkmcnt(3)
v_mfma_f32_16x16x32_bf16 v[96:99], a[16:19], a[68:71], v[96:99]
ds_read_b128 a[84:87], v11 offset:4096
s_add_u32 m0, s60, 0
v_mfma_f32_16x16x32_bf16 v[100:103], a[4:7], a[64:67], 0
ds_read_b128 a[88:91], v10 offset:6144
s_add_u32 s50, s58, 0
v_mfma_f32_16x16x32_bf16 v[100:103], a[20:23], a[68:71], v[100:103]
ds_read_b128 a[92:95], v11 offset:6144
v_mfma_f32_16x16x32_bf16 v[104:107], a[8:11], a[64:67], 0
buffer_load_dwordx4 v6, s[8:11], s50 offen offset:0 lds
s_add_u32 m0, s60, 4096
v_mfma_f32_16x16x32_bf16 v[104:107], a[24:27], a[68:71], v[104:107]
s_add_u32 s50, s58, 28672
s_cmp_eq_u32 s61, 0
s_cselect_b32 s46, 98304, 0
s_sub_u32 s46, s46, 32768
v_mfma_f32_16x16x32_bf16 v[108:111], a[12:15], a[64:67], 0
s_add_u32 s61, s61, s46
s_cmp_eq_u32 s62, 40960
s_cselect_b32 s63, 61440, 0
s_sub_u32 s63, 20480, s63
v_mfma_f32_16x16x32_bf16 v[108:111], a[28:31], a[68:71], v[108:111]
buffer_load_dwordx4 v6, s[8:11], s50 offen offset:0 lds
s_add_u32 m0, s60, 8192
s_waitcnt lgkmcnt(3)
v_mfma_f32_16x16x32_bf16 v[112:115], a[0:3], a[72:75], 0
s_add_u32 s50, s58, 57344
s_add_u32 s62, s62, s63
v_mfma_f32_16x16x32_bf16 v[112:115], a[16:19], a[76:79], v[112:115]
v_add_u32 v12, s46, v12
v_add_u32 v13, s46, v13
v_mfma_f32_16x16x32_bf16 v[116:119], a[4:7], a[72:75], 0
buffer_load_dwordx4 v6, s[8:11], s50 offen offset:0 lds
s_add_u32 m0, s60, 12288
v_mfma_f32_16x16x32_bf16 v[116:119], a[20:23], a[76:79], v[116:119]
ds_read_b128 a[96:99], v10 offset:8192
s_add_u32 s50, s58, 86016
v_mfma_f32_16x16x32_bf16 v[120:123], a[8:11], a[72:75], 0
ds_read_b128 a[100:103], v11 offset:8192
v_add_u32 v14, s46, v14
v_mfma_f32_16x16x32_bf16 v[120:123], a[24:27], a[76:79], v[120:123]
buffer_load_dwordx4 v6, s[8:11], s50 offen offset:0 lds
s_add_u32 m0, s60, 16384
v_mfma_f32_16x16x32_bf16 v[124:127], a[12:15], a[72:75], 0
s_add_u32 s50, s58, 114688
v_add_u32 v15, s46, v15
v_mfma_f32_16x16x32_bf16 v[124:127], a[28:31], a[76:79], v[124:127]
s_waitcnt lgkmcnt(2)
v_mfma_f32_16x16x32_bf16 v[128:131], a[0:3], a[80:83], 0
buffer_load_dwordx4 v6, s[8:11], s50 offen offset:0 lds
s_add_u32 s58, s58, 128
v_mfma_f32_16x16x32_bf16 v[128:131], a[16:19], a[84:87], v[128:131]
s_cmp_eq_u32 s58, s89
s_cselect_b32 s51, 896, 0
s_sub_u32 s58, s58, s51
s_cmp_ge_u32 s60, 139264
s_cselect_b32 s51, 61440, 0
v_mfma_f32_16x16x32_bf16 v[132:135], a[4:7], a[80:83], 0
ds_read_b128 a[104:107], v10 offset:10240
s_sub_u32 s60, s60, s51
v_mfma_f32_16x16x32_bf16 v[132:135], a[20:23], a[84:87], v[132:135]
ds_read_b128 a[108:111], v11 offset:10240
s_add_u32 s60, s60, 20480
v_mfma_f32_16x16x32_bf16 v[136:139], a[8:11], a[80:83], 0
s_add_u32 m0, s59, 0
s_add_u32 s50, s57, 0
v_mfma_f32_16x16x32_bf16 v[136:139], a[24:27], a[84:87], v[136:139]
buffer_load_dwordx4 v5, s[20:23], s50 offen offset:0 lds
s_add_u32 s50, s57, 130048
v_mfma_f32_16x16x32_bf16 v[140:143], a[12:15], a[80:83], 0
v_mfma_f32_16x16x32_bf16 v[140:143], a[28:31], a[84:87], v[140:143]
v_mfma_f32_16x16x32_bf16 v[144:147], a[0:3], a[88:91], 0
buffer_load_dwordx4 v5, s[20:23], s50 offen offset:1024 lds
s_add_u32 s50, s57, 30720
v_mfma_f32_16x16x32_bf16 v[144:147], a[16:19], a[92:95], v[144:147]
v_mfma_f32_16x16x32_bf16 v[148:151], a[4:7], a[88:91], 0
ds_read_b128 a[112:115], v10 offset:12288
v_mfma_f32_16x16x32_bf16 v[148:151], a[20:23], a[92:95], v[148:151]
ds_read_b128 a[116:119], v11 offset:12288
v_mfma_f32_16x16x32_bf16 v[152:155], a[8:11], a[88:91], 0
buffer_load_dwordx4 v5, s[20:23], s50 offen offset:2048 lds
s_add_u32 s50, s57, 160768
v_mfma_f32_16x16x32_bf16 v[152:155], a[24:27], a[92:95], v[152:155]
v_mfma_f32_16x16x32_bf16 v[156:159], a[12:15], a[88:91], 0
s_waitcnt lgkmcnt(2)
v_mfma_f32_16x16x32_bf16 v[156:159], a[28:31], a[92:95], v[156:159]
buffer_load_dwordx4 v5, s[20:23], s50 offen offset:3072 lds
s_add_u32 m0, s59, 16384
v_mfma_f32_16x16x32_bf16 v[160:163], a[0:3], a[96:99], 0
s_add_u32 s50, s57, 262144
v_mfma_f32_16x16x32_bf16 v[160:163], a[16:19], a[100:103], v[160:163]
v_mfma_f32_16x16x32_bf16 v[164:167], a[4:7], a[96:99], 0
ds_read_b128 a[120:123], v10 offset:14336
v_mfma_f32_16x16x32_bf16 v[164:167], a[20:23], a[100:103], v[164:167]
ds_read_b128 a[124:127], v11 offset:14336
v_mfma_f32_16x16x32_bf16 v[168:171], a[8:11], a[96:99], 0
buffer_load_dwordx4 v5, s[20:23], s50 offen offset:0 lds
s_add_u32 s50, s57, 392192
v_mfma_f32_16x16x32_bf16 v[168:171], a[24:27], a[100:103], v[168:171]
s_waitcnt vmcnt(10)
v_mfma_f32_16x16x32_bf16 v[172:175], a[12:15], a[96:99], 0
ds_read_b64_tr_b16 a[32:33], v12 offset:0
v_mfma_f32_16x16x32_bf16 v[172:175], a[28:31], a[100:103], v[172:175]
ds_read_b64_tr_b16 a[34:35], v12 offset:2048
v_mfma_f32_16x16x32_bf16 v[176:179], a[0:3], a[104:107], 0
ds_read_b64_tr_b16 a[48:49], v12 offset:16384
v_mfma_f32_16x16x32_bf16 v[176:179], a[16:19], a[108:111], v[176:179]
ds_read_b64_tr_b16 a[50:51], v12 offset:18432
v_mfma_f32_16x16x32_bf16 v[180:183], a[4:7], a[104:107], 0
ds_read_b128 a[128:131], v10 offset:16384
v_mfma_f32_16x16x32_bf16 v[180:183], a[20:23], a[108:111], v[180:183]
ds_read_b128 a[132:135], v11 offset:16384
v_mfma_f32_16x16x32_bf16 v[184:187], a[8:11], a[104:107], 0
ds_read_b64_tr_b16 a[36:37], v13 offset:0
v_mfma_f32_16x16x32_bf16 v[184:187], a[24:27], a[108:111], v[184:187]
ds_read_b64_tr_b16 a[38:39], v13 offset:2048
v_mfma_f32_16x16x32_bf16 v[188:191], a[12:15], a[104:107], 0
ds_read_b64_tr_b16 a[52:53], v13 offset:16384
v_mfma_f32_16x16x32_bf16 v[188:191], a[28:31], a[108:111], v[188:191]
ds_read_b64_tr_b16 a[54:55], v13 offset:18432
s_waitcnt lgkmcnt(7)
v_mfma_f32_16x16x32_bf16 v[192:195], a[0:3], a[112:115], 0
ds_read_b64_tr_b16 a[40:41], v14 offset:0
v_mfma_f32_16x16x32_bf16 v[192:195], a[16:19], a[116:119], v[192:195]
ds_read_b64_tr_b16 a[42:43], v14 offset:2048
v_mfma_f32_16x16x32_bf16 v[196:199], a[4:7], a[112:115], 0
ds_read_b128 a[136:139], v10 offset:18432
v_add_u32 v10, s63, v10
v_mfma_f32_16x16x32_bf16 v[196:199], a[20:23], a[116:119], v[196:199]
ds_read_b128 a[140:143], v11 offset:18432
v_add_u32 v11, s63, v11
v_mfma_f32_16x16x32_bf16 v[200:203], a[8:11], a[112:115], 0
ds_read_b64_tr_b16 a[56:57], v14 offset:16384
v_mfma_f32_16x16x32_bf16 v[200:203], a[24:27], a[116:119], v[200:203]
ds_read_b64_tr_b16 a[58:59], v14 offset:18432
v_mfma_f32_16x16x32_bf16 v[204:207], a[12:15], a[112:115], 0
ds_read_b64_tr_b16 a[44:45], v15 offset:0
v_mfma_f32_16x16x32_bf16 v[204:207], a[28:31], a[116:119], v[204:207]
ds_read_b64_tr_b16 a[46:47], v15 offset:2048
v_mfma_f32_16x16x32_bf16 v[208:211], a[0:3], a[120:123], 0
buffer_load_dwordx4 v5, s[20:23], s50 offen offset:1024 lds
s_add_u32 s50, s57, 292864
v_mfma_f32_16x16x32_bf16 v[208:211], a[16:19], a[124:127], v[208:211]
ds_read_b64_tr_b16 a[60:61], v15 offset:16384
v_mfma_f32_16x16x32_bf16 v[212:215], a[4:7], a[120:123], 0
ds_read_b64_tr_b16 a[62:63], v15 offset:18432
v_mfma_f32_16x16x32_bf16 v[212:215], a[20:23], a[124:127], v[212:215]
buffer_load_dwordx4 v5, s[20:23], s50 offen offset:2048 lds
s_add_u32 s50, s57, 422912
v_mfma_f32_16x16x32_bf16 v[216:219], a[8:11], a[120:123], 0
s_waitcnt vmcnt(7) lgkmcnt(6)
s_barrier
v_mfma_f32_16x16x32_bf16 v[216:219], a[24:27], a[124:127], v[216:219]
ds_read_b128 a[64:67], v10 offset:0
v_mfma_f32_16x16x32_bf16 v[220:223], a[12:15], a[120:123], 0
buffer_load_dwordx4 v5, s[20:23], s50 offen offset:3072 lds
s_add_u32 s57, s57, 524288
v_mfma_f32_16x16x32_bf16 v[220:223], a[28:31], a[124:127], v[220:223]
ds_read_b128 a[68:71], v11 offset:0
s_cmp_ge_u32 s57, 3670016
s_cselect_b32 s51, 3670016, 0
v_mfma_f32_16x16x32_bf16 v[224:227], a[0:3], a[128:131], 0
s_sub_u32 s57, s57, s51
s_cmp_lt_u32 s59, 32768
s_cselect_b32 s51, 98304, 0
s_add_u32 s59, s59, s51
v_mfma_f32_16x16x32_bf16 v[224:227], a[16:19], a[132:135], v[224:227]
s_sub_u32 s59, s59, 32768
s_add_u32 m0, s60, 0
v_mfma_f32_16x16x32_bf16 v[228:231], a[4:7], a[128:131], 0
ds_read_b128 a[72:75], v10 offset:2048
s_add_u32 s50, s58, 0
v_mfma_f32_16x16x32_bf16 v[228:231], a[20:23], a[132:135], v[228:231]
ds_read_b128 a[76:79], v11 offset:2048
v_mfma_f32_16x16x32_bf16 v[232:235], a[8:11], a[128:131], 0
buffer_load_dwordx4 v6, s[8:11], s50 offen offset:0 lds
s_add_u32 m0, s60, 4096
v_mfma_f32_16x16x32_bf16 v[232:235], a[24:27], a[132:135], v[232:235]
s_add_u32 s50, s58, 28672
v_mfma_f32_16x16x32_bf16 v[236:239], a[12:15], a[128:131], 0
v_mfma_f32_16x16x32_bf16 v[236:239], a[28:31], a[132:135], v[236:239]
buffer_load_dwordx4 v6, s[8:11], s50 offen offset:0 lds
s_add_u32 m0, s60, 8192
v_mfma_f32_16x16x32_bf16 v[240:243], a[0:3], a[136:139], 0
s_add_u32 s50, s58, 57344
v_mfma_f32_16x16x32_bf16 v[240:243], a[16:19], a[140:143], v[240:243]
v_mfma_f32_16x16x32_bf16 v[244:247], a[4:7], a[136:139], 0
ds_read_b128 a[80:83], v10 offset:4096
v_mfma_f32_16x16x32_bf16 v[244:247], a[20:23], a[140:143], v[244:247]
ds_read_b128 a[84:87], v11 offset:4096
v_mfma_f32_16x16x32_bf16 v[248:251], a[8:11], a[136:139], 0
buffer_load_dwordx4 v6, s[8:11], s50 offen offset:0 lds
s_add_u32 m0, s60, 12288
v_mfma_f32_16x16x32_bf16 v[248:251], a[24:27], a[140:143], v[248:251]
s_add_u32 s50, s58, 86016
v_mfma_f32_16x16x32_bf16 v[252:255], a[12:15], a[136:139], 0
s_waitcnt lgkmcnt(2)
v_mfma_f32_16x16x32_bf16 v[252:255], a[28:31], a[140:143], v[252:255]
buffer_load_dwordx4 v6, s[8:11], s50 offen offset:0 lds
s_add_u32 m0, s60, 16384
v_mfma_f32_16x16x32_bf16 v[96:99], a[32:35], a[64:67], v[96:99]
s_add_u32 s50, s58, 114688
v_mfma_f32_16x16x32_bf16 v[96:99], a[48:51], a[68:71], v[96:99]
v_mfma_f32_16x16x32_bf16 v[100:103], a[52:55], a[68:71], v[100:103]
ds_read_b128 a[88:91], v10 offset:6144
v_mfma_f32_16x16x32_bf16 v[100:103], a[36:39], a[64:67], v[100:103]
ds_read_b128 a[92:95], v11 offset:6144
v_mfma_f32_16x16x32_bf16 v[104:107], a[40:43], a[64:67], v[104:107]
buffer_load_dwordx4 v6, s[8:11], s50 offen offset:0 lds
s_add_u32 s58, s58, 128
v_mfma_f32_16x16x32_bf16 v[104:107], a[56:59], a[68:71], v[104:107]
s_cmp_eq_u32 s58, s89
s_cselect_b32 s51, 896, 0
s_sub_u32 s58, s58, s51
s_cmp_ge_u32 s60, 139264
s_cselect_b32 s51, 61440, 0
v_mfma_f32_16x16x32_bf16 v[108:111], a[60:63], a[68:71], v[108:111]
s_sub_u32 s60, s60, s51
s_add_u32 s60, s60, 20480
v_mfma_f32_16x16x32_bf16 v[108:111], a[44:47], a[64:67], v[108:111]
s_add_u32 m0, s59, 0
s_add_u32 s50, s57, 0
s_cmp_eq_u32 s61, 0
s_cselect_b32 s46, 98304, 0
v_mfma_f32_16x16x32_bf16 v[112:115], a[32:35], a[72:75], v[112:115]
buffer_load_dwordx4 v5, s[20:23], s50 offen offset:0 lds
s_add_u32 s50, s57, 130048
v_mfma_f32_16x16x32_bf16 v[112:115], a[48:51], a[76:79], v[112:115]
s_sub_u32 s46, s46, 32768
s_add_u32 s61, s61, s46
s_cmp_eq_u32 s62, 40960
s_cselect_b32 s63, 61440, 0
v_mfma_f32_16x16x32_bf16 v[116:119], a[52:55], a[76:79], v[116:119]
ds_read_b128 a[96:99], v10 offset:8192
s_sub_u32 s63, 20480, s63
v_mfma_f32_16x16x32_bf16 v[116:119], a[36:39], a[72:75], v[116:119]
ds_read_b128 a[100:103], v11 offset:8192
s_add_u32 s62, s62, s63
v_mfma_f32_16x16x32_bf16 v[120:123], a[40:43], a[72:75], v[120:123]
buffer_load_dwordx4 v5, s[20:23], s50 offen offset:1024 lds
s_add_u32 s50, s57, 30720
v_mfma_f32_16x16x32_bf16 v[120:123], a[56:59], a[76:79], v[120:123]
v_add_u32 v12, s46, v12
v_add_u32 v13, s46, v13
v_mfma_f32_16x16x32_bf16 v[124:127], a[60:63], a[76:79], v[124:127]
s_waitcnt lgkmcnt(2)
v_add_u32 v14, s46, v14
v_add_u32 v15, s46, v15
v_mfma_f32_16x16x32_bf16 v[124:127], a[44:47], a[72:75], v[124:127]
buffer_load_dwordx4 v5, s[20:23], s50 offen offset:2048 lds
s_add_u32 s50, s57, 160768
v_mfma_f32_16x16x32_bf16 v[128:131], a[32:35], a[80:83], v[128:131]
v_mfma_f32_16x16x32_bf16 v[128:131], a[48:51], a[84:87], v[128:131]
v_mfma_f32_16x16x32_bf16 v[132:135], a[52:55], a[84:87], v[132:135]
ds_read_b128 a[104:107], v10 offset:10240
v_mfma_f32_16x16x32_bf16 v[132:135], a[36:39], a[80:83], v[132:135]
ds_read_b128 a[108:111], v11 offset:10240
v_mfma_f32_16x16x32_bf16 v[136:139], a[40:43], a[80:83], v[136:139]
buffer_load_dwordx4 v5, s[20:23], s50 offen offset:3072 lds
s_add_u32 m0, s59, 16384
v_mfma_f32_16x16x32_bf16 v[136:139], a[56:59], a[84:87], v[136:139]
s_add_u32 s50, s57, 262144
v_mfma_f32_16x16x32_bf16 v[140:143], a[60:63], a[84:87], v[140:143]
v_mfma_f32_16x16x32_bf16 v[140:143], a[44:47], a[80:83], v[140:143]
buffer_load_dwordx4 v5, s[20:23], s50 offen offset:0 lds
s_add_u32 s50, s57, 392192
v_mfma_f32_16x16x32_bf16 v[144:147], a[32:35], a[88:91], v[144:147]
v_mfma_f32_16x16x32_bf16 v[144:147], a[48:51], a[92:95], v[144:147]
v_mfma_f32_16x16x32_bf16 v[148:151], a[52:55], a[92:95], v[148:151]
ds_read_b128 a[112:115], v10 offset:12288
v_mfma_f32_16x16x32_bf16 v[148:151], a[36:39], a[88:91], v[148:151]
ds_read_b128 a[116:119], v11 offset:12288
v_mfma_f32_16x16x32_bf16 v[152:155], a[40:43], a[88:91], v[152:155]
buffer_load_dwordx4 v5, s[20:23], s50 offen offset:1024 lds
s_add_u32 s50, s57, 292864
v_mfma_f32_16x16x32_bf16 v[152:155], a[56:59], a[92:95], v[152:155]
v_mfma_f32_16x16x32_bf16 v[156:159], a[60:63], a[92:95], v[156:159]
s_waitcnt lgkmcnt(2)
v_mfma_f32_16x16x32_bf16 v[156:159], a[44:47], a[88:91], v[156:159]
buffer_load_dwordx4 v5, s[20:23], s50 offen offset:2048 lds
s_add_u32 s50, s57, 422912
v_mfma_f32_16x16x32_bf16 v[160:163], a[32:35], a[96:99], v[160:163]
v_mfma_f32_16x16x32_bf16 v[160:163], a[48:51], a[100:103], v[160:163]
v_mfma_f32_16x16x32_bf16 v[164:167], a[52:55], a[100:103], v[164:167]
ds_read_b128 a[120:123], v10 offset:14336
v_mfma_f32_16x16x32_bf16 v[164:167], a[36:39], a[96:99], v[164:167]
ds_read_b128 a[124:127], v11 offset:14336
v_mfma_f32_16x16x32_bf16 v[168:171], a[40:43], a[96:99], v[168:171]
buffer_load_dwordx4 v5, s[20:23], s50 offen offset:3072 lds
s_add_u32 s57, s57, 524288
v_mfma_f32_16x16x32_bf16 v[168:171], a[56:59], a[100:103], v[168:171]
s_cmp_ge_u32 s57, 3670016
s_cselect_b32 s51, 3670016, 0
s_sub_u32 s57, s57, s51
s_cmp_lt_u32 s59, 32768
s_cselect_b32 s51, 98304, 0
v_mfma_f32_16x16x32_bf16 v[172:175], a[60:63], a[100:103], v[172:175]
s_add_u32 s59, s59, s51
s_sub_u32 s59, s59, 32768
s_waitcnt vmcnt(13)
v_mfma_f32_16x16x32_bf16 v[172:175], a[44:47], a[96:99], v[172:175]
ds_read_b64_tr_b16 a[0:1], v12 offset:0
v_mfma_f32_16x16x32_bf16 v[176:179], a[32:35], a[104:107], v[176:179]
ds_read_b64_tr_b16 a[2:3], v12 offset:2048
s_add_u32 m0, s60, 0
v_mfma_f32_16x16x32_bf16 v[176:179], a[48:51], a[108:111], v[176:179]
ds_read_b64_tr_b16 a[16:17], v12 offset:16384
s_add_u32 s50, s58, 0
v_mfma_f32_16x16x32_bf16 v[180:183], a[52:55], a[108:111], v[180:183]
ds_read_b128 a[128:131], v10 offset:16384
v_mfma_f32_16x16x32_bf16 v[180:183], a[36:39], a[104:107], v[180:183]
ds_read_b128 a[132:135], v11 offset:16384
v_mfma_f32_16x16x32_bf16 v[184:187], a[40:43], a[104:107], v[184:187]
ds_read_b64_tr_b16 a[18:19], v12 offset:18432
v_mfma_f32_16x16x32_bf16 v[184:187], a[56:59], a[108:111], v[184:187]
ds_read_b64_tr_b16 a[4:5], v13 offset:0
v_mfma_f32_16x16x32_bf16 v[188:191], a[60:63], a[108:111], v[188:191]
ds_read_b64_tr_b16 a[6:7], v13 offset:2048
v_mfma_f32_16x16x32_bf16 v[188:191], a[44:47], a[104:107], v[188:191]
ds_read_b64_tr_b16 a[20:21], v13 offset:16384
s_waitcnt lgkmcnt(7)
v_mfma_f32_16x16x32_bf16 v[192:195], a[32:35], a[112:115], v[192:195]
ds_read_b64_tr_b16 a[22:23], v13 offset:18432
v_mfma_f32_16x16x32_bf16 v[192:195], a[48:51], a[116:119], v[192:195]
ds_read_b64_tr_b16 a[8:9], v14 offset:0
v_mfma_f32_16x16x32_bf16 v[196:199], a[52:55], a[116:119], v[196:199]
ds_read_b128 a[136:139], v10 offset:18432
v_add_u32 v10, s63, v10
v_mfma_f32_16x16x32_bf16 v[196:199], a[36:39], a[112:115], v[196:199]
ds_read_b128 a[140:143], v11 offset:18432
v_add_u32 v11, s63, v11
v_mfma_f32_16x16x32_bf16 v[200:203], a[40:43], a[112:115], v[200:203]
ds_read_b64_tr_b16 a[10:11], v14 offset:2048
v_mfma_f32_16x16x32_bf16 v[200:203], a[56:59], a[116:119], v[200:203]
ds_read_b64_tr_b16 a[24:25], v14 offset:16384
v_mfma_f32_16x16x32_bf16 v[204:207], a[60:63], a[116:119], v[204:207]
ds_read_b64_tr_b16 a[26:27], v14 offset:18432
v_mfma_f32_16x16x32_bf16 v[204:207], a[44:47], a[112:115], v[204:207]
ds_read_b64_tr_b16 a[12:13], v15 offset:0
v_mfma_f32_16x16x32_bf16 v[208:211], a[32:35], a[120:123], v[208:211]
ds_read_b64_tr_b16 a[14:15], v15 offset:2048
v_mfma_f32_16x16x32_bf16 v[208:211], a[48:51], a[124:127], v[208:211]
ds_read_b64_tr_b16 a[28:29], v15 offset:16384
v_mfma_f32_16x16x32_bf16 v[212:215], a[52:55], a[124:127], v[212:215]
ds_read_b64_tr_b16 a[30:31], v15 offset:18432
v_mfma_f32_16x16x32_bf16 v[212:215], a[36:39], a[120:123], v[212:215]
buffer_load_dwordx4 v6, s[8:11], s50 offen offset:0 lds
s_add_u32 m0, s60, 4096
v_mfma_f32_16x16x32_bf16 v[216:219], a[40:43], a[120:123], v[216:219]
s_waitcnt vmcnt(9) lgkmcnt(7)
s_barrier
s_add_u32 s50, s58, 28672
v_mfma_f32_16x16x32_bf16 v[216:219], a[56:59], a[124:127], v[216:219]
ds_read_b128 a[64:67], v10 offset:0
v_mfma_f32_16x16x32_bf16 v[220:223], a[60:63], a[124:127], v[220:223]
ds_read_b128 a[68:71], v11 offset:0
v_mfma_f32_16x16x32_bf16 v[220:223], a[44:47], a[120:123], v[220:223]
buffer_load_dwordx4 v6, s[8:11], s50 offen offset:0 lds
s_add_u32 m0, s60, 8192
v_mfma_f32_16x16x32_bf16 v[224:227], a[32:35], a[128:131], v[224:227]
s_add_u32 s50, s58, 57344
v_mfma_f32_16x16x32_bf16 v[224:227], a[48:51], a[132:135], v[224:227]
v_mfma_f32_16x16x32_bf16 v[228:231], a[52:55], a[132:135], v[228:231]
ds_read_b128 a[72:75], v10 offset:2048
v_mfma_f32_16x16x32_bf16 v[228:231], a[36:39], a[128:131], v[228:231]
ds_read_b128 a[76:79], v11 offset:2048
v_mfma_f32_16x16x32_bf16 v[232:235], a[40:43], a[128:131], v[232:235]
buffer_load_dwordx4 v6, s[8:11], s50 offen offset:0 lds
s_add_u32 m0, s60, 12288
v_mfma_f32_16x16x32_bf16 v[232:235], a[56:59], a[132:135], v[232:235]
s_add_u32 s50, s58, 86016
v_mfma_f32_16x16x32_bf16 v[236:239], a[60:63], a[132:135], v[236:239]
v_mfma_f32_16x16x32_bf16 v[236:239], a[44:47], a[128:131], v[236:239]
buffer_load_dwordx4 v6, s[8:11], s50 offen offset:0 lds
s_add_u32 m0, s60, 16384
v_mfma_f32_16x16x32_bf16 v[240:243], a[32:35], a[136:139], v[240:243]
s_add_u32 s50, s58, 114688
v_mfma_f32_16x16x32_bf16 v[240:243], a[48:51], a[140:143], v[240:243]
v_mfma_f32_16x16x32_bf16 v[244:247], a[52:55], a[140:143], v[244:247]
ds_read_b128 a[80:83], v10 offset:4096
v_mfma_f32_16x16x32_bf16 v[244:247], a[36:39], a[136:139], v[244:247]
ds_read_b128 a[84:87], v11 offset:4096
v_mfma_f32_16x16x32_bf16 v[248:251], a[40:43], a[136:139], v[248:251]
buffer_load_dwordx4 v6, s[8:11], s50 offen offset:0 lds
s_add_u32 s58, s58, 128
v_mfma_f32_16x16x32_bf16 v[248:251], a[56:59], a[140:143], v[248:251]
s_cmp_eq_u32 s58, s89
s_cselect_b32 s51, 896, 0
s_sub_u32 s58, s58, s51
s_cmp_ge_u32 s60, 139264
s_cselect_b32 s51, 61440, 0
v_mfma_f32_16x16x32_bf16 v[252:255], a[60:63], a[140:143], v[252:255]
s_sub_u32 s60, s60, s51
s_add_u32 s60, s60, 20480
v_mfma_f32_16x16x32_bf16 v[252:255], a[44:47], a[136:139], v[252:255]
s_add_u32 m0, s59, 0
s_add_u32 s50, s57, 0
s_waitcnt lgkmcnt(2)
v_mfma_f32_16x16x32_bf16 v[96:99], a[0:3], a[64:67], v[96:99]
buffer_load_dwordx4 v5, s[20:23], s50 offen offset:0 lds
s_add_u32 s50, s57, 130048
v_mfma_f32_16x16x32_bf16 v[96:99], a[16:19], a[68:71], v[96:99]
v_mfma_f32_16x16x32_bf16 v[100:103], a[20:23], a[68:71], v[100:103]
ds_read_b128 a[88:91], v10 offset:6144
v_mfma_f32_16x16x32_bf16 v[100:103], a[4:7], a[64:67], v[100:103]
ds_read_b128 a[92:95], v11 offset:6144
v_mfma_f32_16x16x32_bf16 v[104:107], a[8:11], a[64:67], v[104:107]
buffer_load_dwordx4 v5, s[20:23], s50 offen offset:1024 lds
s_add_u32 s50, s57, 30720
v_mfma_f32_16x16x32_bf16 v[104:107], a[24:27], a[68:71], v[104:107]
s_cmp_eq_u32 s61, 0
s_cselect_b32 s46, 98304, 0
s_sub_u32 s46, s46, 32768
s_add_u32 s61, s61, s46
v_mfma_f32_16x16x32_bf16 v[108:111], a[28:31], a[68:71], v[108:111]
s_cmp_eq_u32 s62, 40960
s_cselect_b32 s63, 61440, 0
s_sub_u32 s63, 20480, s63
s_add_u32 s62, s62, s63
v_mfma_f32_16x16x32_bf16 v[108:111], a[12:15], a[64:67], v[108:111]
buffer_load_dwordx4 v5, s[20:23], s50 offen offset:2048 lds
s_add_u32 s50, s57, 160768
v_mfma_f32_16x16x32_bf16 v[112:115], a[0:3], a[72:75], v[112:115]
v_add_u32 v12, s46, v12
v_add_u32 v13, s46, v13
v_mfma_f32_16x16x32_bf16 v[112:115], a[16:19], a[76:79], v[112:115]
v_add_u32 v14, s46, v14
v_add_u32 v15, s46, v15
v_mfma_f32_16x16x32_bf16 v[116:119], a[20:23], a[76:79], v[116:119]
ds_read_b128 a[96:99], v10 offset:8192
v_mfma_f32_16x16x32_bf16 v[116:119], a[4:7], a[72:75], v[116:119]
ds_read_b128 a[100:103], v11 offset:8192
v_mfma_f32_16x16x32_bf16 v[120:123], a[8:11], a[72:75], v[120:123]
buffer_load_dwordx4 v5, s[20:23], s50 offen offset:3072 lds
s_add_u32 m0, s59, 16384
v_mfma_f32_16x16x32_bf16 v[120:123], a[24:27], a[76:79], v[120:123]
s_add_u32 s50, s57, 262144
v_mfma_f32_16x16x32_bf16 v[124:127], a[28:31], a[76:79], v[124:127]
s_waitcnt lgkmcnt(2)
v_mfma_f32_16x16x32_bf16 v[124:127], a[12:15], a[72:75], v[124:127]
buffer_load_dwordx4 v5, s[20:23], s50 offen offset:0 lds
s_add_u32 s50, s57, 392192
v_mfma_f32_16x16x32_bf16 v[128:131], a[0:3], a[80:83], v[128:131]
v_mfma_f32_16x16x32_bf16 v[128:131], a[16:19], a[84:87], v[128:131]
v_mfma_f32_16x16x32_bf16 v[132:135], a[20:23], a[84:87], v[132:135]
ds_read_b128 a[104:107], v10 offset:10240
v_mfma_f32_16x16x32_bf16 v[132:135], a[4:7], a[80:83], v[132:135]
ds_read_b128 a[108:111], v11 offset:10240
v_mfma_f32_16x16x32_bf16 v[136:139], a[8:11], a[80:83], v[136:139]
buffer_load_dwordx4 v5, s[20:23], s50 offen offset:1024 lds
s_add_u32 s50, s57, 292864
v_mfma_f32_16x16x32_bf16 v[136:139], a[24:27], a[84:87], v[136:139]
v_mfma_f32_16x16x32_bf16 v[140:143], a[28:31], a[84:87], v[140:143]
v_mfma_f32_16x16x32_bf16 v[140:143], a[12:15], a[80:83], v[140:143]
buffer_load_dwordx4 v5, s[20:23], s50 offen offset:2048 lds
s_add_u32 s50, s57, 422912
v_mfma_f32_16x16x32_bf16 v[144:147], a[0:3], a[88:91], v[144:147]
v_mfma_f32_16x16x32_bf16 v[144:147], a[16:19], a[92:95], v[144:147]
v_mfma_f32_16x16x32_bf16 v[148:151], a[20:23], a[92:95], v[148:151]
ds_read_b128 a[112:115], v10 offset:12288
v_mfma_f32_16x16x32_bf16 v[148:151], a[4:7], a[88:91], v[148:151]
ds_read_b128 a[116:119], v11 offset:12288
v_mfma_f32_16x16x32_bf16 v[152:155], a[8:11], a[88:91], v[152:155]
buffer_load_dwordx4 v5, s[20:23], s50 offen offset:3072 lds
s_add_u32 s57, s57, 524288
v_mfma_f32_16x16x32_bf16 v[152:155], a[24:27], a[92:95], v[152:155]
s_cmp_ge_u32 s57, 3670016
s_cselect_b32 s51, 3670016, 0
s_sub_u32 s57, s57, s51
s_cmp_lt_u32 s59, 32768
s_cselect_b32 s51, 98304, 0
v_mfma_f32_16x16x32_bf16 v[156:159], a[28:31], a[92:95], v[156:159]
s_add_u32 s59, s59, s51
s_sub_u32 s59, s59, 32768
v_mfma_f32_16x16x32_bf16 v[156:159], a[12:15], a[88:91], v[156:159]
s_add_u32 m0, s60, 0
s_add_u32 s50, s58, 0
s_waitcnt lgkmcnt(2)
v_mfma_f32_16x16x32_bf16 v[160:163], a[0:3], a[96:99], v[160:163]
buffer_load_dwordx4 v6, s[8:11], s50 offen offset:0 lds
s_add_u32 m0, s60, 4096
v_mfma_f32_16x16x32_bf16 v[160:163], a[16:19], a[100:103], v[160:163]
s_add_u32 s50, s58, 28672
v_mfma_f32_16x16x32_bf16 v[164:167], a[20:23], a[100:103], v[164:167]
ds_read_b128 a[120:123], v10 offset:14336
v_mfma_f32_16x16x32_bf16 v[164:167], a[4:7], a[96:99], v[164:167]
ds_read_b128 a[124:127], v11 offset:14336
v_mfma_f32_16x16x32_bf16 v[168:171], a[8:11], a[96:99], v[168:171]
buffer_load_dwordx4 v6, s[8:11], s50 offen offset:0 lds
s_waitcnt vmcnt(15)
v_mfma_f32_16x16x32_bf16 v[168:171], a[24:27], a[100:103], v[168:171]
s_add_u32 m0, s60, 8192
s_add_u32 s50, s58, 57344
v_mfma_f32_16x16x32_bf16 v[172:175], a[28:31], a[100:103], v[172:175]
ds_read_b64_tr_b16 a[32:33], v12 offset:0
v_mfma_f32_16x16x32_bf16 v[172:175], a[12:15], a[96:99], v[172:175]
ds_read_b64_tr_b16 a[34:35], v12 offset:2048
v_mfma_f32_16x16x32_bf16 v[176:179], a[0:3], a[104:107], v[176:179]
ds_read_b64_tr_b16 a[48:49], v12 offset:16384
v_mfma_f32_16x16x32_bf16 v[176:179], a[16:19], a[108:111], v[176:179]
ds_read_b64_tr_b16 a[50:51], v12 offset:18432
v_mfma_f32_16x16x32_bf16 v[180:183], a[20:23], a[108:111], v[180:183]
ds_read_b128 a[128:131], v10 offset:16384
v_mfma_f32_16x16x32_bf16 v[180:183], a[4:7], a[104:107], v[180:183]
ds_read_b128 a[132:135], v11 offset:16384
v_mfma_f32_16x16x32_bf16 v[184:187], a[8:11], a[104:107], v[184:187]
ds_read_b64_tr_b16 a[36:37], v13 offset:0
v_mfma_f32_16x16x32_bf16 v[184:187], a[24:27], a[108:111], v[184:187]
ds_read_b64_tr_b16 a[38:39], v13 offset:2048
v_mfma_f32_16x16x32_bf16 v[188:191], a[28:31], a[108:111], v[188:191]
ds_read_b64_tr_b16 a[52:53], v13 offset:16384
v_mfma_f32_16x16x32_bf16 v[188:191], a[12:15], a[104:107], v[188:191]
ds_read_b64_tr_b16 a[54:55], v13 offset:18432
s_waitcnt lgkmcnt(7)
v_mfma_f32_16x16x32_bf16 v[192:195], a[0:3], a[112:115], v[192:195]
ds_read_b64_tr_b16 a[40:41], v14 offset:0
v_mfma_f32_16x16x32_bf16 v[192:195], a[16:19], a[116:119], v[192:195]
ds_read_b64_tr_b16 a[42:43], v14 offset:2048
v_mfma_f32_16x16x32_bf16 v[196:199], a[20:23], a[116:119], v[196:199]
ds_read_b128 a[136:139], v10 offset:18432
v_add_u32 v10, s63, v10
v_mfma_f32_16x16x32_bf16 v[196:199], a[4:7], a[112:115], v[196:199]
ds_read_b128 a[140:143], v11 offset:18432
v_add_u32 v11, s63, v11
v_mfma_f32_16x16x32_bf16 v[200:203], a[8:11], a[112:115], v[200:203]
ds_read_b64_tr_b16 a[56:57], v14 offset:16384
v_mfma_f32_16x16x32_bf16 v[200:203], a[24:27], a[116:119], v[200:203]
ds_read_b64_tr_b16 a[58:59], v14 offset:18432
v_mfma_f32_16x16x32_bf16 v[204:207], a[28:31], a[116:119], v[204:207]
ds_read_b64_tr_b16 a[44:45], v15 offset:0
v_mfma_f32_16x16x32_bf16 v[204:207], a[12:15], a[112:115], v[204:207]
ds_read_b64_tr_b16 a[46:47], v15 offset:2048
v_mfma_f32_16x16x32_bf16 v[208:211], a[0:3], a[120:123], v[208:211]
ds_read_b64_tr_b16 a[60:61], v15 offset:16384
v_mfma_f32_16x16x32_bf16 v[208:211], a[16:19], a[124:127], v[208:211]
ds_read_b64_tr_b16 a[62:63], v15 offset:18432
v_mfma_f32_16x16x32_bf16 v[212:215], a[20:23], a[124:127], v[212:215]
buffer_load_dwordx4 v6, s[8:11], s50 offen offset:0 lds
s_add_u32 m0, s60, 12288
v_mfma_f32_16x16x32_bf16 v[212:215], a[4:7], a[120:123], v[212:215]
s_add_u32 s50, s58, 86016
v_mfma_f32_16x16x32_bf16 v[216:219], a[8:11], a[120:123], v[216:219]
s_waitcnt vmcnt(11) lgkmcnt(6)
s_barrier
v_mfma_f32_16x16x32_bf16 v[216:219], a[24:27], a[124:127], v[216:219]
ds_read_b128 a[64:67], v10 offset:0
v_mfma_f32_16x16x32_bf16 v[220:223], a[28:31], a[124:127], v[220:223]
ds_read_b128 a[68:71], v11 offset:0
v_mfma_f32_16x16x32_bf16 v[220:223], a[12:15], a[120:123], v[220:223]
buffer_load_dwordx4 v6, s[8:11], s50 offen offset:0 lds
s_add_u32 m0, s60, 16384
v_mfma_f32_16x16x32_bf16 v[224:227], a[0:3], a[128:131], v[224:227]
s_add_u32 s50, s58, 114688
v_mfma_f32_16x16x32_bf16 v[224:227], a[16:19], a[132:135], v[224:227]
v_mfma_f32_16x16x32_bf16 v[228:231], a[20:23], a[132:135], v[228:231]
ds_read_b128 a[72:75], v10 offset:2048
v_mfma_f32_16x16x32_bf16 v[228:231], a[4:7], a[128:131], v[228:231]
ds_read_b128 a[76:79], v11 offset:2048
v_mfma_f32_16x16x32_bf16 v[232:235], a[8:11], a[128:131], v[232:235]
buffer_load_dwordx4 v6, s[8:11], s50 offen offset:0 lds
s_add_u32 s58, s58, 128
v_mfma_f32_16x16x32_bf16 v[232:235], a[24:27], a[132:135], v[232:235]
s_cmp_eq_u32 s58, s89
s_cselect_b32 s51, 896, 0
s_sub_u32 s58, s58, s51
s_cmp_ge_u32 s60, 139264
s_cselect_b32 s51, 61440, 0
v_mfma_f32_16x16x32_bf16 v[236:239], a[28:31], a[132:135], v[236:239]
s_sub_u32 s60, s60, s51
s_add_u32 s60, s60, 20480
v_mfma_f32_16x16x32_bf16 v[236:239], a[12:15], a[128:131], v[236:239]
s_add_u32 m0, s59, 0
s_add_u32 s50, s57, 0
v_mfma_f32_16x16x32_bf16 v[240:243], a[0:3], a[136:139], v[240:243]
buffer_load_dwordx4 v5, s[20:23], s50 offen offset:0 lds
s_add_u32 s50, s57, 130048
v_mfma_f32_16x16x32_bf16 v[240:243], a[16:19], a[140:143], v[240:243]
v_mfma_f32_16x16x32_bf16 v[244:247], a[20:23], a[140:143], v[244:247]
ds_read_b128 a[80:83], v10 offset:4096
v_mfma_f32_16x16x32_bf16 v[244:247], a[4:7], a[136:139], v[244:247]
ds_read_b128 a[84:87], v11 offset:4096
v_mfma_f32_16x16x32_bf16 v[248:251], a[8:11], a[136:139], v[248:251]
buffer_load_dwordx4 v5, s[20:23], s50 offen offset:1024 lds
s_add_u32 s50, s57, 30720
v_mfma_f32_16x16x32_bf16 v[248:251], a[24:27], a[140:143], v[248:251]
v_mfma_f32_16x16x32_bf16 v[252:255], a[28:31], a[140:143], v[252:255]
s_waitcnt lgkmcnt(2)
v_mfma_f32_16x16x32_bf16 v[252:255], a[12:15], a[136:139], v[252:255]
buffer_load_dwordx4 v5, s[20:23], s50 offen offset:2048 lds
s_add_u32 s50, s57, 160768
v_mfma_f32_16x16x32_bf16 v[96:99], a[32:35], a[64:67], v[96:99]
v_mfma_f32_16x16x32_bf16 v[96:99], a[48:51], a[68:71], v[96:99]
v_mfma_f32_16x16x32_bf16 v[100:103], a[52:55], a[68:71], v[100:103]
ds_read_b128 a[88:91], v10 offset:6144
v_mfma_f32_16x16x32_bf16 v[100:103], a[36:39], a[64:67], v[100:103]
ds_read_b128 a[92:95], v11 offset:6144
v_mfma_f32_16x16x32_bf16 v[104:107], a[40:43], a[64:67], v[104:107]
buffer_load_dwordx4 v5, s[20:23], s50 offen offset:3072 lds
s_add_u32 m0, s59, 16384
v_mfma_f32_16x16x32_bf16 v[104:107], a[56:59], a[68:71], v[104:107]
s_add_u32 s50, s57, 262144
s_cmp_eq_u32 s61, 0
s_cselect_b32 s46, 98304, 0
s_sub_u32 s46, s46, 32768
v_mfma_f32_16x16x32_bf16 v[108:111], a[60:63], a[68:71], v[108:111]
s_add_u32 s61, s61, s46
s_cmp_eq_u32 s62, 40960
s_cselect_b32 s63, 61440, 0
s_sub_u32 s63, 20480, s63
v_mfma_f32_16x16x32_bf16 v[108:111], a[44:47], a[64:67], v[108:111]
buffer_load_dwordx4 v5, s[20:23], s50 offen offset:0 lds
s_add_u32 s50, s57, 392192
v_mfma_f32_16x16x32_bf16 v[112:115], a[32:35], a[72:75], v[112:115]
s_add_u32 s62, s62, s63
v_mfma_f32_16x16x32_bf16 v[112:115], a[48:51], a[76:79], v[112:115]
v_add_u32 v12, s46, v12
v_add_u32 v13, s46, v13
v_mfma_f32_16x16x32_bf16 v[116:119], a[52:55], a[76:79], v[116:119]
ds_read_b128 a[96:99], v10 offset:8192
v_add_u32 v14, s46, v14
v_mfma_f32_16x16x32_bf16 v[116:119], a[36:39], a[72:75], v[116:119]
ds_read_b128 a[100:103], v11 offset:8192
v_add_u32 v15, s46, v15
v_mfma_f32_16x16x32_bf16 v[120:123], a[40:43], a[72:75], v[120:123]
buffer_load_dwordx4 v5, s[20:23], s50 offen offset:1024 lds
s_add_u32 s50, s57, 292864
v_mfma_f32_16x16x32_bf16 v[120:123], a[56:59], a[76:79], v[120:123]
v_mfma_f32_16x16x32_bf16 v[124:127], a[60:63], a[76:79], v[124:127]
s_waitcnt lgkmcnt(2)
v_mfma_f32_16x16x32_bf16 v[124:127], a[44:47], a[72:75], v[124:127]
buffer_load_dwordx4 v5, s[20:23], s50 offen offset:2048 lds
s_add_u32 s50, s57, 422912
v_mfma_f32_16x16x32_bf16 v[128:131], a[32:35], a[80:83], v[128:131]
v_mfma_f32_16x16x32_bf16 v[128:131], a[48:51], a[84:87], v[128:131]
v_mfma_f32_16x16x32_bf16 v[132:135], a[52:55], a[84:87], v[132:135]
ds_read_b128 a[104:107], v10 offset:10240
v_mfma_f32_16x16x32_bf16 v[132:135], a[36:39], a[80:83], v[132:135]
ds_read_b128 a[108:111], v11 offset:10240
v_mfma_f32_16x16x32_bf16 v[136:139], a[40:43], a[80:83], v[136:139]
buffer_load_dwordx4 v5, s[20:23], s50 offen offset:3072 lds
s_add_u32 s57, s57, 524288
v_mfma_f32_16x16x32_bf16 v[136:139], a[56:59], a[84:87], v[136:139]
s_cmp_ge_u32 s57, 3670016
s_cselect_b32 s51, 3670016, 0
s_sub_u32 s57, s57, s51
s_cmp_lt_u32 s59, 32768
s_cselect_b32 s51, 98304, 0
v_mfma_f32_16x16x32_bf16 v[140:143], a[60:63], a[84:87], v[140:143]
s_add_u32 s59, s59, s51
s_sub_u32 s59, s59, 32768
v_mfma_f32_16x16x32_bf16 v[140:143], a[44:47], a[80:83], v[140:143]
s_add_u32 m0, s60, 0
s_add_u32 s50, s58, 0
v_mfma_f32_16x16x32_bf16 v[144:147], a[32:35], a[88:91], v[144:147]
buffer_load_dwordx4 v6, s[8:11], s50 offen offset:0 lds
s_add_u32 m0, s60, 4096
v_mfma_f32_16x16x32_bf16 v[144:147], a[48:51], a[92:95], v[144:147]
s_add_u32 s50, s58, 28672
v_mfma_f32_16x16x32_bf16 v[148:151], a[52:55], a[92:95], v[148:151]
ds_read_b128 a[112:115], v10 offset:12288
v_mfma_f32_16x16x32_bf16 v[148:151], a[36:39], a[88:91], v[148:151]
ds_read_b128 a[116:119], v11 offset:12288
v_mfma_f32_16x16x32_bf16 v[152:155], a[40:43], a[88:91], v[152:155]
buffer_load_dwordx4 v6, s[8:11], s50 offen offset:0 lds
s_add_u32 m0, s60, 8192
v_mfma_f32_16x16x32_bf16 v[152:155], a[56:59], a[92:95], v[152:155]
s_add_u32 s50, s58, 57344
v_mfma_f32_16x16x32_bf16 v[156:159], a[60:63], a[92:95], v[156:159]
s_waitcnt lgkmcnt(2)
v_mfma_f32_16x16x32_bf16 v[156:159], a[44:47], a[88:91], v[156:159]
buffer_load_dwordx4 v6, s[8:11], s50 offen offset:0 lds
s_add_u32 m0, s60, 12288
v_mfma_f32_16x16x32_bf16 v[160:163], a[32:35], a[96:99], v[160:163]
s_add_u32 s50, s58, 86016
v_mfma_f32_16x16x32_bf16 v[160:163], a[48:51], a[100:103], v[160:163]
v_mfma_f32_16x16x32_bf16 v[164:167], a[52:55], a[100:103], v[164:167]
ds_read_b128 a[120:123], v10 offset:14336
v_mfma_f32_16x16x32_bf16 v[164:167], a[36:39], a[96:99], v[164:167]
ds_read_b128 a[124:127], v11 offset:14336
v_mfma_f32_16x16x32_bf16 v[168:171], a[40:43], a[96:99], v[168:171]
buffer_load_dwordx4 v6, s[8:11], s50 offen offset:0 lds
s_waitcnt vmcnt(17)
v_mfma_f32_16x16x32_bf16 v[168:171], a[56:59], a[100:103], v[168:171]
s_add_u32 m0, s60, 16384
s_add_u32 s50, s58, 114688
v_mfma_f32_16x16x32_bf16 v[172:175], a[60:63], a[100:103], v[172:175]
ds_read_b64_tr_b16 a[0:1], v12 offset:0
v_mfma_f32_16x16x32_bf16 v[172:175], a[44:47], a[96:99], v[172:175]
ds_read_b64_tr_b16 a[2:3], v12 offset:2048
v_mfma_f32_16x16x32_bf16 v[176:179], a[32:35], a[104:107], v[176:179]
ds_read_b64_tr_b16 a[16:17], v12 offset:16384
v_mfma_f32_16x16x32_bf16 v[176:179], a[48:51], a[108:111], v[176:179]
ds_read_b64_tr_b16 a[18:19], v12 offset:18432
v_mfma_f32_16x16x32_bf16 v[180:183], a[52:55], a[108:111], v[180:183]
ds_read_b128 a[128:131], v10 offset:16384
v_mfma_f32_16x16x32_bf16 v[180:183], a[36:39], a[104:107], v[180:183]
ds_read_b128 a[132:135], v11 offset:16384
v_mfma_f32_16x16x32_bf16 v[184:187], a[40:43], a[104:107], v[184:187]
ds_read_b64_tr_b16 a[4:5], v13 offset:0
v_mfma_f32_16x16x32_bf16 v[184:187], a[56:59], a[108:111], v[184:187]
ds_read_b64_tr_b16 a[6:7], v13 offset:2048
v_mfma_f32_16x16x32_bf16 v[188:191], a[60:63], a[108:111], v[188:191]
ds_read_b64_tr_b16 a[20:21], v13 offset:16384
v_mfma_f32_16x16x32_bf16 v[188:191], a[44:47], a[104:107], v[188:191]
ds_read_b64_tr_b16 a[22:23], v13 offset:18432
s_waitcnt lgkmcnt(7)
v_mfma_f32_16x16x32_bf16 v[192:195], a[32:35], a[112:115], v[192:195]
ds_read_b64_tr_b16 a[8:9], v14 offset:0
v_mfma_f32_16x16x32_bf16 v[192:195], a[48:51], a[116:119], v[192:195]
ds_read_b64_tr_b16 a[10:11], v14 offset:2048
v_mfma_f32_16x16x32_bf16 v[196:199], a[52:55], a[116:119], v[196:199]
ds_read_b128 a[136:139], v10 offset:18432
v_add_u32 v10, s63, v10
v_mfma_f32_16x16x32_bf16 v[196:199], a[36:39], a[112:115], v[196:199]
ds_read_b128 a[140:143], v11 offset:18432
v_add_u32 v11, s63, v11
v_mfma_f32_16x16x32_bf16 v[200:203], a[40:43], a[112:115], v[200:203]
ds_read_b64_tr_b16 a[24:25], v14 offset:16384
v_mfma_f32_16x16x32_bf16 v[200:203], a[56:59], a[116:119], v[200:203]
ds_read_b64_tr_b16 a[26:27], v14 offset:18432
v_mfma_f32_16x16x32_bf16 v[204:207], a[60:63], a[116:119], v[204:207]
ds_read_b64_tr_b16 a[12:13], v15 offset:0
v_mfma_f32_16x16x32_bf16 v[204:207], a[44:47], a[112:115], v[204:207]
ds_read_b64_tr_b16 a[14:15], v15 offset:2048
v_mfma_f32_16x16x32_bf16 v[208:211], a[32:35], a[120:123], v[208:211]
ds_read_b64_tr_b16 a[28:29], v15 offset:16384
v_mfma_f32_16x16x32_bf16 v[208:211], a[48:51], a[124:127], v[208:211]
ds_read_b64_tr_b16 a[30:31], v15 offset:18432
v_mfma_f32_16x16x32_bf16 v[212:215], a[52:55], a[124:127], v[212:215]
buffer_load_dwordx4 v6, s[8:11], s50 offen offset:0 lds
s_add_u32 s58, s58, 128
v_mfma_f32_16x16x32_bf16 v[212:215], a[36:39], a[120:123], v[212:215]
s_cmp_eq_u32 s58, s89
s_cselect_b32 s51, 896, 0
s_sub_u32 s58, s58, s51
s_cmp_ge_u32 s60, 139264
s_cselect_b32 s51, 61440, 0
v_mfma_f32_16x16x32_bf16 v[216:219], a[40:43], a[120:123], v[216:219]
s_waitcnt vmcnt(13) lgkmcnt(6)
s_barrier
s_sub_u32 s60, s60, s51
v_mfma_f32_16x16x32_bf16 v[216:219], a[56:59], a[124:127], v[216:219]
ds_read_b128 a[64:67], v10 offset:0
s_add_u32 s60, s60, 20480
v_mfma_f32_16x16x32_bf16 v[220:223], a[60:63], a[124:127], v[220:223]
ds_read_b128 a[68:71], v11 offset:0
v_mfma_f32_16x16x32_bf16 v[220:223], a[44:47], a[120:123], v[220:223]
s_add_u32 m0, s59, 0
s_add_u32 s50, s57, 0
v_mfma_f32_16x16x32_bf16 v[224:227], a[32:35], a[128:131], v[224:227]
buffer_load_dwordx4 v5, s[20:23], s50 offen offset:0 lds
s_add_u32 s50, s57, 130048
v_mfma_f32_16x16x32_bf16 v[224:227], a[48:51], a[132:135], v[224:227]
v_mfma_f32_16x16x32_bf16 v[228:231], a[52:55], a[132:135], v[228:231]
ds_read_b128 a[72:75], v10 offset:2048
v_mfma_f32_16x16x32_bf16 v[228:231], a[36:39], a[128:131], v[228:231]
ds_read_b128 a[76:79], v11 offset:2048
v_mfma_f32_16x16x32_bf16 v[232:235], a[40:43], a[128:131], v[232:235]
buffer_load_dwordx4 v5, s[20:23], s50 offen offset:1024 lds
s_add_u32 s50, s57, 30720
v_mfma_f32_16x16x32_bf16 v[232:235], a[56:59], a[132:135], v[232:235]
v_mfma_f32_16x16x32_bf16 v[236:239], a[60:63], a[132:135], v[236:239]
v_mfma_f32_16x16x32_bf16 v[236:239], a[44:47], a[128:131], v[236:239]
buffer_load_dwordx4 v5, s[20:23], s50 offen offset:2048 lds
s_add_u32 s50, s57, 160768
v_mfma_f32_16x16x32_bf16 v[240:243], a[32:35], a[136:139], v[240:243]
v_mfma_f32_16x16x32_bf16 v[240:243], a[48:51], a[140:143], v[240:243]
v_mfma_f32_16x16x32_bf16 v[244:247], a[52:55], a[140:143], v[244:247]
ds_read_b128 a[80:83], v10 offset:4096
v_mfma_f32_16x16x32_bf16 v[244:247], a[36:39], a[136:139], v[244:247]
ds_read_b128 a[84:87], v11 offset:4096
v_mfma_f32_16x16x32_bf16 v[248:251], a[40:43], a[136:139], v[248:251]
buffer_load_dwordx4 v5, s[20:23], s50 offen offset:3072 lds
s_add_u32 m0, s59, 16384
v_mfma_f32_16x16x32_bf16 v[248:251], a[56:59], a[140:143], v[248:251]
s_add_u32 s50, s57, 262144
v_mfma_f32_16x16x32_bf16 v[252:255], a[60:63], a[140:143], v[252:255]
s_waitcnt lgkmcnt(2)
v_mfma_f32_16x16x32_bf16 v[252:255], a[44:47], a[136:139], v[252:255]
buffer_load_dwordx4 v5, s[20:23], s50 offen offset:0 lds
s_add_u32 s50, s57, 392192
v_mfma_f32_16x16x32_bf16 v[96:99], a[0:3], a[64:67], v[96:99]
v_mfma_f32_16x16x32_bf16 v[96:99], a[16:19], a[68:71], v[96:99]
v_mfma_f32_16x16x32_bf16 v[100:103], a[20:23], a[68:71], v[100:103]
ds_read_b128 a[88:91], v10 offset:6144
v_mfma_f32_16x16x32_bf16 v[100:103], a[4:7], a[64:67], v[100:103]
ds_read_b128 a[92:95], v11 offset:6144
v_mfma_f32_16x16x32_bf16 v[104:107], a[8:11], a[64:67], v[104:107]
buffer_load_dwordx4 v5, s[20:23], s50 offen offset:1024 lds
s_add_u32 s50, s57, 292864
v_mfma_f32_16x16x32_bf16 v[104:107], a[24:27], a[68:71], v[104:107]
s_cmp_eq_u32 s61, 0
s_cselect_b32 s46, 98304, 0
s_sub_u32 s46, s46, 32768
s_add_u32 s61, s61, s46
v_mfma_f32_16x16x32_bf16 v[108:111], a[28:31], a[68:71], v[108:111]
s_cmp_eq_u32 s62, 40960
s_cselect_b32 s63, 61440, 0
s_sub_u32 s63, 20480, s63
s_add_u32 s62, s62, s63
v_mfma_f32_16x16x32_bf16 v[108:111], a[12:15], a[64:67], v[108:111]
buffer_load_dwordx4 v5, s[20:23], s50 offen offset:2048 lds
s_add_u32 s50, s57, 422912
v_mfma_f32_16x16x32_bf16 v[112:115], a[0:3], a[72:75], v[112:115]
v_add_u32 v12, s46, v12
v_add_u32 v13, s46, v13
v_mfma_f32_16x16x32_bf16 v[112:115], a[16:19], a[76:79], v[112:115]
v_add_u32 v14, s46, v14
v_add_u32 v15, s46, v15
v_mfma_f32_16x16x32_bf16 v[116:119], a[20:23], a[76:79], v[116:119]
ds_read_b128 a[96:99], v10 offset:8192
v_mfma_f32_16x16x32_bf16 v[116:119], a[4:7], a[72:75], v[116:119]
ds_read_b128 a[100:103], v11 offset:8192
v_mfma_f32_16x16x32_bf16 v[120:123], a[8:11], a[72:75], v[120:123]
buffer_load_dwordx4 v5, s[20:23], s50 offen offset:3072 lds
s_add_u32 s57, s57, 524288
v_mfma_f32_16x16x32_bf16 v[120:123], a[24:27], a[76:79], v[120:123]
s_cmp_ge_u32 s57, 3670016
s_cselect_b32 s51, 3670016, 0
s_sub_u32 s57, s57, s51
s_cmp_lt_u32 s59, 32768
s_cselect_b32 s51, 98304, 0
v_mfma_f32_16x16x32_bf16 v[124:127], a[28:31], a[76:79], v[124:127]
s_add_u32 s59, s59, s51
s_sub_u32 s59, s59, 32768
v_mfma_f32_16x16x32_bf16 v[124:127], a[12:15], a[72:75], v[124:127]
s_add_u32 m0, s60, 0
s_add_u32 s50, s58, 0
s_waitcnt lgkmcnt(2)
v_mfma_f32_16x16x32_bf16 v[128:131], a[0:3], a[80:83], v[128:131]
buffer_load_dwordx4 v6, s[8:11], s50 offen offset:0 lds
s_add_u32 m0, s60, 4096
v_mfma_f32_16x16x32_bf16 v[128:131], a[16:19], a[84:87], v[128:131]
s_add_u32 s50, s58, 28672
v_mfma_f32_16x16x32_bf16 v[132:135], a[20:23], a[84:87], v[132:135]
ds_read_b128 a[104:107], v10 offset:10240
v_mfma_f32_16x16x32_bf16 v[132:135], a[4:7], a[80:83], v[132:135]
ds_read_b128 a[108:111], v11 offset:10240
v_mfma_f32_16x16x32_bf16 v[136:139], a[8:11], a[80:83], v[136:139]
buffer_load_dwordx4 v6, s[8:11], s50 offen offset:0 lds
s_add_u32 m0, s60, 8192
v_mfma_f32_16x16x32_bf16 v[136:139], a[24:27], a[84:87], v[136:139]
s_add_u32 s50, s58, 57344
v_mfma_f32_16x16x32_bf16 v[140:143], a[28:31], a[84:87], v[140:143]
v_mfma_f32_16x16x32_bf16 v[140:143], a[12:15], a[80:83], v[140:143]
buffer_load_dwordx4 v6, s[8:11], s50 offen offset:0 lds
s_add_u32 m0, s60, 12288
v_mfma_f32_16x16x32_bf16 v[144:147], a[0:3], a[88:91], v[144:147]
s_add_u32 s50, s58, 86016
v_mfma_f32_16x16x32_bf16 v[144:147], a[16:19], a[92:95], v[144:147]
v_mfma_f32_16x16x32_bf16 v[148:151], a[20:23], a[92:95], v[148:151]
ds_read_b128 a[112:115], v10 offset:12288
v_mfma_f32_16x16x32_bf16 v[148:151], a[4:7], a[88:91], v[148:151]
ds_read_b128 a[116:119], v11 offset:12288
v_mfma_f32_16x16x32_bf16 v[152:155], a[8:11], a[88:91], v[152:155]
buffer_load_dwordx4 v6, s[8:11], s50 offen offset:0 lds
s_add_u32 m0, s60, 16384
v_mfma_f32_16x16x32_bf16 v[152:155], a[24:27], a[92:95], v[152:155]
s_add_u32 s50, s58, 114688
v_mfma_f32_16x16x32_bf16 v[156:159], a[28:31], a[92:95], v[156:159]
s_waitcnt lgkmcnt(2)
v_mfma_f32_16x16x32_bf16 v[156:159], a[12:15], a[88:91], v[156:159]
buffer_load_dwordx4 v6, s[8:11], s50 offen offset:0 lds
s_add_u32 s58, s58, 128
v_mfma_f32_16x16x32_bf16 v[160:163], a[0:3], a[96:99], v[160:163]
s_cmp_eq_u32 s58, s89
s_cselect_b32 s51, 896, 0
s_sub_u32 s58, s58, s51
s_cmp_ge_u32 s60, 139264
s_cselect_b32 s51, 61440, 0
v_mfma_f32_16x16x32_bf16 v[160:163], a[16:19], a[100:103], v[160:163]
s_sub_u32 s60, s60, s51
s_add_u32 s60, s60, 20480
v_mfma_f32_16x16x32_bf16 v[164:167], a[20:23], a[100:103], v[164:167]
ds_read_b128 a[120:123], v10 offset:14336
s_mov_b32 m0, s40
v_mfma_f32_16x16x32_bf16 v[164:167], a[4:7], a[96:99], v[164:167]
ds_read_b128 a[124:127], v11 offset:14336
v_mfma_f32_16x16x32_bf16 v[168:171], a[8:11], a[96:99], v[168:171]
buffer_load_dwordx4 v2, s[12:15], s38 offen offset:0 nt lds
s_waitcnt vmcnt(19)
v_mfma_f32_16x16x32_bf16 v[168:171], a[24:27], a[100:103], v[168:171]
v_mfma_f32_16x16x32_bf16 v[172:175], a[28:31], a[100:103], v[172:175]
ds_read_b64_tr_b16 a[32:33], v12 offset:0
v_mfma_f32_16x16x32_bf16 v[172:175], a[12:15], a[96:99], v[172:175]
ds_read_b64_tr_b16 a[34:35], v12 offset:2048
v_mfma_f32_16x16x32_bf16 v[176:179], a[0:3], a[104:107], v[176:179]
ds_read_b64_tr_b16 a[48:49], v12 offset:16384
v_mfma_f32_16x16x32_bf16 v[176:179], a[16:19], a[108:111], v[176:179]
ds_read_b64_tr_b16 a[50:51], v12 offset:18432
v_mfma_f32_16x16x32_bf16 v[180:183], a[20:23], a[108:111], v[180:183]
ds_read_b128 a[128:131], v10 offset:16384
v_mfma_f32_16x16x32_bf16 v[180:183], a[4:7], a[104:107], v[180:183]
ds_read_b128 a[132:135], v11 offset:16384
v_mfma_f32_16x16x32_bf16 v[184:187], a[8:11], a[104:107], v[184:187]
ds_read_b64_tr_b16 a[36:37], v13 offset:0
v_mfma_f32_16x16x32_bf16 v[184:187], a[24:27], a[108:111], v[184:187]
ds_read_b64_tr_b16 a[38:39], v13 offset:2048
v_mfma_f32_16x16x32_bf16 v[188:191], a[28:31], a[108:111], v[188:191]
ds_read_b64_tr_b16 a[52:53], v13 offset:16384
v_mfma_f32_16x16x32_bf16 v[188:191], a[12:15], a[104:107], v[188:191]
ds_read_b64_tr_b16 a[54:55], v13 offset:18432
s_waitcnt lgkmcnt(7)
v_mfma_f32_16x16x32_bf16 v[192:195], a[0:3], a[112:115], v[192:195]
ds_read_b64_tr_b16 a[40:41], v14 offset:0
v_mfma_f32_16x16x32_bf16 v[192:195], a[16:19], a[116:119], v[192:195]
ds_read_b64_tr_b16 a[42:43], v14 offset:2048
v_mfma_f32_16x16x32_bf16 v[196:199], a[20:23], a[116:119], v[196:199]
ds_read_b128 a[136:139], v10 offset:18432
v_add_u32 v10, s63, v10
v_mfma_f32_16x16x32_bf16 v[196:199], a[4:7], a[112:115], v[196:199]
ds_read_b128 a[140:143], v11 offset:18432
v_add_u32 v11, s63, v11
v_mfma_f32_16x16x32_bf16 v[200:203], a[8:11], a[112:115], v[200:203]
ds_read_b64_tr_b16 a[56:57], v14 offset:16384
v_mfma_f32_16x16x32_bf16 v[200:203], a[24:27], a[116:119], v[200:203]
ds_read_b64_tr_b16 a[58:59], v14 offset:18432
v_mfma_f32_16x16x32_bf16 v[204:207], a[28:31], a[116:119], v[204:207]
ds_read_b64_tr_b16 a[44:45], v15 offset:0
v_mfma_f32_16x16x32_bf16 v[204:207], a[12:15], a[112:115], v[204:207]
ds_read_b64_tr_b16 a[46:47], v15 offset:2048
v_mfma_f32_16x16x32_bf16 v[208:211], a[0:3], a[120:123], v[208:211]
ds_read_b64_tr_b16 a[60:61], v15 offset:16384
v_mfma_f32_16x16x32_bf16 v[208:211], a[16:19], a[124:127], v[208:211]
ds_read_b64_tr_b16 a[62:63], v15 offset:18432
v_mfma_f32_16x16x32_bf16 v[212:215], a[20:23], a[124:127], v[212:215]
buffer_load_dwordx4 v3, s[12:15], s38 offen offset:1024 nt lds
v_mfma_f32_16x16x32_bf16 v[212:215], a[4:7], a[120:123], v[212:215]
v_mfma_f32_16x16x32_bf16 v[216:219], a[8:11], a[120:123], v[216:219]
s_waitcnt vmcnt(15) lgkmcnt(6)
s_barrier
v_mfma_f32_16x16x32_bf16 v[216:219], a[24:27], a[124:127], v[216:219]
ds_read_b128 a[64:67], v10 offset:0
v_mfma_f32_16x16x32_bf16 v[220:223], a[28:31], a[124:127], v[220:223]
ds_read_b128 a[68:71], v11 offset:0
v_mfma_f32_16x16x32_bf16 v[220:223], a[12:15], a[120:123], v[220:223]
buffer_load_dwordx4 v2, s[12:15], s38 offen offset:2048 nt lds
v_mfma_f32_16x16x32_bf16 v[224:227], a[0:3], a[128:131], v[224:227]
v_mfma_f32_16x16x32_bf16 v[224:227], a[16:19], a[132:135], v[224:227]
v_mfma_f32_16x16x32_bf16 v[228:231], a[20:23], a[132:135], v[228:231]
ds_read_b128 a[72:75], v10 offset:2048
v_mfma_f32_16x16x32_bf16 v[228:231], a[4:7], a[128:131], v[228:231]
ds_read_b128 a[76:79], v11 offset:2048
v_mfma_f32_16x16x32_bf16 v[232:235], a[8:11], a[128:131], v[232:235]
buffer_load_dwordx4 v3, s[12:15], s38 offen offset:3072 nt lds
s_add_u32 m0, s40, 16384
v_mfma_f32_16x16x32_bf16 v[232:235], a[24:27], a[132:135], v[232:235]
s_add_u32 s38, s38, 16384
v_mfma_f32_16x16x32_bf16 v[236:239], a[28:31], a[132:135], v[236:239]
v_mfma_f32_16x16x32_bf16 v[236:239], a[12:15], a[128:131], v[236:239]
buffer_load_dwordx4 v2, s[12:15], s38 offen offset:0 nt lds
v_mfma_f32_16x16x32_bf16 v[240:243], a[0:3], a[136:139], v[240:243]
v_mfma_f32_16x16x32_bf16 v[240:243], a[16:19], a[140:143], v[240:243]
v_mfma_f32_16x16x32_bf16 v[244:247], a[20:23], a[140:143], v[244:247]
ds_read_b128 a[80:83], v10 offset:4096
v_mfma_f32_16x16x32_bf16 v[244:247], a[4:7], a[136:139], v[244:247]
ds_read_b128 a[84:87], v11 offset:4096
v_mfma_f32_16x16x32_bf16 v[248:251], a[8:11], a[136:139], v[248:251]
buffer_load_dwordx4 v3, s[12:15], s38 offen offset:1024 nt lds
v_mfma_f32_16x16x32_bf16 v[248:251], a[24:27], a[140:143], v[248:251]
v_mfma_f32_16x16x32_bf16 v[252:255], a[28:31], a[140:143], v[252:255]
s_waitcnt lgkmcnt(2)
v_mfma_f32_16x16x32_bf16 v[252:255], a[12:15], a[136:139], v[252:255]
buffer_load_dwordx4 v2, s[12:15], s38 offen offset:2048 nt lds
v_mfma_f32_16x16x32_bf16 v[96:99], a[32:35], a[64:67], v[96:99]
v_mfma_f32_16x16x32_bf16 v[96:99], a[48:51], a[68:71], v[96:99]
v_mfma_f32_16x16x32_bf16 v[100:103], a[52:55], a[68:71], v[100:103]
ds_read_b128 a[88:91], v10 offset:6144
v_mfma_f32_16x16x32_bf16 v[100:103], a[36:39], a[64:67], v[100:103]
ds_read_b128 a[92:95], v11 offset:6144
v_mfma_f32_16x16x32_bf16 v[104:107], a[40:43], a[64:67], v[104:107]
buffer_load_dwordx4 v3, s[12:15], s38 offen offset:3072 nt lds
s_add_u32 s38, s38, 16384
v_mfma_f32_16x16x32_bf16 v[104:107], a[56:59], a[68:71], v[104:107]
s_add_u32 s40, s40, 32768
s_cmp_eq_u32 s40, s41
s_cselect_b32 s40, s42, s40
s_add_u32 s40, s40, 32768
v_mfma_f32_16x16x32_bf16 v[108:111], a[60:63], a[68:71], v[108:111]
s_cmp_eq_u32 s40, s41
s_cselect_b32 s40, s42, s40
s_cmp_eq_u32 s61, 0
s_cselect_b32 s46, 98304, 0
s_sub_u32 s46, s46, 32768
v_mfma_f32_16x16x32_bf16 v[108:111], a[44:47], a[64:67], v[108:111]
s_add_u32 s61, s61, s46
s_cmp_eq_u32 s62, 40960
s_cselect_b32 s63, 61440, 0
s_sub_u32 s63, 20480, s63
v_mfma_f32_16x16x32_bf16 v[112:115], a[32:35], a[72:75], v[112:115]
s_add_u32 s62, s62, s63
v_mfma_f32_16x16x32_bf16 v[112:115], a[48:51], a[76:79], v[112:115]
v_add_u32 v12, s46, v12
v_add_u32 v13, s46, v13
v_mfma_f32_16x16x32_bf16 v[116:119], a[52:55], a[76:79], v[116:119]
ds_read_b128 a[96:99], v10 offset:8192
v_add_u32 v14, s46, v14
v_mfma_f32_16x16x32_bf16 v[116:119], a[36:39], a[72:75], v[116:119]
ds_read_b128 a[100:103], v11 offset:8192
v_mfma_f32_16x16x32_bf16 v[120:123], a[40:43], a[72:75], v[120:123]
s_mov_b32 m0, s40
v_add_u32 v15, s46, v15
v_mfma_f32_16x16x32_bf16 v[120:123], a[56:59], a[76:79], v[120:123]
buffer_load_dwordx4 v2, s[12:15], s38 offen offset:0 nt lds
v_mfma_f32_16x16x32_bf16 v[124:127], a[60:63], a[76:79], v[124:127]
v_mfma_f32_16x16x32_bf16 v[124:127], a[44:47], a[72:75], v[124:127]
s_waitcnt lgkmcnt(2)
v_mfma_f32_16x16x32_bf16 v[128:131], a[32:35], a[80:83], v[128:131]
buffer_load_dwordx4 v3, s[12:15], s38 offen offset:1024 nt lds
v_mfma_f32_16x16x32_bf16 v[128:131], a[48:51], a[84:87], v[128:131]
v_mfma_f32_16x16x32_bf16 v[132:135], a[52:55], a[84:87], v[132:135]
ds_read_b128 a[104:107], v10 offset:10240
v_mfma_f32_16x16x32_bf16 v[132:135], a[36:39], a[80:83], v[132:135]
ds_read_b128 a[108:111], v11 offset:10240
v_mfma_f32_16x16x32_bf16 v[136:139], a[40:43], a[80:83], v[136:139]
buffer_load_dwordx4 v2, s[12:15], s38 offen offset:2048 nt lds
v_mfma_f32_16x16x32_bf16 v[136:139], a[56:59], a[84:87], v[136:139]
v_mfma_f32_16x16x32_bf16 v[140:143], a[60:63], a[84:87], v[140:143]
v_mfma_f32_16x16x32_bf16 v[140:143], a[44:47], a[80:83], v[140:143]
buffer_load_dwordx4 v3, s[12:15], s38 offen offset:3072 nt lds
s_add_u32 m0, s40, 16384
v_mfma_f32_16x16x32_bf16 v[144:147], a[32:35], a[88:91], v[144:147]
s_add_u32 s38, s38, 16384
v_mfma_f32_16x16x32_bf16 v[144:147], a[48:51], a[92:95], v[144:147]
v_mfma_f32_16x16x32_bf16 v[148:151], a[52:55], a[92:95], v[148:151]
ds_read_b128 a[112:115], v10 offset:12288
v_mfma_f32_16x16x32_bf16 v[148:151], a[36:39], a[88:91], v[148:151]
ds_read_b128 a[116:119], v11 offset:12288
v_mfma_f32_16x16x32_bf16 v[152:155], a[40:43], a[88:91], v[152:155]
buffer_load_dwordx4 v2, s[12:15], s38 offen offset:0 nt lds
v_mfma_f32_16x16x32_bf16 v[152:155], a[56:59], a[92:95], v[152:155]
v_mfma_f32_16x16x32_bf16 v[156:159], a[60:63], a[92:95], v[156:159]
s_waitcnt lgkmcnt(2)
v_mfma_f32_16x16x32_bf16 v[156:159], a[44:47], a[88:91], v[156:159]
buffer_load_dwordx4 v3, s[12:15], s38 offen offset:1024 nt lds
v_mfma_f32_16x16x32_bf16 v[160:163], a[32:35], a[96:99], v[160:163]
v_mfma_f32_16x16x32_bf16 v[160:163], a[48:51], a[100:103], v[160:163]
v_mfma_f32_16x16x32_bf16 v[164:167], a[52:55], a[100:103], v[164:167]
ds_read_b128 a[120:123], v10 offset:14336
v_mfma_f32_16x16x32_bf16 v[164:167], a[36:39], a[96:99], v[164:167]
ds_read_b128 a[124:127], v11 offset:14336
v_mfma_f32_16x16x32_bf16 v[168:171], a[40:43], a[96:99], v[168:171]
buffer_load_dwordx4 v2, s[12:15], s38 offen offset:2048 nt lds
s_waitcnt vmcnt(20)
v_mfma_f32_16x16x32_bf16 v[168:171], a[56:59], a[100:103], v[168:171]
v_mfma_f32_16x16x32_bf16 v[172:175], a[60:63], a[100:103], v[172:175]
ds_read_b64_tr_b16 a[0:1], v12 offset:0
v_mfma_f32_16x16x32_bf16 v[172:175], a[44:47], a[96:99], v[172:175]
ds_read_b64_tr_b16 a[2:3], v12 offset:2048
v_mfma_f32_16x16x32_bf16 v[176:179], a[32:35], a[104:107], v[176:179]
ds_read_b64_tr_b16 a[16:17], v12 offset:16384
v_mfma_f32_16x16x32_bf16 v[176:179], a[48:51], a[108:111], v[176:179]
ds_read_b64_tr_b16 a[18:19], v12 offset:18432
v_mfma_f32_16x16x32_bf16 v[180:183], a[52:55], a[108:111], v[180:183]
ds_read_b128 a[128:131], v10 offset:16384
v_mfma_f32_16x16x32_bf16 v[180:183], a[36:39], a[104:107], v[180:183]
ds_read_b128 a[132:135], v11 offset:16384
v_mfma_f32_16x16x32_bf16 v[184:187], a[40:43], a[104:107], v[184:187]
ds_read_b64_tr_b16 a[4:5], v13 offset:0
v_mfma_f32_16x16x32_bf16 v[184:187], a[56:59], a[108:111], v[184:187]
ds_read_b64_tr_b16 a[6:7], v13 offset:2048
v_mfma_f32_16x16x32_bf16 v[188:191], a[60:63], a[108:111], v[188:191]
ds_read_b64_tr_b16 a[20:21], v13 offset:16384
v_mfma_f32_16x16x32_bf16 v[188:191], a[44:47], a[104:107], v[188:191]
ds_read_b64_tr_b16 a[22:23], v13 offset:18432
s_waitcnt lgkmcnt(7)
v_mfma_f32_16x16x32_bf16 v[192:195], a[32:35], a[112:115], v[192:195]
ds_read_b64_tr_b16 a[8:9], v14 offset:0
v_mfma_f32_16x16x32_bf16 v[192:195], a[48:51], a[116:119], v[192:195]
ds_read_b64_tr_b16 a[10:11], v14 offset:2048
v_mfma_f32_16x16x32_bf16 v[196:199], a[52:55], a[116:119], v[196:199]
ds_read_b128 a[136:139], v10 offset:18432
v_add_u32 v10, s63, v10
v_mfma_f32_16x16x32_bf16 v[196:199], a[36:39], a[112:115], v[196:199]
ds_read_b128 a[140:143], v11 offset:18432
v_add_u32 v11, s63, v11
v_mfma_f32_16x16x32_bf16 v[200:203], a[40:43], a[112:115], v[200:203]
ds_read_b64_tr_b16 a[24:25], v14 offset:16384
v_mfma_f32_16x16x32_bf16 v[200:203], a[56:59], a[116:119], v[200:203]
ds_read_b64_tr_b16 a[26:27], v14 offset:18432
v_mfma_f32_16x16x32_bf16 v[204:207], a[60:63], a[116:119], v[204:207]
ds_read_b64_tr_b16 a[12:13], v15 offset:0
v_mfma_f32_16x16x32_bf16 v[204:207], a[44:47], a[112:115], v[204:207]
ds_read_b64_tr_b16 a[14:15], v15 offset:2048
v_mfma_f32_16x16x32_bf16 v[208:211], a[32:35], a[120:123], v[208:211]
ds_read_b64_tr_b16 a[28:29], v15 offset:16384
v_mfma_f32_16x16x32_bf16 v[208:211], a[48:51], a[124:127], v[208:211]
ds_read_b64_tr_b16 a[30:31], v15 offset:18432
v_mfma_f32_16x16x32_bf16 v[212:215], a[52:55], a[124:127], v[212:215]
buffer_load_dwordx4 v3, s[12:15], s38 offen offset:3072 nt lds
s_add_u32 s38, s38, 16384
v_mfma_f32_16x16x32_bf16 v[212:215], a[36:39], a[120:123], v[212:215]
s_add_u32 s40, s40, 32768
s_cmp_eq_u32 s40, s41
s_cselect_b32 s40, s42, s40
v_mfma_f32_16x16x32_bf16 v[216:219], a[40:43], a[120:123], v[216:219]
s_waitcnt vmcnt(16) lgkmcnt(6)
s_barrier
v_mfma_f32_16x16x32_bf16 v[216:219], a[56:59], a[124:127], v[216:219]
ds_read_b128 a[64:67], v10 offset:0
v_mfma_f32_16x16x32_bf16 v[220:223], a[60:63], a[124:127], v[220:223]
ds_read_b128 a[68:71], v11 offset:0
v_mfma_f32_16x16x32_bf16 v[220:223], a[44:47], a[120:123], v[220:223]
ds_read_b128 a[72:75], v10 offset:2048
v_mfma_f32_16x16x32_bf16 v[224:227], a[32:35], a[128:131], v[224:227]
ds_read_b128 a[76:79], v11 offset:2048
v_mfma_f32_16x16x32_bf16 v[224:227], a[48:51], a[132:135], v[224:227]
ds_read_b128 a[80:83], v10 offset:4096
v_mfma_f32_16x16x32_bf16 v[228:231], a[52:55], a[132:135], v[228:231]
ds_read_b128 a[84:87], v11 offset:4096
v_mfma_f32_16x16x32_bf16 v[228:231], a[36:39], a[128:131], v[228:231]
ds_read_b128 a[88:91], v10 offset:6144
v_mfma_f32_16x16x32_bf16 v[232:235], a[40:43], a[128:131], v[232:235]
ds_read_b128 a[92:95], v11 offset:6144
v_mfma_f32_16x16x32_bf16 v[232:235], a[56:59], a[132:135], v[232:235]
ds_read_b128 a[96:99], v10 offset:8192
v_mfma_f32_16x16x32_bf16 v[236:239], a[60:63], a[132:135], v[236:239]
ds_read_b128 a[100:103], v11 offset:8192
v_mfma_f32_16x16x32_bf16 v[236:239], a[44:47], a[128:131], v[236:239]
ds_read_b128 a[104:107], v10 offset:10240
v_mfma_f32_16x16x32_bf16 v[240:243], a[32:35], a[136:139], v[240:243]
ds_read_b128 a[108:111], v11 offset:10240
v_mfma_f32_16x16x32_bf16 v[240:243], a[48:51], a[140:143], v[240:243]
ds_read_b128 a[112:115], v10 offset:12288
v_mfma_f32_16x16x32_bf16 v[244:247], a[52:55], a[140:143], v[244:247]
ds_read_b128 a[116:119], v11 offset:12288
v_mfma_f32_16x16x32_bf16 v[244:247], a[36:39], a[136:139], v[244:247]
buffer_store_byte v22, v21, s[4:7], s83 offen sc0 sc1
v_mfma_f32_16x16x32_bf16 v[248:251], a[40:43], a[136:139], v[248:251]
ds_read_b128 a[120:123], v10 offset:14336
v_mfma_f32_16x16x32_bf16 v[248:251], a[56:59], a[140:143], v[248:251]
ds_read_b128 a[124:127], v11 offset:14336
v_mfma_f32_16x16x32_bf16 v[252:255], a[60:63], a[140:143], v[252:255]
buffer_load_dword v6, v21, s[16:19], s39 offen offset:0
v_mfma_f32_16x16x32_bf16 v[252:255], a[44:47], a[136:139], v[252:255]
s_waitcnt lgkmcnt(4)
v_mfma_f32_16x16x32_bf16 v[96:99], a[0:3], a[64:67], v[96:99]
buffer_load_dword v6, v21, s[24:27], s47 offen offset:0
s_mov_b32 s52, 0x3db8aa3b
s_mov_b32 s53, 0x3db8aa3b
v_mfma_f32_16x16x32_bf16 v[96:99], a[16:19], a[68:71], v[96:99]
v_mfma_f32_16x16x32_bf16 v[100:103], a[20:23], a[68:71], v[100:103]
v_mfma_f32_16x16x32_bf16 v[100:103], a[4:7], a[64:67], v[100:103]
v_mfma_f32_16x16x32_bf16 v[104:107], a[8:11], a[64:67], v[104:107]
ds_read_b128 a[128:131], v10 offset:16384
v_mfma_f32_16x16x32_bf16 v[104:107], a[24:27], a[68:71], v[104:107]
ds_read_b128 a[132:135], v11 offset:16384
v_mfma_f32_16x16x32_bf16 v[108:111], a[28:31], a[68:71], v[108:111]
s_nop 0
v_mul_f32 v96, s53, v96
v_mul_f32 v97, s53, v97
v_mfma_f32_16x16x32_bf16 v[108:111], a[12:15], a[64:67], v[108:111]
v_mul_f32 v98, s53, v98
v_mul_f32 v99, s53, v99
v_mfma_f32_16x16x32_bf16 v[112:115], a[0:3], a[72:75], v[112:115]
v_cvt_pk_bf16_f32 v96, v96, v97
v_cvt_pk_bf16_f32 v97, v98, v99
v_mfma_f32_16x16x32_bf16 v[112:115], a[16:19], a[76:79], v[112:115]
v_mul_f32 v100, s53, v100
v_mul_f32 v101, s53, v101
v_mfma_f32_16x16x32_bf16 v[116:119], a[20:23], a[76:79], v[116:119]
v_mul_f32 v102, s53, v102
v_mul_f32 v103, s53, v103
v_mfma_f32_16x16x32_bf16 v[116:119], a[4:7], a[72:75], v[116:119]
v_cvt_pk_bf16_f32 v100, v100, v101
v_cvt_pk_bf16_f32 v101, v102, v103
v_mfma_f32_16x16x32_bf16 v[120:123], a[8:11], a[72:75], v[120:123]
ds_read_b128 a[136:139], v10 offset:18432
v_mul_f32 v104, s53, v104
v_mfma_f32_16x16x32_bf16 v[120:123], a[24:27], a[76:79], v[120:123]
ds_read_b128 a[140:143], v11 offset:18432
v_mul_f32 v105, s53, v105
v_mfma_f32_16x16x32_bf16 v[124:127], a[28:31], a[76:79], v[124:127]
v_mul_f32 v106, s53, v106
v_mul_f32 v107, s53, v107
v_mfma_f32_16x16x32_bf16 v[124:127], a[12:15], a[72:75], v[124:127]
v_cvt_pk_bf16_f32 v104, v104, v105
v_cvt_pk_bf16_f32 v105, v106, v107
v_mfma_f32_16x16x32_bf16 v[128:131], a[0:3], a[80:83], v[128:131]
v_mul_f32 v108, s53, v108
v_mul_f32 v109, s53, v109
v_mfma_f32_16x16x32_bf16 v[128:131], a[16:19], a[84:87], v[128:131]
s_waitcnt lgkmcnt(0)
s_barrier
v_mul_f32 v110, s53, v110
v_mfma_f32_16x16x32_bf16 v[132:135], a[20:23], a[84:87], v[132:135]
ds_write_b64 v19, v[96:97] offset:0
v_mul_f32 v111, s53, v111
v_mfma_f32_16x16x32_bf16 v[132:135], a[4:7], a[80:83], v[132:135]
ds_write_b64 v19, v[100:101] offset:512
v_cvt_pk_bf16_f32 v108, v108, v109
v_mfma_f32_16x16x32_bf16 v[136:139], a[8:11], a[80:83], v[136:139]
ds_write_b64 v19, v[104:105] offset:1024
v_cvt_pk_bf16_f32 v109, v110, v111
v_mfma_f32_16x16x32_bf16 v[136:139], a[24:27], a[84:87], v[136:139]
ds_write_b64 v19, v[108:109] offset:1536
v_mul_f32 v112, s53, v112
v_mfma_f32_16x16x32_bf16 v[140:143], a[28:31], a[84:87], v[140:143]
v_mul_f32 v113, s53, v113
v_mul_f32 v114, s53, v114
v_mfma_f32_16x16x32_bf16 v[140:143], a[12:15], a[80:83], v[140:143]
v_mul_f32 v115, s53, v115
v_cvt_pk_bf16_f32 v112, v112, v113
v_mfma_f32_16x16x32_bf16 v[144:147], a[0:3], a[88:91], v[144:147]
v_cvt_pk_bf16_f32 v113, v114, v115
v_mul_f32 v116, s53, v116
v_mfma_f32_16x16x32_bf16 v[144:147], a[16:19], a[92:95], v[144:147]
ds_write_b64 v19, v[112:113] offset:8192
v_mul_f32 v117, s53, v117
v_mfma_f32_16x16x32_bf16 v[148:151], a[20:23], a[92:95], v[148:151]
v_mul_f32 v118, s53, v118
v_mul_f32 v119, s53, v119
v_mfma_f32_16x16x32_bf16 v[148:151], a[4:7], a[88:91], v[148:151]
v_cvt_pk_bf16_f32 v116, v116, v117
v_cvt_pk_bf16_f32 v117, v118, v119
v_mfma_f32_16x16x32_bf16 v[152:155], a[8:11], a[88:91], v[152:155]
ds_write_b64 v19, v[116:117] offset:8704
v_mul_f32 v120, s53, v120
v_mfma_f32_16x16x32_bf16 v[152:155], a[24:27], a[92:95], v[152:155]
v_mul_f32 v121, s53, v121
v_mul_f32 v122, s53, v122
v_mfma_f32_16x16x32_bf16 v[156:159], a[28:31], a[92:95], v[156:159]
v_mul_f32 v123, s53, v123
v_cvt_pk_bf16_f32 v120, v120, v121
v_mfma_f32_16x16x32_bf16 v[156:159], a[12:15], a[88:91], v[156:159]
v_cvt_pk_bf16_f32 v121, v122, v123
v_mul_f32 v124, s53, v124
v_mfma_f32_16x16x32_bf16 v[160:163], a[0:3], a[96:99], v[160:163]
ds_write_b64 v19, v[120:121] offset:9216
v_mul_f32 v125, s53, v125
v_mfma_f32_16x16x32_bf16 v[160:163], a[16:19], a[100:103], v[160:163]
v_mul_f32 v126, s53, v126
v_mul_f32 v127, s53, v127
v_mfma_f32_16x16x32_bf16 v[164:167], a[20:23], a[100:103], v[164:167]
v_cvt_pk_bf16_f32 v124, v124, v125
v_cvt_pk_bf16_f32 v125, v126, v127
v_mfma_f32_16x16x32_bf16 v[164:167], a[4:7], a[96:99], v[164:167]
ds_write_b64 v19, v[124:125] offset:9728
v_mul_f32 v128, s53, v128
v_mfma_f32_16x16x32_bf16 v[168:171], a[8:11], a[96:99], v[168:171]
v_mul_f32 v129, s53, v129
v_mul_f32 v130, s53, v130
v_mfma_f32_16x16x32_bf16 v[168:171], a[24:27], a[100:103], v[168:171]
v_mul_f32 v131, s53, v131
v_cvt_pk_bf16_f32 v128, v128, v129
v_mfma_f32_16x16x32_bf16 v[172:175], a[28:31], a[100:103], v[172:175]
v_cvt_pk_bf16_f32 v129, v130, v131
v_mul_f32 v132, s53, v132
v_mfma_f32_16x16x32_bf16 v[172:175], a[12:15], a[96:99], v[172:175]
ds_write_b64 v19, v[128:129] offset:16384
v_mul_f32 v133, s53, v133
v_mfma_f32_16x16x32_bf16 v[176:179], a[0:3], a[104:107], v[176:179]
v_mul_f32 v134, s53, v134
v_mul_f32 v135, s53, v135
v_mfma_f32_16x16x32_bf16 v[176:179], a[16:19], a[108:111], v[176:179]
v_cvt_pk_bf16_f32 v132, v132, v133
v_cvt_pk_bf16_f32 v133, v134, v135
v_mfma_f32_16x16x32_bf16 v[180:183], a[20:23], a[108:111], v[180:183]
ds_write_b64 v19, v[132:133] offset:16896
v_mul_f32 v136, s53, v136
v_mfma_f32_16x16x32_bf16 v[180:183], a[4:7], a[104:107], v[180:183]
v_mul_f32 v137, s53, v137
v_mul_f32 v138, s53, v138
v_mfma_f32_16x16x32_bf16 v[184:187], a[8:11], a[104:107], v[184:187]
v_mul_f32 v139, s53, v139
v_cvt_pk_bf16_f32 v136, v136, v137
v_mfma_f32_16x16x32_bf16 v[184:187], a[24:27], a[108:111], v[184:187]
v_cvt_pk_bf16_f32 v137, v138, v139
v_mul_f32 v140, s53, v140
v_mfma_f32_16x16x32_bf16 v[188:191], a[28:31], a[108:111], v[188:191]
ds_write_b64 v19, v[136:137] offset:17408
v_mul_f32 v141, s53, v141
v_mfma_f32_16x16x32_bf16 v[188:191], a[12:15], a[104:107], v[188:191]
v_mul_f32 v142, s53, v142
v_mul_f32 v143, s53, v143
v_mfma_f32_16x16x32_bf16 v[192:195], a[0:3], a[112:115], v[192:195]
v_cvt_pk_bf16_f32 v140, v140, v141
v_cvt_pk_bf16_f32 v141, v142, v143
v_mfma_f32_16x16x32_bf16 v[192:195], a[16:19], a[116:119], v[192:195]
ds_write_b64 v19, v[140:141] offset:17920
v_mul_f32 v144, s53, v144
v_mfma_f32_16x16x32_bf16 v[196:199], a[20:23], a[116:119], v[196:199]
v_mul_f32 v145, s53, v145
v_mul_f32 v146, s53, v146
v_mfma_f32_16x16x32_bf16 v[196:199], a[4:7], a[112:115], v[196:199]
v_mul_f32 v147, s53, v147
v_cvt_pk_bf16_f32 v144, v144, v145
v_mfma_f32_16x16x32_bf16 v[200:203], a[8:11], a[112:115], v[200:203]
v_cvt_pk_bf16_f32 v145, v146, v147
v_mul_f32 v148, s53, v148
v_mfma_f32_16x16x32_bf16 v[200:203], a[24:27], a[116:119], v[200:203]
ds_write_b64 v19, v[144:145] offset:24576
v_mul_f32 v149, s53, v149
v_mfma_f32_16x16x32_bf16 v[204:207], a[28:31], a[116:119], v[204:207]
v_mul_f32 v150, s53, v150
v_mul_f32 v151, s53, v151
v_mfma_f32_16x16x32_bf16 v[204:207], a[12:15], a[112:115], v[204:207]
v_cvt_pk_bf16_f32 v148, v148, v149
v_cvt_pk_bf16_f32 v149, v150, v151
v_mfma_f32_16x16x32_bf16 v[208:211], a[0:3], a[120:123], v[208:211]
ds_write_b64 v19, v[148:149] offset:25088
v_mul_f32 v152, s53, v152
v_mfma_f32_16x16x32_bf16 v[208:211], a[16:19], a[124:127], v[208:211]
v_mul_f32 v153, s53, v153
v_mul_f32 v154, s53, v154
v_mfma_f32_16x16x32_bf16 v[212:215], a[20:23], a[124:127], v[212:215]
v_mul_f32 v155, s53, v155
v_cvt_pk_bf16_f32 v152, v152, v153
v_mfma_f32_16x16x32_bf16 v[212:215], a[4:7], a[120:123], v[212:215]
v_cvt_pk_bf16_f32 v153, v154, v155
v_mul_f32 v156, s53, v156
v_mfma_f32_16x16x32_bf16 v[216:219], a[8:11], a[120:123], v[216:219]
ds_write_b64 v19, v[152:153] offset:25600
v_mul_f32 v157, s53, v157
v_mfma_f32_16x16x32_bf16 v[216:219], a[24:27], a[124:127], v[216:219]
v_mul_f32 v158, s53, v158
v_mul_f32 v159, s53, v159
v_mfma_f32_16x16x32_bf16 v[220:223], a[28:31], a[124:127], v[220:223]
v_cvt_pk_bf16_f32 v156, v156, v157
v_cvt_pk_bf16_f32 v157, v158, v159
v_mfma_f32_16x16x32_bf16 v[220:223], a[12:15], a[120:123], v[220:223]
ds_write_b64 v19, v[156:157] offset:26112
v_pk_mul_f32 v[160:161], v[160:161], s[52:53]
v_mfma_f32_16x16x32_bf16 v[224:227], a[0:3], a[128:131], v[224:227]
v_pk_mul_f32 v[162:163], v[162:163], s[52:53]
v_cvt_pk_bf16_f32 v160, v160, v161
v_mfma_f32_16x16x32_bf16 v[224:227], a[16:19], a[132:135], v[224:227]
v_cvt_pk_bf16_f32 v161, v162, v163
v_pk_mul_f32 v[164:165], v[164:165], s[52:53]
v_mfma_f32_16x16x32_bf16 v[228:231], a[20:23], a[132:135], v[228:231]
ds_write_b64 v19, v[160:161] offset:32768
v_pk_mul_f32 v[166:167], v[166:167], s[52:53]
v_mfma_f32_16x16x32_bf16 v[228:231], a[4:7], a[128:131], v[228:231]
v_cvt_pk_bf16_f32 v164, v164, v165
v_cvt_pk_bf16_f32 v165, v166, v167
v_mfma_f32_16x16x32_bf16 v[232:235], a[8:11], a[128:131], v[232:235]
ds_write_b64 v19, v[164:165] offset:33280
v_pk_mul_f32 v[168:169], v[168:169], s[52:53]
v_mfma_f32_16x16x32_bf16 v[232:235], a[24:27], a[132:135], v[232:235]
v_pk_mul_f32 v[170:171], v[170:171], s[52:53]
v_cvt_pk_bf16_f32 v168, v168, v169
v_mfma_f32_16x16x32_bf16 v[236:239], a[28:31], a[132:135], v[236:239]
v_cvt_pk_bf16_f32 v169, v170, v171
v_pk_mul_f32 v[172:173], v[172:173], s[52:53]
v_mfma_f32_16x16x32_bf16 v[236:239], a[12:15], a[128:131], v[236:239]
ds_write_b64 v19, v[168:169] offset:33792
v_pk_mul_f32 v[174:175], v[174:175], s[52:53]
v_mfma_f32_16x16x32_bf16 v[240:243], a[0:3], a[136:139], v[240:243]
v_cvt_pk_bf16_f32 v172, v172, v173
v_cvt_pk_bf16_f32 v173, v174, v175
v_mfma_f32_16x16x32_bf16 v[240:243], a[16:19], a[140:143], v[240:243]
ds_write_b64 v19, v[172:173] offset:34304
v_pk_mul_f32 v[176:177], v[176:177], s[52:53]
v_mfma_f32_16x16x32_bf16 v[244:247], a[20:23], a[140:143], v[244:247]
v_pk_mul_f32 v[178:179], v[178:179], s[52:53]
v_cvt_pk_bf16_f32 v176, v176, v177
v_mfma_f32_16x16x32_bf16 v[244:247], a[4:7], a[136:139], v[244:247]
v_cvt_pk_bf16_f32 v177, v178, v179
v_pk_mul_f32 v[180:181], v[180:181], s[52:53]
v_mfma_f32_16x16x32_bf16 v[248:251], a[8:11], a[136:139], v[248:251]
ds_write_b64 v19, v[176:177] offset:40960
v_pk_mul_f32 v[182:183], v[182:183], s[52:53]
v_mfma_f32_16x16x32_bf16 v[248:251], a[24:27], a[140:143], v[248:251]
v_cvt_pk_bf16_f32 v180, v180, v181
v_cvt_pk_bf16_f32 v181, v182, v183
v_mfma_f32_16x16x32_bf16 v[252:255], a[28:31], a[140:143], v[252:255]
ds_write_b64 v19, v[180:181] offset:41472
v_pk_mul_f32 v[184:185], v[184:185], s[52:53]
v_mfma_f32_16x16x32_bf16 v[252:255], a[12:15], a[136:139], v[252:255]
v_pk_mul_f32 v[186:187], v[186:187], s[52:53]
v_cvt_pk_bf16_f32 v184, v184, v185
v_cvt_pk_bf16_f32 v185, v186, v187
ds_write_b64 v19, v[184:185] offset:41984
v_pk_mul_f32 v[188:189], v[188:189], s[52:53]
v_pk_mul_f32 v[190:191], v[190:191], s[52:53]
v_cvt_pk_bf16_f32 v188, v188, v189
v_cvt_pk_bf16_f32 v189, v190, v191
ds_write_b64 v19, v[188:189] offset:42496
v_pk_mul_f32 v[192:193], v[192:193], s[52:53]
v_pk_mul_f32 v[194:195], v[194:195], s[52:53]
v_cvt_pk_bf16_f32 v192, v192, v193
v_cvt_pk_bf16_f32 v193, v194, v195
ds_write_b64 v19, v[192:193] offset:49152
v_pk_mul_f32 v[196:197], v[196:197], s[52:53]
v_pk_mul_f32 v[198:199], v[198:199], s[52:53]
v_cvt_pk_bf16_f32 v196, v196, v197
v_cvt_pk_bf16_f32 v197, v198, v199
ds_write_b64 v19, v[196:197] offset:49664
v_pk_mul_f32 v[200:201], v[200:201], s[52:53]
v_pk_mul_f32 v[202:203], v[202:203], s[52:53]
v_cvt_pk_bf16_f32 v200, v200, v201
v_cvt_pk_bf16_f32 v201, v202, v203
ds_write_b64 v19, v[200:201] offset:50176
v_pk_mul_f32 v[204:205], v[204:205], s[52:53]
v_pk_mul_f32 v[206:207], v[206:207], s[52:53]
v_cvt_pk_bf16_f32 v204, v204, v205
v_cvt_pk_bf16_f32 v205, v206, v207
ds_write_b64 v19, v[204:205] offset:50688
v_pk_mul_f32 v[208:209], v[208:209], s[52:53]
v_pk_mul_f32 v[210:211], v[210:211], s[52:53]
v_cvt_pk_bf16_f32 v208, v208, v209
v_cvt_pk_bf16_f32 v209, v210, v211
ds_write_b64 v19, v[208:209] offset:57344
v_pk_mul_f32 v[212:213], v[212:213], s[52:53]
v_pk_mul_f32 v[214:215], v[214:215], s[52:53]
v_cvt_pk_bf16_f32 v212, v212, v213
v_cvt_pk_bf16_f32 v213, v214, v215
ds_write_b64 v19, v[212:213] offset:57856
v_pk_mul_f32 v[216:217], v[216:217], s[52:53]
v_pk_mul_f32 v[218:219], v[218:219], s[52:53]
v_cvt_pk_bf16_f32 v216, v216, v217
v_cvt_pk_bf16_f32 v217, v218, v219
ds_write_b64 v19, v[216:217] offset:58368
v_pk_mul_f32 v[220:221], v[220:221], s[52:53]
v_pk_mul_f32 v[222:223], v[222:223], s[52:53]
v_cvt_pk_bf16_f32 v220, v220, v221
v_cvt_pk_bf16_f32 v221, v222, v223
ds_write_b64 v19, v[220:221] offset:58880
v_pk_mul_f32 v[224:225], v[224:225], s[52:53]
v_pk_mul_f32 v[226:227], v[226:227], s[52:53]
v_cvt_pk_bf16_f32 v224, v224, v225
v_cvt_pk_bf16_f32 v225, v226, v227
ds_write_b64 v20, v[224:225] offset:0
v_pk_mul_f32 v[228:229], v[228:229], s[52:53]
v_pk_mul_f32 v[230:231], v[230:231], s[52:53]
v_cvt_pk_bf16_f32 v228, v228, v229
v_cvt_pk_bf16_f32 v229, v230, v231
ds_write_b64 v20, v[228:229] offset:512
v_pk_mul_f32 v[232:233], v[232:233], s[52:53]
v_pk_mul_f32 v[234:235], v[234:235], s[52:53]
v_cvt_pk_bf16_f32 v232, v232, v233
v_cvt_pk_bf16_f32 v233, v234, v235
ds_write_b64 v20, v[232:233] offset:1024
v_pk_mul_f32 v[236:237], v[236:237], s[52:53]
v_pk_mul_f32 v[238:239], v[238:239], s[52:53]
v_cvt_pk_bf16_f32 v236, v236, v237
v_cvt_pk_bf16_f32 v237, v238, v239
ds_write_b64 v20, v[236:237] offset:1536
v_pk_mul_f32 v[240:241], v[240:241], s[52:53]
v_pk_mul_f32 v[242:243], v[242:243], s[52:53]
v_cvt_pk_bf16_f32 v240, v240, v241
v_cvt_pk_bf16_f32 v241, v242, v243
ds_write_b64 v20, v[240:241] offset:8192
v_pk_mul_f32 v[244:245], v[244:245], s[52:53]
v_pk_mul_f32 v[246:247], v[246:247], s[52:53]
v_cvt_pk_bf16_f32 v244, v244, v245
v_cvt_pk_bf16_f32 v245, v246, v247
ds_write_b64 v20, v[244:245] offset:8704
v_pk_mul_f32 v[248:249], v[248:249], s[52:53]
v_pk_mul_f32 v[250:251], v[250:251], s[52:53]
v_cvt_pk_bf16_f32 v248, v248, v249
v_cvt_pk_bf16_f32 v249, v250, v251
ds_write_b64 v20, v[248:249] offset:9216
v_pk_mul_f32 v[252:253], v[252:253], s[52:53]
v_pk_mul_f32 v[254:255], v[254:255], s[52:53]
v_cvt_pk_bf16_f32 v252, v252, v253
v_cvt_pk_bf16_f32 v253, v254, v255
ds_write_b64 v20, v[252:253] offset:9728
s_lshl_b32 s50, s33, 14
s_sub_u32 s50, 114688, s50
v_add_u32 v12, s50, v24
v_add_u32 v13, s50, v25
v_add_u32 v14, s50, v26
v_add_u32 v15, s50, v27
v_lshrrev_b32 v29, 3, v1
v_mul_u32_u24 v29, 896, v29
v_and_b32 v5, 0x70, v4
v_add_u32 v5, v5, v29
s_lshl_b32 s63, s32, 13
s_waitcnt lgkmcnt(0)
v_mov_b32 v224, 0
v_mov_b32 v225, 0
v_mov_b32 v226, 0
v_mov_b32 v227, 0
v_mov_b32 v228, 0
v_mov_b32 v229, 0
v_mov_b32 v230, 0
v_mov_b32 v231, 0
v_mov_b32 v232, 0
v_mov_b32 v233, 0
v_mov_b32 v234, 0
v_mov_b32 v235, 0
v_mov_b32 v250, 0
v_mov_b32 v251, 0
v_mov_b32 v252, 0
s_waitcnt vmcnt(11)
s_barrier
ds_read_b128 v[32:35], v16 offset:0
ds_read_b128 v[36:39], v16 offset:1024
ds_read_b128 v[40:43], v16 offset:2048
ds_read_b128 v[44:47], v16 offset:3072
ds_read_b128 v[64:67], v17 offset:0
ds_read_b128 v[68:71], v17 offset:1024
ds_read_b128 v[72:75], v17 offset:2048
ds_read_b128 v[76:79], v17 offset:3072
ds_read_b128 a[192:195], v8 offset:0
ds_read_b128 a[196:199], v9 offset:0
ds_read_b128 a[200:203], v8 offset:4096
ds_read_b128 a[204:207], v9 offset:4096
s_waitcnt lgkmcnt(3)
v_mfma_f32_16x16x32_bf16 v[128:131], a[192:195], v[32:35], v[224:227]
ds_read_b128 v[80:83], v17 offset:4096
s_waitcnt lgkmcnt(3)
v_mfma_f32_16x16x32_bf16 v[128:131], a[196:199], v[36:39], v[128:131]
ds_read_b128 v[84:87], v17 offset:5120
s_waitcnt lgkmcnt(3)
v_mfma_f32_16x16x32_bf16 v[128:131], a[200:203], v[40:43], v[128:131]
ds_read_b128 a[208:211], v8 offset:8192
s_waitcnt lgkmcnt(3)
v_mfma_f32_16x16x32_bf16 v[128:131], a[204:207], v[44:47], v[128:131]
ds_read_b128 v[88:91], v17 offset:6144
v_mfma_f32_16x16x32_bf16 v[132:135], a[192:195], v[64:67], v[228:231]
ds_read_b128 a[212:215], v9 offset:8192
v_mfma_f32_16x16x32_bf16 v[132:135], a[196:199], v[68:71], v[132:135]
ds_read_b128 v[92:95], v17 offset:7168
ds_read_b128 a[216:219], v8 offset:12288
v_mfma_f32_16x16x32_bf16 v[132:135], a[200:203], v[72:75], v[132:135]
ds_read_b128 v[48:51], v16 offset:4096
ds_read_b128 v[52:55], v16 offset:5120
ds_read_b128 v[56:59], v16 offset:6144
ds_read_b128 v[60:63], v16 offset:7168
ds_read_b128 v[96:99], v18 offset:0
ds_read_b128 v[100:103], v18 offset:1024
ds_read_b128 v[104:107], v18 offset:2048
ds_read_b128 v[108:111], v18 offset:3072
ds_read_b128 v[112:115], v18 offset:4096
ds_read_b128 v[116:119], v18 offset:5120
ds_read_b128 v[120:123], v18 offset:6144
ds_read_b128 v[124:127], v18 offset:7168
ds_read_b128 a[220:223], v9 offset:12288
v_mfma_f32_16x16x32_bf16 v[132:135], a[204:207], v[76:79], v[132:135]
ds_read_b128 a[224:227], v8 offset:2048
s_waitcnt lgkmcnt(15)
v_mfma_f32_16x16x32_bf16 v[132:135], a[208:211], v[80:83], v[132:135]
ds_read_b128 a[228:231], v9 offset:2048
s_bitcmp1_b64 s[48:49], 0
s_cselect_b32 s46, s45, s44
v_mfma_f32_16x16x32_bf16 v[132:135], a[212:215], v[84:87], v[132:135]
ds_read_b128 a[232:235], v8 offset:6144
s_lshr_b64 s[48:49], s[48:49], 1
s_waitcnt lgkmcnt(15)
v_mfma_f32_16x16x32_bf16 v[132:135], a[216:219], v[88:91], v[132:135]
s_waitcnt lgkmcnt(4)
s_barrier
s_mov_b32 m0, s40
s_waitcnt lgkmcnt(3)
v_mfma_f32_16x16x32_bf16 v[132:135], a[220:223], v[92:95], v[132:135]
buffer_load_dwordx4 v4, s[16:19], s39 offen offset:0 nt lds
v_mfma_f32_16x16x32_bf16 v[128:131], a[208:211], v[48:51], v[128:131]
ds_read_b128 a[236:239], v9 offset:6144
v_mfma_f32_16x16x32_bf16 v[128:131], a[212:215], v[52:55], v[128:131]
ds_read_b128 a[240:243], v8 offset:10240
v_mfma_f32_16x16x32_bf16 v[128:131], a[216:219], v[56:59], v[128:131]
ds_read_b128 a[244:247], v9 offset:10240
v_mfma_f32_16x16x32_bf16 v[128:131], a[220:223], v[60:63], v[128:131]
ds_read_b128 a[248:251], v8 offset:14336
v_add_u32 v8, s43, v8
s_waitcnt lgkmcnt(5)
v_mfma_f32_16x16x32_bf16 v[140:143], a[224:227], v[32:35], v[224:227]
ds_read_b128 a[252:255], v9 offset:14336
v_add_u32 v9, s43, v9
v_mfma_f32_16x16x32_bf16 v[140:143], a[228:231], v[36:39], v[140:143]
buffer_load_dwordx4 v4, s[16:19], s39 offen offset:1024 nt lds
s_waitcnt lgkmcnt(5)
v_mfma_f32_16x16x32_bf16 v[140:143], a[232:235], v[40:43], v[140:143]
ds_read_b128 a[192:195], v8 offset:0
s_waitcnt lgkmcnt(5)
v_mfma_f32_16x16x32_bf16 v[140:143], a[236:239], v[44:47], v[140:143]
ds_read_b128 a[196:199], v9 offset:0
v_max3_f32 v238, v132, v133, v134
v_mfma_f32_16x16x32_bf16 v[144:147], a[224:227], v[64:67], v[228:231]
ds_read_b128 a[200:203], v8 offset:4096
v_mfma_f32_16x16x32_bf16 v[144:147], a[228:231], v[68:71], v[144:147]
ds_read_b128 a[204:207], v9 offset:4096
v_max3_f32 v236, v128, v129, v130
v_mfma_f32_16x16x32_bf16 v[144:147], a[232:235], v[72:75], v[144:147]
s_waitcnt lgkmcnt(5)
v_max_f32 v236, v236, v131
v_mov_b32 v237, v236
v_mfma_f32_16x16x32_bf16 v[144:147], a[236:239], v[76:79], v[144:147]
buffer_load_dwordx4 v4, s[16:19], s39 offen offset:2048 nt lds
v_mfma_f32_16x16x32_bf16 v[144:147], a[240:243], v[80:83], v[144:147]
v_permlane32_swap_b32 v236, v237
v_max_f32 v236, v236, v237
v_mfma_f32_16x16x32_bf16 v[144:147], a[244:247], v[84:87], v[144:147]
v_mov_b32 v237, v236
v_max_f32 v238, v238, v135
v_mfma_f32_16x16x32_bf16 v[144:147], a[248:251], v[88:91], v[144:147]
s_waitcnt lgkmcnt(2)
v_permlane16_swap_b32 v236, v237
v_max_f32 v236, v236, v237
v_mfma_f32_16x16x32_bf16 v[144:147], a[252:255], v[92:95], v[144:147]
v_ceil_f32 v236, v236
v_sub_f32 v224, 0, v236
v_mfma_f32_16x16x32_bf16 v[140:143], a[240:243], v[48:51], v[140:143]
s_waitcnt lgkmcnt(0)
v_sub_f32 v225, 0, v236
v_sub_f32 v226, 0, v236
v_mfma_f32_16x16x32_bf16 v[140:143], a[244:247], v[52:55], v[140:143]
buffer_load_dwordx4 v4, s[16:19], s39 offen offset:3072 nt lds
v_sub_f32 v227, 0, v236
v_mfma_f32_16x16x32_bf16 v[140:143], a[248:251], v[56:59], v[140:143]
ds_read_b128 a[208:211], v8 offset:8192
v_mov_b32 v239, v238
v_mfma_f32_16x16x32_bf16 v[140:143], a[252:255], v[60:63], v[140:143]
ds_read_b128 a[212:215], v9 offset:8192
v_permlane32_swap_b32 v238, v239
v_mfma_f32_16x16x32_bf16 v[152:155], a[192:195], v[32:35], v[224:227]
ds_read_b128 a[216:219], v8 offset:12288
v_max_f32 v238, v238, v239
v_mov_b32 v239, v238
v_mfma_f32_16x16x32_bf16 v[152:155], a[196:199], v[36:39], v[152:155]
ds_read_b128 a[220:223], v9 offset:12288
v_permlane16_swap_b32 v238, v239
v_max_f32 v238, v238, v239
v_ceil_f32 v238, v238
v_sub_f32 v228, 0, v238
v_sub_f32 v229, 0, v238
v_sub_f32 v230, 0, v238
v_sub_f32 v231, 0, v238
v_mfma_f32_16x16x32_bf16 v[152:155], a[200:203], v[40:43], v[152:155]
s_add_u32 m0, s40, 16384
v_sub_f32 v128, v128, v236
v_sub_f32 v129, v129, v236
s_add_u32 s39, s39, 16384
v_mfma_f32_16x16x32_bf16 v[152:155], a[204:207], v[44:47], v[152:155]
buffer_load_dwordx4 v4, s[16:19], s39 offen offset:0 nt lds
v_mfma_f32_16x16x32_bf16 v[156:159], a[192:195], v[64:67], v[228:231]
v_exp_f32 v237, v129
v_mfma_f32_16x16x32_bf16 v[156:159], a[196:199], v[68:71], v[156:159]
v_sub_f32 v132, v132, v238
v_sub_f32 v133, v133, v238
v_mfma_f32_16x16x32_bf16 v[156:159], a[200:203], v[72:75], v[156:159]
v_exp_f32 v240, v132
v_mfma_f32_16x16x32_bf16 v[156:159], a[204:207], v[76:79], v[156:159]
s_waitcnt lgkmcnt(1)
v_exp_f32 v241, v133
v_mfma_f32_16x16x32_bf16 v[160:163], a[192:195], v[96:99], v[232:235]
s_bitcmp1_b64 s[48:49], 0
s_cselect_b32 s46, s45, s44
v_sub_f32 v130, v130, v236
v_sub_f32 v131, v131, v236
v_mfma_f32_16x16x32_bf16 v[160:163], a[196:199], v[100:103], v[160:163]
buffer_load_dwordx4 v4, s[16:19], s39 offen offset:1024 nt lds
v_mfma_f32_16x16x32_bf16 v[160:163], a[200:203], v[104:107], v[160:163]
ds_read_b128 a[224:227], v8 offset:2048
v_sub_f32 v140, v140, v236
v_mfma_f32_16x16x32_bf16 v[160:163], a[204:207], v[108:111], v[160:163]
ds_read_b128 a[228:231], v9 offset:2048
v_sub_f32 v141, v141, v236
v_mfma_f32_16x16x32_bf16 v[160:163], a[208:211], v[112:115], v[160:163]
ds_read_b128 a[232:235], v8 offset:6144
v_sub_f32 v142, v142, v236
v_mfma_f32_16x16x32_bf16 v[160:163], a[212:215], v[116:119], v[160:163]
ds_read_b128 a[236:239], v9 offset:6144
v_sub_f32 v143, v143, v236
v_mfma_f32_16x16x32_bf16 v[160:163], a[216:219], v[120:123], v[160:163]
s_lshr_b64 s[48:49], s[48:49], 1
v_exp_f32 v236, v128
s_waitcnt lgkmcnt(4)
v_mfma_f32_16x16x32_bf16 v[160:163], a[220:223], v[124:127], v[160:163]
buffer_load_dwordx4 v4, s[16:19], s39 offen offset:2048 nt lds
v_mfma_f32_16x16x32_bf16 v[156:159], a[208:211], v[80:83], v[156:159]
v_exp_f32 v239, v131
v_mfma_f32_16x16x32_bf16 v[156:159], a[212:215], v[84:87], v[156:159]
v_sub_f32 v134, v134, v238
v_sub_f32 v135, v135, v238
v_mfma_f32_16x16x32_bf16 v[156:159], a[216:219], v[88:91], v[156:159]
v_exp_f32 v242, v134
v_mfma_f32_16x16x32_bf16 v[156:159], a[220:223], v[92:95], v[156:159]
v_exp_f32 v243, v135
v_mfma_f32_16x16x32_bf16 v[152:155], a[208:211], v[48:51], v[152:155]
s_waitcnt lgkmcnt(0)
v_sub_f32 v144, v144, v238
v_sub_f32 v145, v145, v238
v_mfma_f32_16x16x32_bf16 v[152:155], a[212:215], v[52:55], v[152:155]
buffer_load_dwordx4 v4, s[16:19], s39 offen offset:3072 nt lds
s_add_u32 s39, s39, 16384
s_add_u32 s40, s40, 32768
s_cmp_eq_u32 s40, s41
s_cselect_b32 s40, s42, s40
s_mov_b32 m0, s40
v_mfma_f32_16x16x32_bf16 v[152:155], a[216:219], v[56:59], v[152:155]
buffer_load_dwordx4 v2, s[12:15], s38 offen offset:0 nt lds
v_mfma_f32_16x16x32_bf16 v[152:155], a[220:223], v[60:63], v[152:155]
ds_read_b128 a[240:243], v8 offset:10240
v_sub_f32 v146, v146, v238
v_mfma_f32_16x16x32_bf16 v[164:167], a[224:227], v[32:35], v[224:227]
ds_read_b128 a[244:247], v9 offset:10240
v_sub_f32 v147, v147, v238
v_mfma_f32_16x16x32_bf16 v[164:167], a[228:231], v[36:39], v[164:167]
ds_read_b128 a[248:251], v8 offset:14336
v_add_f32 v244, v236, v237
v_mfma_f32_16x16x32_bf16 v[164:167], a[232:235], v[40:43], v[164:167]
ds_read_b128 a[252:255], v9 offset:14336
v_add_f32 v245, v240, v241
v_mfma_f32_16x16x32_bf16 v[164:167], a[236:239], v[44:47], v[164:167]
v_exp_f32 v238, v130
v_mfma_f32_16x16x32_bf16 v[168:171], a[224:227], v[64:67], v[228:231]
buffer_load_dwordx4 v3, s[12:15], s38 offen offset:1024 nt lds
v_mfma_f32_16x16x32_bf16 v[168:171], a[228:231], v[68:71], v[168:171]
v_add_f32 v244, v238, v244
v_add_f32 v245, v242, v245
v_mfma_f32_16x16x32_bf16 v[168:171], a[232:235], v[72:75], v[168:171]
v_cvt_pk_bf16_f32 v176, v236, v237
v_add_f32 v244, v239, v244
v_mfma_f32_16x16x32_bf16 v[168:171], a[236:239], v[76:79], v[168:171]
v_exp_f32 v236, v140
v_mfma_f32_16x16x32_bf16 v[172:175], a[224:227], v[96:99], v[232:235]
v_exp_f32 v237, v141
v_mfma_f32_16x16x32_bf16 v[172:175], a[228:231], v[100:103], v[172:175]
v_cvt_pk_bf16_f32 v180, v240, v241
v_add_f32 v245, v243, v245
v_mfma_f32_16x16x32_bf16 v[172:175], a[232:235], v[104:107], v[172:175]
buffer_load_dwordx4 v2, s[12:15], s38 offen offset:2048 nt lds
v_mfma_f32_16x16x32_bf16 v[172:175], a[236:239], v[108:111], v[172:175]
s_waitcnt lgkmcnt(0)
v_exp_f32 v240, v144
v_mfma_f32_16x16x32_bf16 v[172:175], a[240:243], v[112:115], v[172:175]
v_exp_f32 v241, v145
v_mfma_f32_16x16x32_bf16 v[172:175], a[244:247], v[116:119], v[172:175]
s_waitcnt vmcnt(14)
s_barrier
v_add_f32 v244, v236, v244
v_mfma_f32_16x16x32_bf16 v[172:175], a[248:251], v[120:123], v[172:175]
v_add_f32 v245, v240, v245
v_add_u32 v8, s46, v8
v_mfma_f32_16x16x32_bf16 v[172:175], a[252:255], v[124:127], v[172:175]
ds_read_b128 a[192:195], v8 offset:0
v_cvt_pk_bf16_f32 v177, v238, v239
v_mfma_f32_16x16x32_bf16 v[168:171], a[240:243], v[80:83], v[168:171]
buffer_load_dwordx4 v3, s[12:15], s38 offen offset:3072 nt lds
v_mfma_f32_16x16x32_bf16 v[168:171], a[244:247], v[84:87], v[168:171]
ds_read_b128 a[200:203], v8 offset:4096
v_cvt_pk_bf16_f32 v181, v242, v243
v_mfma_f32_16x16x32_bf16 v[168:171], a[248:251], v[88:91], v[168:171]
s_add_u32 m0, s40, 16384
v_exp_f32 v238, v142
v_add_f32 v244, v237, v244
v_add_f32 v245, v241, v245
v_exp_f32 v242, v146
v_mfma_f32_16x16x32_bf16 v[168:171], a[252:255], v[92:95], v[168:171]
s_add_u32 s38, s38, 16384
v_exp_f32 v239, v143
v_add_u32 v9, s46, v9
v_add_f32 v244, v238, v244
v_exp_f32 v243, v147
v_add_f32 v245, v242, v245
v_mfma_f32_16x16x32_bf16 v[164:167], a[240:243], v[48:51], v[164:167]
ds_read_b128 a[196:199], v9 offset:0
v_add_f32 v244, v239, v244
v_add_f32 v245, v243, v245
v_mfma_f32_16x16x32_bf16 v[164:167], a[244:247], v[52:55], v[164:167]
ds_read_b128 a[204:207], v9 offset:4096
v_max_f32 v253, v244, v245
v_mfma_f32_16x16x32_bf16 v[164:167], a[248:251], v[56:59], v[164:167]
buffer_load_dwordx4 v2, s[12:15], s38 offen offset:0 nt lds
v_cmp_lt_f32 vcc, s54, v253
v_mfma_f32_16x16x32_bf16 v[164:167], a[252:255], v[60:63], v[164:167]
ds_read_b128 a[208:211], v8 offset:8192
v_cvt_pk_bf16_f32 v178, v236, v237
v_cvt_pk_bf16_f32 v179, v238, v239
v_cvt_pk_bf16_f32 v182, v240, v241
v_cvt_pk_bf16_f32 v183, v242, v243
s_cbranch_vccnz L_slow_0
L_ret_0:
s_waitcnt lgkmcnt(4)
v_mfma_f32_16x16x32_bf16 v[128:131], a[192:195], v[32:35], v[224:227]
ds_read_b128 a[212:215], v9 offset:8192
v_add_f32 v250, v244, v250
s_waitcnt lgkmcnt(3)
v_mfma_f32_16x16x32_bf16 v[128:131], a[196:199], v[36:39], v[128:131]
ds_read_b128 a[216:219], v8 offset:12288
v_add_f32 v251, v245, v251
v_mfma_f32_16x16x32_bf16 v[128:131], a[200:203], v[40:43], v[128:131]
ds_read_b128 a[220:223], v9 offset:12288
s_waitcnt lgkmcnt(4)
v_mfma_f32_16x16x32_bf16 v[128:131], a[204:207], v[44:47], v[128:131]
ds_read_b128 a[224:227], v8 offset:2048
v_max3_f32 v236, v160, v161, v162
v_mfma_f32_16x16x32_bf16 v[132:135], a[192:195], v[64:67], v[228:231]
buffer_load_dwordx4 v3, s[12:15], s38 offen offset:1024 nt lds
v_mfma_f32_16x16x32_bf16 v[132:135], a[196:199], v[68:71], v[132:135]
ds_read_b128 a[228:231], v9 offset:2048
v_max_f32 v236, v236, v163
v_mfma_f32_16x16x32_bf16 v[132:135], a[200:203], v[72:75], v[132:135]
ds_read_b128 a[232:235], v8 offset:6144
v_mov_b32 v237, v236
v_mfma_f32_16x16x32_bf16 v[132:135], a[204:207], v[76:79], v[132:135]
ds_read_b128 a[236:239], v9 offset:6144
v_permlane32_swap_b32 v236, v237
s_waitcnt lgkmcnt(6)
v_mfma_f32_16x16x32_bf16 v[132:135], a[208:211], v[80:83], v[132:135]
s_bitcmp1_b64 s[48:49], 0
s_cselect_b32 s46, s45, s44
v_exp_f32 v238, v154
v_mfma_f32_16x16x32_bf16 v[132:135], a[212:215], v[84:87], v[132:135]
ds_read_b128 a[240:243], v8 offset:10240
v_max_f32 v236, v236, v237
s_waitcnt lgkmcnt(5)
v_mfma_f32_16x16x32_bf16 v[132:135], a[216:219], v[88:91], v[132:135]
buffer_load_dwordx4 v2, s[12:15], s38 offen offset:2048 nt lds
v_mfma_f32_16x16x32_bf16 v[132:135], a[220:223], v[92:95], v[132:135]
ds_read_b128 a[244:247], v9 offset:10240
v_mov_b32 v237, v236
v_mfma_f32_16x16x32_bf16 v[128:131], a[208:211], v[48:51], v[128:131]
ds_read_b128 a[248:251], v8 offset:14336
v_permlane16_swap_b32 v236, v237
v_mfma_f32_16x16x32_bf16 v[128:131], a[212:215], v[52:55], v[128:131]
ds_read_b128 a[252:255], v9 offset:14336
v_max_f32 v236, v236, v237
v_mfma_f32_16x16x32_bf16 v[128:131], a[216:219], v[56:59], v[128:131]
s_lshr_b64 s[48:49], s[48:49], 1
v_exp_f32 v239, v155
v_mfma_f32_16x16x32_bf16 v[128:131], a[220:223], v[60:63], v[128:131]
s_waitcnt lgkmcnt(4)
v_exp_f32 v240, v156
v_mfma_f32_16x16x32_bf16 v[140:143], a[224:227], v[32:35], v[224:227]
buffer_load_dwordx4 v3, s[12:15], s38 offen offset:3072 nt lds
s_add_u32 s38, s38, 16384
s_add_u32 s40, s40, 32768
s_cmp_eq_u32 s40, s41
s_cselect_b32 s40, s42, s40
s_mov_b32 m0, s40
v_mfma_f32_16x16x32_bf16 v[140:143], a[228:231], v[36:39], v[140:143]
buffer_load_dwordx4 v4, s[16:19], s39 offen offset:0 nt lds
v_mfma_f32_16x16x32_bf16 v[140:143], a[232:235], v[40:43], v[140:143]
v_exp_f32 v241, v157
v_mfma_f32_16x16x32_bf16 v[140:143], a[236:239], v[44:47], v[140:143]
v_exp_f32 v242, v158
v_mfma_f32_16x16x32_bf16 v[144:147], a[224:227], v[64:67], v[228:231]
s_waitcnt lgkmcnt(0)
v_exp_f32 v243, v159
v_mfma_f32_16x16x32_bf16 v[144:147], a[228:231], v[68:71], v[144:147]
s_waitcnt vmcnt(9)
s_barrier
v_ceil_f32 v236, v236
v_mfma_f32_16x16x32_bf16 v[144:147], a[232:235], v[72:75], v[144:147]
ds_read_b64_tr_b16 a[192:193], v12 offset:0
v_sub_f32 v232, 0, v236
v_mfma_f32_16x16x32_bf16 v[144:147], a[236:239], v[76:79], v[144:147]
buffer_load_dwordx4 v4, s[16:19], s39 offen offset:1024 nt lds
v_mfma_f32_16x16x32_bf16 v[144:147], a[240:243], v[80:83], v[144:147]
v_exp_f32 v237, v153
v_sub_f32 v233, 0, v236
v_sub_f32 v234, 0, v236
v_sub_f32 v235, 0, v236
v_sub_f32 v160, v160, v236
v_sub_f32 v161, v161, v236
v_sub_f32 v162, v162, v236
v_sub_f32 v163, v163, v236
v_sub_f32 v172, v172, v236
v_sub_f32 v173, v173, v236
v_sub_f32 v174, v174, v236
v_sub_f32 v175, v175, v236
v_exp_f32 v236, v152
v_mfma_f32_16x16x32_bf16 v[144:147], a[244:247], v[84:87], v[144:147]
ds_read_b64_tr_b16 a[194:195], v12 offset:2048
v_cvt_pk_bf16_f32 v188, v236, v237
v_add_f32 v247, v236, v237
v_exp_f32 v236, v160
v_exp_f32 v237, v161
v_mfma_f32_16x16x32_bf16 v[144:147], a[248:251], v[88:91], v[144:147]
ds_read_b64_tr_b16 a[196:197], v13 offset:0
v_cvt_pk_bf16_f32 v189, v238, v239
v_add_f32 v247, v238, v247
v_add_f32 v248, v240, v241
v_add_f32 v249, v236, v237
v_exp_f32 v238, v162
v_mfma_f32_16x16x32_bf16 v[144:147], a[252:255], v[92:95], v[144:147]
ds_read_b64_tr_b16 a[198:199], v13 offset:2048
v_add_f32 v247, v239, v247
v_cvt_pk_bf16_f32 v192, v240, v241
v_add_f32 v248, v242, v248
v_exp_f32 v239, v163
v_add_f32 v249, v238, v249
v_exp_f32 v240, v164
v_exp_f32 v241, v165
v_mfma_f32_16x16x32_bf16 v[140:143], a[240:243], v[48:51], v[140:143]
ds_read_b64_tr_b16 a[216:217], v14 offset:0
v_add_f32 v248, v243, v248
v_cvt_pk_bf16_f32 v196, v236, v237
v_add_f32 v249, v239, v249
v_cvt_pk_bf16_f32 v190, v240, v241
v_add_f32 v247, v240, v247
v_exp_f32 v236, v168
v_exp_f32 v240, v172
v_mfma_f32_16x16x32_bf16 v[140:143], a[244:247], v[52:55], v[140:143]
buffer_load_dwordx4 v4, s[16:19], s39 offen offset:2048 nt lds
v_cvt_pk_bf16_f32 v193, v242, v243
v_add_f32 v247, v241, v247
v_exp_f32 v242, v166
v_exp_f32 v243, v167
v_exp_f32 v237, v169
v_add_f32 v248, v236, v248
v_exp_f32 v241, v173
v_add_f32 v249, v240, v249
v_mfma_f32_16x16x32_bf16 v[140:143], a[248:251], v[56:59], v[140:143]
ds_read_b64_tr_b16 a[218:219], v14 offset:2048
v_add_u32 v8, s43, v8
v_cvt_pk_bf16_f32 v197, v238, v239
v_cvt_pk_bf16_f32 v191, v242, v243
v_add_f32 v247, v242, v247
v_add_f32 v248, v237, v248
v_exp_f32 v238, v170
v_add_f32 v249, v241, v249
v_exp_f32 v242, v174
v_mfma_f32_16x16x32_bf16 v[140:143], a[252:255], v[60:63], v[140:143]
ds_read_b128 a[200:203], v8 offset:0
v_add_u32 v9, s43, v9
v_add_f32 v247, v243, v247
v_exp_f32 v239, v171
v_add_f32 v248, v238, v248
v_exp_f32 v243, v175
v_add_f32 v249, v242, v249
s_waitcnt lgkmcnt(5)
v_mfma_f32_16x16x32_bf16 a[0:3], a[192:195], v[176:179], 0
ds_read_b128 a[204:207], v9 offset:0
v_add_f32 v248, v239, v248
v_add_f32 v249, v243, v249
v_mfma_f32_16x16x32_bf16 a[64:67], a[192:195], v[180:183], 0
ds_read_b128 a[208:211], v8 offset:4096
v_max3_f32 v253, v247, v248, v249
s_waitcnt lgkmcnt(5)
v_mfma_f32_16x16x32_bf16 a[4:7], a[196:199], v[176:179], 0
ds_read_b128 a[212:215], v9 offset:4096
v_cmp_lt_f32 vcc, s54, v253
v_mfma_f32_16x16x32_bf16 a[68:71], a[196:199], v[180:183], 0
buffer_load_dwordx4 v4, s[16:19], s39 offen offset:3072 nt lds
v_cvt_pk_bf16_f32 v194, v236, v237
v_cvt_pk_bf16_f32 v195, v238, v239
v_cvt_pk_bf16_f32 v198, v240, v241
v_cvt_pk_bf16_f32 v199, v242, v243
s_cbranch_vccnz L_slow_1
L_ret_1:
s_waitcnt lgkmcnt(3)
v_mfma_f32_16x16x32_bf16 v[152:155], a[200:203], v[32:35], v[224:227]
ds_read_b64_tr_b16 a[220:221], v15 offset:0
s_add_u32 m0, s40, 16384
s_waitcnt lgkmcnt(3)
v_mfma_f32_16x16x32_bf16 v[152:155], a[204:207], v[36:39], v[152:155]
ds_read_b64_tr_b16 a[222:223], v15 offset:2048
s_add_u32 s39, s39, 16384
s_waitcnt lgkmcnt(3)
v_mfma_f32_16x16x32_bf16 v[152:155], a[208:211], v[40:43], v[152:155]
ds_read_b128 a[224:227], v8 offset:8192
v_add_f32 v250, v247, v250
s_waitcnt lgkmcnt(3)
v_mfma_f32_16x16x32_bf16 v[152:155], a[212:215], v[44:47], v[152:155]
ds_read_b128 a[228:231], v9 offset:8192
v_add_f32 v251, v248, v251
v_mfma_f32_16x16x32_bf16 a[8:11], a[216:219], v[176:179], 0
ds_read_b128 a[232:235], v8 offset:12288
v_add_f32 v252, v249, v252
v_mfma_f32_16x16x32_bf16 a[72:75], a[216:219], v[180:183], 0
buffer_load_dwordx4 v4, s[16:19], s39 offen offset:0 nt lds
v_mfma_f32_16x16x32_bf16 v[156:159], a[200:203], v[64:67], v[228:231]
ds_read_b128 a[236:239], v9 offset:12288
s_bitcmp1_b64 s[48:49], 0
s_cselect_b32 s46, s45, s44
v_mfma_f32_16x16x32_bf16 v[156:159], a[204:207], v[68:71], v[156:159]
ds_read_b64_tr_b16 a[240:241], v12 offset:4096
s_lshr_b64 s[48:49], s[48:49], 1
v_mfma_f32_16x16x32_bf16 v[156:159], a[208:211], v[72:75], v[156:159]
ds_read_b64_tr_b16 a[242:243], v12 offset:6144
v_mfma_f32_16x16x32_bf16 v[156:159], a[212:215], v[76:79], v[156:159]
ds_read_b64_tr_b16 a[244:245], v13 offset:4096
s_waitcnt lgkmcnt(6)
v_mfma_f32_16x16x32_bf16 a[12:15], a[220:223], v[176:179], 0
ds_read_b64_tr_b16 a[246:247], v13 offset:6144
v_mfma_f32_16x16x32_bf16 a[76:79], a[220:223], v[180:183], 0
buffer_load_dwordx4 v4, s[16:19], s39 offen offset:1024 nt lds
v_mfma_f32_16x16x32_bf16 v[160:163], a[200:203], v[96:99], v[232:235]
v_exp_f32 v236, v128
v_mfma_f32_16x16x32_bf16 v[160:163], a[204:207], v[100:103], v[160:163]
ds_read_b64_tr_b16 a[248:249], v14 offset:4096
v_mfma_f32_16x16x32_bf16 v[160:163], a[208:211], v[104:107], v[160:163]
ds_read_b64_tr_b16 a[250:251], v14 offset:6144
v_mfma_f32_16x16x32_bf16 v[160:163], a[212:215], v[108:111], v[160:163]
v_exp_f32 v237, v129
v_mfma_f32_16x16x32_bf16 v[160:163], a[224:227], v[112:115], v[160:163]
s_waitcnt lgkmcnt(3)
v_exp_f32 v240, v132
v_mfma_f32_16x16x32_bf16 v[160:163], a[228:231], v[116:119], v[160:163]
buffer_load_dwordx4 v4, s[16:19], s39 offen offset:2048 nt lds
v_mfma_f32_16x16x32_bf16 v[160:163], a[232:235], v[120:123], v[160:163]
s_waitcnt lgkmcnt(2)
v_exp_f32 v241, v133
v_mfma_f32_16x16x32_bf16 v[160:163], a[236:239], v[124:127], v[160:163]
ds_read_b64_tr_b16 a[252:253], v15 offset:4096
v_add_f32 v244, v236, v237
v_mfma_f32_16x16x32_bf16 a[16:19], a[240:243], v[176:179], 0
ds_read_b64_tr_b16 a[254:255], v15 offset:6144
v_add_f32 v245, v240, v241
v_mfma_f32_16x16x32_bf16 a[80:83], a[240:243], v[180:183], 0
ds_read_b64_tr_b16 a[192:193], v12 offset:8192
v_cvt_pk_bf16_f32 v200, v236, v237
v_mfma_f32_16x16x32_bf16 a[20:23], a[244:247], v[176:179], 0
ds_read_b64_tr_b16 a[194:195], v12 offset:10240
v_cvt_pk_bf16_f32 v204, v240, v241
v_mfma_f32_16x16x32_bf16 a[84:87], a[244:247], v[180:183], 0
buffer_load_dwordx4 v4, s[16:19], s39 offen offset:3072 nt lds
s_add_u32 s39, s39, 16384
s_add_u32 s40, s40, 32768
s_cmp_eq_u32 s40, s41
s_cselect_b32 s40, s42, s40
s_mov_b32 m0, s40
v_mfma_f32_16x16x32_bf16 v[156:159], a[224:227], v[80:83], v[156:159]
buffer_load_dwordx4 v2, s[12:15], s38 offen offset:0 nt lds
v_mfma_f32_16x16x32_bf16 v[156:159], a[228:231], v[84:87], v[156:159]
ds_read_b64_tr_b16 a[196:197], v13 offset:8192
v_mfma_f32_16x16x32_bf16 v[156:159], a[232:235], v[88:91], v[156:159]
ds_read_b64_tr_b16 a[198:199], v13 offset:10240
v_mfma_f32_16x16x32_bf16 v[156:159], a[236:239], v[92:95], v[156:159]
ds_read_b128 a[200:203], v8 offset:2048
s_waitcnt lgkmcnt(5)
v_mfma_f32_16x16x32_bf16 a[24:27], a[248:251], v[176:179], 0
ds_read_b128 a[204:207], v9 offset:2048
v_mfma_f32_16x16x32_bf16 a[88:91], a[248:251], v[180:183], 0
ds_read_b128 a[208:211], v8 offset:6144
v_mfma_f32_16x16x32_bf16 v[152:155], a[224:227], v[48:51], v[152:155]
buffer_load_dwordx4 v3, s[12:15], s38 offen offset:1024 nt lds
v_mfma_f32_16x16x32_bf16 v[152:155], a[228:231], v[52:55], v[152:155]
ds_read_b128 a[212:215], v9 offset:6144
v_mfma_f32_16x16x32_bf16 v[152:155], a[232:235], v[56:59], v[152:155]
ds_read_b64_tr_b16 a[216:217], v14 offset:8192
v_mfma_f32_16x16x32_bf16 v[152:155], a[236:239], v[60:63], v[152:155]
ds_read_b64_tr_b16 a[218:219], v14 offset:10240
v_mfma_f32_16x16x32_bf16 a[28:31], a[252:255], v[176:179], 0
s_waitcnt lgkmcnt(5)
v_exp_f32 v238, v130
v_mfma_f32_16x16x32_bf16 a[92:95], a[252:255], v[180:183], 0
ds_read_b64_tr_b16 a[220:221], v15 offset:8192
v_add_f32 v244, v238, v244
v_mfma_f32_16x16x32_bf16 a[32:35], a[192:195], v[176:179], 0
buffer_load_dwordx4 v2, s[12:15], s38 offen offset:2048 nt lds
v_mfma_f32_16x16x32_bf16 a[96:99], a[192:195], v[180:183], 0
ds_read_b64_tr_b16 a[222:223], v15 offset:10240
v_mfma_f32_16x16x32_bf16 a[36:39], a[196:199], v[176:179], 0
v_exp_f32 v242, v134
v_mfma_f32_16x16x32_bf16 a[100:103], a[196:199], v[180:183], 0
v_exp_f32 v239, v131
v_mfma_f32_16x16x32_bf16 v[164:167], a[200:203], v[32:35], v[224:227]
s_waitcnt lgkmcnt(2)
v_exp_f32 v243, v135
v_mfma_f32_16x16x32_bf16 v[164:167], a[204:207], v[36:39], v[164:167]
ds_read_b128 a[224:227], v8 offset:10240
v_add_f32 v245, v242, v245
v_mfma_f32_16x16x32_bf16 v[164:167], a[208:211], v[40:43], v[164:167]
buffer_load_dwordx4 v3, s[12:15], s38 offen offset:3072 nt lds
v_mfma_f32_16x16x32_bf16 v[164:167], a[212:215], v[44:47], v[164:167]
ds_read_b128 a[228:231], v9 offset:10240
s_add_u32 m0, s40, 16384
v_mfma_f32_16x16x32_bf16 a[40:43], a[216:219], v[176:179], 0
ds_read_b128 a[232:235], v8 offset:14336
s_add_u32 s38, s38, 16384
v_mfma_f32_16x16x32_bf16 a[104:107], a[216:219], v[180:183], 0
ds_read_b128 a[236:239], v9 offset:14336
v_add_f32 v244, v239, v244
v_mfma_f32_16x16x32_bf16 v[168:171], a[200:203], v[64:67], v[228:231]
ds_read_b64_tr_b16 a[240:241], v12 offset:12288
v_add_f32 v245, v243, v245
v_mfma_f32_16x16x32_bf16 v[168:171], a[204:207], v[68:71], v[168:171]
ds_read_b64_tr_b16 a[242:243], v12 offset:14336
v_add_u32 v12, s43, v12
v_mfma_f32_16x16x32_bf16 v[168:171], a[208:211], v[72:75], v[168:171]
buffer_load_dwordx4 v2, s[12:15], s38 offen offset:0 nt lds
v_mfma_f32_16x16x32_bf16 v[168:171], a[212:215], v[76:79], v[168:171]
ds_read_b64_tr_b16 a[244:245], v13 offset:12288
v_add_u32 v8, s46, v8
s_waitcnt lgkmcnt(6)
v_mfma_f32_16x16x32_bf16 a[44:47], a[220:223], v[176:179], 0
ds_read_b64_tr_b16 a[246:247], v13 offset:14336
v_add_u32 v13, s43, v13
v_mfma_f32_16x16x32_bf16 a[108:111], a[220:223], v[180:183], 0
v_exp_f32 v236, v140
v_mfma_f32_16x16x32_bf16 v[172:175], a[200:203], v[96:99], v[232:235]
v_exp_f32 v240, v144
v_mfma_f32_16x16x32_bf16 v[172:175], a[204:207], v[100:103], v[172:175]
ds_read_b64_tr_b16 a[248:249], v14 offset:12288
v_add_f32 v244, v236, v244
v_mfma_f32_16x16x32_bf16 v[172:175], a[208:211], v[104:107], v[172:175]
buffer_load_dwordx4 v3, s[12:15], s38 offen offset:1024 nt lds
v_mfma_f32_16x16x32_bf16 v[172:175], a[212:215], v[108:111], v[172:175]
ds_read_b64_tr_b16 a[250:251], v14 offset:14336
v_add_f32 v245, v240, v245
v_mfma_f32_16x16x32_bf16 v[172:175], a[224:227], v[112:115], v[172:175]
s_waitcnt lgkmcnt(3)
v_exp_f32 v237, v141
v_mfma_f32_16x16x32_bf16 v[172:175], a[228:231], v[116:119], v[172:175]
v_exp_f32 v241, v145
v_mfma_f32_16x16x32_bf16 v[172:175], a[232:235], v[120:123], v[172:175]
s_waitcnt lgkmcnt(2)
v_cvt_pk_bf16_f32 v201, v238, v239
v_cvt_pk_bf16_f32 v205, v242, v243
v_mfma_f32_16x16x32_bf16 v[172:175], a[236:239], v[124:127], v[172:175]
ds_read_b64_tr_b16 a[252:253], v15 offset:12288
v_add_f32 v244, v237, v244
v_mfma_f32_16x16x32_bf16 a[48:51], a[240:243], v[176:179], 0
buffer_load_dwordx4 v2, s[12:15], s38 offen offset:2048 nt lds
v_mfma_f32_16x16x32_bf16 a[112:115], a[240:243], v[180:183], 0
ds_read_b64_tr_b16 a[254:255], v15 offset:14336
v_add_f32 v245, v241, v245
v_mfma_f32_16x16x32_bf16 a[52:55], a[244:247], v[176:179], 0
ds_read_b64_tr_b16 a[192:193], v12 offset:0
v_add_u32 v9, s46, v9
v_mfma_f32_16x16x32_bf16 a[116:119], a[244:247], v[180:183], 0
ds_read_b64_tr_b16 a[194:195], v12 offset:2048
v_add_u32 v14, s43, v14
v_mfma_f32_16x16x32_bf16 v[168:171], a[224:227], v[80:83], v[168:171]
ds_read_b64_tr_b16 a[196:197], v13 offset:0
v_cvt_pk_bf16_f32 v202, v236, v237
v_mfma_f32_16x16x32_bf16 v[168:171], a[228:231], v[84:87], v[168:171]
s_waitcnt vmcnt(15)
s_barrier
v_cvt_pk_bf16_f32 v206, v240, v241
v_mfma_f32_16x16x32_bf16 v[168:171], a[232:235], v[88:91], v[168:171]
buffer_load_dwordx4 v3, s[12:15], s38 offen offset:3072 nt lds
v_mfma_f32_16x16x32_bf16 v[168:171], a[236:239], v[92:95], v[168:171]
ds_read_b64_tr_b16 a[198:199], v13 offset:2048
s_add_u32 s38, s38, 16384
s_waitcnt lgkmcnt(5)
v_mfma_f32_16x16x32_bf16 a[56:59], a[248:251], v[176:179], 0
ds_read_b128 a[200:203], v8 offset:0
s_add_u32 s40, s40, 32768
v_mfma_f32_16x16x32_bf16 a[120:123], a[248:251], v[180:183], 0
ds_read_b128 a[204:207], v9 offset:0
s_cmp_eq_u32 s40, s41
s_cselect_b32 s40, s42, s40
v_mfma_f32_16x16x32_bf16 v[164:167], a[224:227], v[48:51], v[164:167]
ds_read_b128 a[208:211], v8 offset:4096
v_add_u32 v15, s43, v15
v_mfma_f32_16x16x32_bf16 v[164:167], a[228:231], v[52:55], v[164:167]
ds_read_b128 a[212:215], v9 offset:4096
v_mfma_f32_16x16x32_bf16 v[164:167], a[232:235], v[56:59], v[164:167]
ds_read_b64_tr_b16 a[216:217], v14 offset:0
v_mfma_f32_16x16x32_bf16 v[164:167], a[236:239], v[60:63], v[164:167]
ds_read_b64_tr_b16 a[218:219], v14 offset:2048
s_waitcnt lgkmcnt(7)
v_mfma_f32_16x16x32_bf16 a[60:63], a[252:255], v[176:179], 0
ds_read_b64_tr_b16 a[220:221], v15 offset:0
v_mfma_f32_16x16x32_bf16 a[124:127], a[252:255], v[180:183], 0
ds_read_b64_tr_b16 a[222:223], v15 offset:2048
v_mfma_f32_16x16x32_bf16 a[0:3], a[192:195], v[188:191], a[0:3]
s_waitcnt lgkmcnt(6)
v_exp_f32 v238, v142
v_exp_f32 v242, v146
v_mfma_f32_16x16x32_bf16 a[64:67], a[192:195], v[192:195], a[64:67]
s_mov_b32 m0, s40
v_exp_f32 v239, v143
v_add_f32 v244, v238, v244
v_exp_f32 v243, v147
v_add_f32 v245, v242, v245
v_mfma_f32_16x16x32_bf16 a[128:131], a[192:195], v[196:199], 0
buffer_load_dwordx4 v4, s[16:19], s39 offen offset:0 nt lds
v_add_f32 v244, v239, v244
v_add_f32 v245, v243, v245
v_mfma_f32_16x16x32_bf16 a[4:7], a[196:199], v[188:191], a[4:7]
v_max_f32 v253, v244, v245
v_cvt_pk_bf16_f32 v203, v238, v239
v_mfma_f32_16x16x32_bf16 a[68:71], a[196:199], v[192:195], a[68:71]
v_cmp_lt_f32 vcc, s54, v253
v_cvt_pk_bf16_f32 v207, v242, v243
v_mfma_f32_16x16x32_bf16 a[132:135], a[196:199], v[196:199], 0
ds_read_b128 a[224:227], v8 offset:8192
s_cbranch_vccnz L_slow_2
L_ret_2:
v_mfma_f32_16x16x32_bf16 v[128:131], a[200:203], v[32:35], v[224:227]
ds_read_b128 a[228:231], v9 offset:8192
v_add_f32 v250, v244, v250
v_mfma_f32_16x16x32_bf16 v[128:131], a[204:207], v[36:39], v[128:131]
ds_read_b128 a[232:235], v8 offset:12288
v_add_f32 v251, v245, v251
s_waitcnt lgkmcnt(3)
v_mfma_f32_16x16x32_bf16 v[128:131], a[208:211], v[40:43], v[128:131]
ds_read_b128 a[236:239], v9 offset:12288
s_bitcmp1_b64 s[48:49], 0
s_cselect_b32 s46, s45, s44
v_mfma_f32_16x16x32_bf16 v[128:131], a[212:215], v[44:47], v[128:131]
ds_read_b64_tr_b16 a[240:241], v12 offset:4096
s_lshr_b64 s[48:49], s[48:49], 1
v_mfma_f32_16x16x32_bf16 a[8:11], a[216:219], v[188:191], a[8:11]
ds_read_b64_tr_b16 a[242:243], v12 offset:6144
v_mfma_f32_16x16x32_bf16 a[72:75], a[216:219], v[192:195], a[72:75]
buffer_load_dwordx4 v4, s[16:19], s39 offen offset:1024 nt lds
v_mfma_f32_16x16x32_bf16 a[136:139], a[216:219], v[196:199], 0
ds_read_b64_tr_b16 a[244:245], v13 offset:4096
v_mfma_f32_16x16x32_bf16 a[12:15], a[220:223], v[188:191], a[12:15]
ds_read_b64_tr_b16 a[246:247], v13 offset:6144
v_mfma_f32_16x16x32_bf16 a[76:79], a[220:223], v[192:195], a[76:79]
v_exp_f32 v236, v152
v_mfma_f32_16x16x32_bf16 a[140:143], a[220:223], v[196:199], 0
v_exp_f32 v237, v153
v_mfma_f32_16x16x32_bf16 v[132:135], a[200:203], v[64:67], v[228:231]
v_exp_f32 v238, v154
v_mfma_f32_16x16x32_bf16 v[132:135], a[204:207], v[68:71], v[132:135]
buffer_load_dwordx4 v4, s[16:19], s39 offen offset:2048 nt lds
v_mfma_f32_16x16x32_bf16 v[132:135], a[208:211], v[72:75], v[132:135]
s_waitcnt lgkmcnt(2)
v_exp_f32 v239, v155
v_mfma_f32_16x16x32_bf16 v[132:135], a[212:215], v[76:79], v[132:135]
ds_read_b64_tr_b16 a[248:249], v14 offset:4096
v_cvt_pk_bf16_f32 v212, v236, v237
v_mfma_f32_16x16x32_bf16 v[132:135], a[224:227], v[80:83], v[132:135]
ds_read_b64_tr_b16 a[250:251], v14 offset:6144
v_add_f32 v247, v236, v237
v_mfma_f32_16x16x32_bf16 v[132:135], a[228:231], v[84:87], v[132:135]
s_waitcnt lgkmcnt(2)
v_exp_f32 v240, v156
v_mfma_f32_16x16x32_bf16 v[132:135], a[232:235], v[88:91], v[132:135]
ds_read_b64_tr_b16 a[252:253], v15 offset:4096
v_cvt_pk_bf16_f32 v213, v238, v239
v_mfma_f32_16x16x32_bf16 v[132:135], a[236:239], v[92:95], v[132:135]
ds_read_b64_tr_b16 a[254:255], v15 offset:6144
v_add_f32 v247, v238, v247
v_mfma_f32_16x16x32_bf16 a[16:19], a[240:243], v[188:191], a[16:19]
buffer_load_dwordx4 v4, s[16:19], s39 offen offset:3072 nt lds
v_mfma_f32_16x16x32_bf16 a[80:83], a[240:243], v[192:195], a[80:83]
ds_read_b64_tr_b16 a[192:193], v12 offset:8192
s_add_u32 m0, s40, 16384
v_mfma_f32_16x16x32_bf16 a[144:147], a[240:243], v[196:199], 0
ds_read_b64_tr_b16 a[194:195], v12 offset:10240
s_add_u32 s39, s39, 16384
v_mfma_f32_16x16x32_bf16 a[20:23], a[244:247], v[188:191], a[20:23]
v_exp_f32 v241, v157
v_mfma_f32_16x16x32_bf16 a[84:87], a[244:247], v[192:195], a[84:87]
ds_read_b64_tr_b16 a[196:197], v13 offset:8192
v_add_f32 v248, v240, v241
v_mfma_f32_16x16x32_bf16 a[148:151], a[244:247], v[196:199], 0
ds_read_b64_tr_b16 a[198:199], v13 offset:10240
v_add_f32 v247, v239, v247
v_mfma_f32_16x16x32_bf16 v[128:131], a[224:227], v[48:51], v[128:131]
buffer_load_dwordx4 v4, s[16:19], s39 offen offset:0 nt lds
v_mfma_f32_16x16x32_bf16 v[128:131], a[228:231], v[52:55], v[128:131]
ds_read_b128 a[200:203], v8 offset:2048
v_cvt_pk_bf16_f32 v216, v240, v241
v_mfma_f32_16x16x32_bf16 v[128:131], a[232:235], v[56:59], v[128:131]
ds_read_b128 a[204:207], v9 offset:2048
v_mfma_f32_16x16x32_bf16 v[128:131], a[236:239], v[60:63], v[128:131]
ds_read_b128 a[208:211], v8 offset:6144
s_waitcnt lgkmcnt(5)
v_mfma_f32_16x16x32_bf16 a[24:27], a[248:251], v[188:191], a[24:27]
ds_read_b128 a[212:215], v9 offset:6144
v_mfma_f32_16x16x32_bf16 a[88:91], a[248:251], v[192:195], a[88:91]
ds_read_b64_tr_b16 a[216:217], v14 offset:8192
v_mfma_f32_16x16x32_bf16 a[152:155], a[248:251], v[196:199], 0
ds_read_b64_tr_b16 a[218:219], v14 offset:10240
v_mfma_f32_16x16x32_bf16 a[28:31], a[252:255], v[188:191], a[28:31]
buffer_load_dwordx4 v4, s[16:19], s39 offen offset:1024 nt lds
v_mfma_f32_16x16x32_bf16 a[92:95], a[252:255], v[192:195], a[92:95]
ds_read_b64_tr_b16 a[220:221], v15 offset:8192
v_mfma_f32_16x16x32_bf16 a[156:159], a[252:255], v[196:199], 0
ds_read_b64_tr_b16 a[222:223], v15 offset:10240
v_mfma_f32_16x16x32_bf16 a[32:35], a[192:195], v[188:191], a[32:35]
v_exp_f32 v236, v160
v_mfma_f32_16x16x32_bf16 a[96:99], a[192:195], v[192:195], a[96:99]
v_exp_f32 v237, v161
v_mfma_f32_16x16x32_bf16 a[160:163], a[192:195], v[196:199], 0
s_waitcnt lgkmcnt(3)
v_exp_f32 v242, v158
v_mfma_f32_16x16x32_bf16 a[36:39], a[196:199], v[188:191], a[36:39]
buffer_load_dwordx4 v4, s[16:19], s39 offen offset:2048 nt lds
v_mfma_f32_16x16x32_bf16 a[100:103], a[196:199], v[192:195], a[100:103]
s_waitcnt lgkmcnt(2)
v_exp_f32 v238, v162
v_mfma_f32_16x16x32_bf16 a[164:167], a[196:199], v[196:199], 0
ds_read_b128 a[224:227], v8 offset:10240
v_add_f32 v249, v236, v237
v_mfma_f32_16x16x32_bf16 v[140:143], a[200:203], v[32:35], v[224:227]
ds_read_b128 a[228:231], v9 offset:10240
v_add_f32 v248, v242, v248
v_mfma_f32_16x16x32_bf16 v[140:143], a[204:207], v[36:39], v[140:143]
ds_read_b128 a[232:235], v8 offset:14336
v_add_f32 v249, v238, v249
v_mfma_f32_16x16x32_bf16 v[140:143], a[208:211], v[40:43], v[140:143]
ds_read_b128 a[236:239], v9 offset:14336
v_cvt_pk_bf16_f32 v220, v236, v237
v_mfma_f32_16x16x32_bf16 v[140:143], a[212:215], v[44:47], v[140:143]
ds_read_b64_tr_b16 a[240:241], v12 offset:12288
v_add_u32 v8, s43, v8
v_mfma_f32_16x16x32_bf16 a[40:43], a[216:219], v[188:191], a[40:43]
ds_read_b64_tr_b16 a[242:243], v12 offset:14336
v_add_u32 v12, s46, v12
v_mfma_f32_16x16x32_bf16 a[104:107], a[216:219], v[192:195], a[104:107]
buffer_load_dwordx4 v4, s[16:19], s39 offen offset:3072 nt lds
v_mfma_f32_16x16x32_bf16 a[168:171], a[216:219], v[196:199], 0
ds_read_b64_tr_b16 a[244:245], v13 offset:12288
s_add_u32 s39, s39, 16384
s_waitcnt lgkmcnt(6)
v_mfma_f32_16x16x32_bf16 a[44:47], a[220:223], v[188:191], a[44:47]
ds_read_b64_tr_b16 a[246:247], v13 offset:14336
v_add_u32 v13, s46, v13
v_mfma_f32_16x16x32_bf16 a[108:111], a[220:223], v[192:195], a[108:111]
s_add_u32 s40, s40, 32768
v_exp_f32 v243, v159
v_mfma_f32_16x16x32_bf16 a[172:175], a[220:223], v[196:199], 0
s_cmp_eq_u32 s40, s41
s_cselect_b32 s40, s42, s40
v_exp_f32 v239, v163
v_mfma_f32_16x16x32_bf16 v[144:147], a[200:203], v[64:67], v[228:231]
v_exp_f32 v240, v164
v_mfma_f32_16x16x32_bf16 v[144:147], a[204:207], v[68:71], v[144:147]
v_exp_f32 v241, v165
v_mfma_f32_16x16x32_bf16 v[144:147], a[208:211], v[72:75], v[144:147]
s_waitcnt lgkmcnt(2)
v_exp_f32 v236, v168
v_mfma_f32_16x16x32_bf16 v[144:147], a[212:215], v[76:79], v[144:147]
ds_read_b64_tr_b16 a[248:249], v14 offset:12288
v_add_f32 v248, v243, v248
v_mfma_f32_16x16x32_bf16 v[144:147], a[224:227], v[80:83], v[144:147]
ds_read_b64_tr_b16 a[250:251], v14 offset:14336
v_add_f32 v249, v239, v249
v_mfma_f32_16x16x32_bf16 v[144:147], a[228:231], v[84:87], v[144:147]
v_exp_f32 v237, v169
v_mfma_f32_16x16x32_bf16 v[144:147], a[232:235], v[88:91], v[144:147]
ds_read_b64_tr_b16 a[252:253], v15 offset:12288
v_cvt_pk_bf16_f32 v214, v240, v241
v_mfma_f32_16x16x32_bf16 v[144:147], a[236:239], v[92:95], v[144:147]
ds_read_b64_tr_b16 a[254:255], v15 offset:14336
v_add_f32 v247, v240, v247
v_mfma_f32_16x16x32_bf16 a[48:51], a[240:243], v[188:191], a[48:51]
v_exp_f32 v240, v172
v_mfma_f32_16x16x32_bf16 a[112:115], a[240:243], v[192:195], a[112:115]
v_cvt_pk_bf16_f32 v217, v242, v243
v_add_f32 v247, v241, v247
v_mfma_f32_16x16x32_bf16 a[176:179], a[240:243], v[196:199], 0
s_waitcnt lgkmcnt(3)
v_exp_f32 v242, v166
v_mfma_f32_16x16x32_bf16 a[52:55], a[244:247], v[188:191], a[52:55]
v_exp_f32 v243, v167
v_mfma_f32_16x16x32_bf16 a[116:119], a[244:247], v[192:195], a[116:119]
v_exp_f32 v241, v173
v_mfma_f32_16x16x32_bf16 a[180:183], a[244:247], v[196:199], 0
s_waitcnt vmcnt(16) lgkmcnt(0)
s_barrier
v_add_f32 v248, v236, v248
v_mfma_f32_16x16x32_bf16 v[140:143], a[224:227], v[48:51], v[140:143]
ds_read_b64_tr_b16 a[192:193], v12 offset:0
v_add_f32 v249, v240, v249
v_mfma_f32_16x16x32_bf16 v[140:143], a[228:231], v[52:55], v[140:143]
ds_read_b64_tr_b16 a[194:195], v12 offset:2048
v_cvt_pk_bf16_f32 v221, v238, v239
v_mfma_f32_16x16x32_bf16 v[140:143], a[232:235], v[56:59], v[140:143]
ds_read_b64_tr_b16 a[196:197], v13 offset:0
v_cvt_pk_bf16_f32 v215, v242, v243
v_mfma_f32_16x16x32_bf16 v[140:143], a[236:239], v[60:63], v[140:143]
ds_read_b64_tr_b16 a[198:199], v13 offset:2048
v_add_f32 v247, v242, v247
v_mfma_f32_16x16x32_bf16 a[56:59], a[248:251], v[188:191], a[56:59]
ds_read_b128 a[200:203], v8 offset:0
v_add_f32 v248, v237, v248
v_mfma_f32_16x16x32_bf16 a[120:123], a[248:251], v[192:195], a[120:123]
ds_read_b128 a[208:211], v8 offset:4096
v_add_f32 v249, v241, v249
v_mfma_f32_16x16x32_bf16 a[184:187], a[248:251], v[196:199], 0
v_exp_f32 v238, v170
v_mfma_f32_16x16x32_bf16 a[60:63], a[252:255], v[188:191], a[60:63]
v_exp_f32 v242, v174
v_mfma_f32_16x16x32_bf16 a[124:127], a[252:255], v[192:195], a[124:127]
s_waitcnt lgkmcnt(2)
v_exp_f32 v239, v171
v_mfma_f32_16x16x32_bf16 a[188:191], a[252:255], v[196:199], 0
s_waitcnt lgkmcnt(3)
v_add_u32 v9, s43, v9
v_add_f32 v247, v243, v247
v_add_f32 v248, v238, v248
v_exp_f32 v243, v175
v_add_f32 v249, v242, v249
v_mfma_f32_16x16x32_bf16 a[0:3], a[192:195], v[200:203], a[0:3]
ds_read_b128 a[204:207], v9 offset:0
v_add_f32 v248, v239, v248
v_add_f32 v249, v243, v249
v_mfma_f32_16x16x32_bf16 a[64:67], a[192:195], v[204:207], a[64:67]
ds_read_b128 a[212:215], v9 offset:4096
v_max3_f32 v253, v247, v248, v249
v_mfma_f32_16x16x32_bf16 a[4:7], a[196:199], v[200:203], a[4:7]
v_add_u32 v14, s46, v14
v_cmp_lt_f32 vcc, s54, v253
v_mfma_f32_16x16x32_bf16 a[68:71], a[196:199], v[204:207], a[68:71]
ds_read_b64_tr_b16 a[216:217], v14 offset:0
v_cvt_pk_bf16_f32 v218, v236, v237
ds_read_b64_tr_b16 a[218:219], v14 offset:2048
v_cvt_pk_bf16_f32 v219, v238, v239
v_cvt_pk_bf16_f32 v222, v240, v241
v_cvt_pk_bf16_f32 v223, v242, v243
s_cbranch_vccnz L_slow_3
L_ret_3:
s_waitcnt lgkmcnt(4)
v_mfma_f32_16x16x32_bf16 v[152:155], a[200:203], v[32:35], v[224:227]
s_mov_b32 m0, s40
v_exp_f32 v236, v128
s_waitcnt lgkmcnt(3)
v_mfma_f32_16x16x32_bf16 v[152:155], a[204:207], v[36:39], v[152:155]
ds_read_b128 a[224:227], v8 offset:8192
v_add_u32 v15, s46, v15
v_mfma_f32_16x16x32_bf16 v[152:155], a[208:211], v[40:43], v[152:155]
ds_read_b64_tr_b16 a[220:221], v15 offset:0
v_add_f32 v250, v247, v250
s_waitcnt lgkmcnt(4)
v_mfma_f32_16x16x32_bf16 v[152:155], a[212:215], v[44:47], v[152:155]
ds_read_b64_tr_b16 a[222:223], v15 offset:2048
v_add_f32 v251, v248, v251
s_waitcnt lgkmcnt(3)
v_mfma_f32_16x16x32_bf16 a[8:11], a[216:219], v[200:203], a[8:11]
ds_read_b128 a[228:231], v9 offset:8192
v_add_f32 v252, v249, v252
v_mfma_f32_16x16x32_bf16 a[72:75], a[216:219], v[204:207], a[72:75]
ds_read_b128 a[232:235], v8 offset:12288
s_bitcmp1_b64 s[48:49], 0
s_cselect_b32 s46, s45, s44
v_mfma_f32_16x16x32_bf16 v[156:159], a[200:203], v[64:67], v[228:231]
ds_read_b128 a[236:239], v9 offset:12288
s_lshr_b64 s[48:49], s[48:49], 1
v_mfma_f32_16x16x32_bf16 v[156:159], a[204:207], v[68:71], v[156:159]
ds_read_b64_tr_b16 a[240:241], v12 offset:4096
v_mfma_f32_16x16x32_bf16 v[156:159], a[208:211], v[72:75], v[156:159]
ds_read_b64_tr_b16 a[242:243], v12 offset:6144
v_mfma_f32_16x16x32_bf16 v[156:159], a[212:215], v[76:79], v[156:159]
ds_read_b64_tr_b16 a[244:245], v13 offset:4096
s_waitcnt lgkmcnt(6)
v_mfma_f32_16x16x32_bf16 a[12:15], a[220:223], v[200:203], a[12:15]
ds_read_b64_tr_b16 a[246:247], v13 offset:6144
v_mfma_f32_16x16x32_bf16 a[76:79], a[220:223], v[204:207], a[76:79]
buffer_load_dwordx4 v2, s[12:15], s38 offen offset:0 nt lds
v_mfma_f32_16x16x32_bf16 v[160:163], a[200:203], v[96:99], v[232:235]
v_exp_f32 v237, v129
v_mfma_f32_16x16x32_bf16 v[160:163], a[204:207], v[100:103], v[160:163]
ds_read_b64_tr_b16 a[248:249], v14 offset:4096
v_add_f32 v244, v236, v237
v_mfma_f32_16x16x32_bf16 v[160:163], a[208:211], v[104:107], v[160:163]
ds_read_b64_tr_b16 a[250:251], v14 offset:6144
v_cvt_pk_bf16_f32 v176, v236, v237
v_mfma_f32_16x16x32_bf16 v[160:163], a[212:215], v[108:111], v[160:163]
v_exp_f32 v240, v132
v_mfma_f32_16x16x32_bf16 v[160:163], a[224:227], v[112:115], v[160:163]
s_waitcnt lgkmcnt(3)
v_exp_f32 v241, v133
v_mfma_f32_16x16x32_bf16 v[160:163], a[228:231], v[116:119], v[160:163]
buffer_load_dwordx4 v3, s[12:15], s38 offen offset:1024 nt lds
v_mfma_f32_16x16x32_bf16 v[160:163], a[232:235], v[120:123], v[160:163]
s_waitcnt lgkmcnt(2)
v_exp_f32 v238, v130
v_mfma_f32_16x16x32_bf16 v[160:163], a[236:239], v[124:127], v[160:163]
ds_read_b64_tr_b16 a[252:253], v15 offset:4096
v_add_f32 v245, v240, v241
v_mfma_f32_16x16x32_bf16 a[16:19], a[240:243], v[200:203], a[16:19]
ds_read_b64_tr_b16 a[254:255], v15 offset:6144
v_add_f32 v244, v238, v244
v_mfma_f32_16x16x32_bf16 a[80:83], a[240:243], v[204:207], a[80:83]
ds_read_b64_tr_b16 a[192:193], v12 offset:8192
v_cvt_pk_bf16_f32 v180, v240, v241
v_mfma_f32_16x16x32_bf16 a[20:23], a[244:247], v[200:203], a[20:23]
ds_read_b64_tr_b16 a[194:195], v12 offset:10240
v_mfma_f32_16x16x32_bf16 a[84:87], a[244:247], v[204:207], a[84:87]
ds_read_b64_tr_b16 a[196:197], v13 offset:8192
v_mfma_f32_16x16x32_bf16 v[156:159], a[224:227], v[80:83], v[156:159]
ds_read_b64_tr_b16 a[198:199], v13 offset:10240
v_mfma_f32_16x16x32_bf16 v[156:159], a[228:231], v[84:87], v[156:159]
ds_read_b128 a[200:203], v8 offset:2048
v_mfma_f32_16x16x32_bf16 v[156:159], a[232:235], v[88:91], v[156:159]
ds_read_b128 a[204:207], v9 offset:2048
v_mfma_f32_16x16x32_bf16 v[156:159], a[236:239], v[92:95], v[156:159]
ds_read_b128 a[208:211], v8 offset:6144
s_waitcnt lgkmcnt(7)
v_mfma_f32_16x16x32_bf16 a[24:27], a[248:251], v[200:203], a[24:27]
ds_read_b128 a[212:215], v9 offset:6144
v_mfma_f32_16x16x32_bf16 a[88:91], a[248:251], v[204:207], a[88:91]
ds_read_b64_tr_b16 a[216:217], v14 offset:8192
v_mfma_f32_16x16x32_bf16 v[152:155], a[224:227], v[48:51], v[152:155]
ds_read_b64_tr_b16 a[218:219], v14 offset:10240
v_mfma_f32_16x16x32_bf16 v[152:155], a[228:231], v[52:55], v[152:155]
buffer_load_dwordx4 v2, s[12:15], s38 offen offset:2048 nt lds
v_mfma_f32_16x16x32_bf16 v[152:155], a[232:235], v[56:59], v[152:155]
v_exp_f32 v242, v134
v_mfma_f32_16x16x32_bf16 v[152:155], a[236:239], v[60:63], v[152:155]
v_exp_f32 v239, v131
v_mfma_f32_16x16x32_bf16 a[28:31], a[252:255], v[200:203], a[28:31]
s_waitcnt lgkmcnt(3)
v_exp_f32 v243, v135
v_mfma_f32_16x16x32_bf16 a[92:95], a[252:255], v[204:207], a[92:95]
ds_read_b64_tr_b16 a[220:221], v15 offset:8192
v_add_f32 v245, v242, v245
v_mfma_f32_16x16x32_bf16 a[32:35], a[192:195], v[200:203], a[32:35]
ds_read_b64_tr_b16 a[222:223], v15 offset:10240
v_add_f32 v244, v239, v244
v_mfma_f32_16x16x32_bf16 a[96:99], a[192:195], v[204:207], a[96:99]
buffer_load_dwordx4 v3, s[12:15], s38 offen offset:3072 nt lds
v_mfma_f32_16x16x32_bf16 a[36:39], a[196:199], v[200:203], a[36:39]
s_add_u32 m0, s40, 16384
v_exp_f32 v236, v140
v_mfma_f32_16x16x32_bf16 a[100:103], a[196:199], v[204:207], a[100:103]
s_add_u32 s38, s38, 16384
v_exp_f32 v240, v144
v_mfma_f32_16x16x32_bf16 v[164:167], a[200:203], v[32:35], v[224:227]
s_waitcnt lgkmcnt(2)
v_exp_f32 v237, v141
v_mfma_f32_16x16x32_bf16 v[164:167], a[204:207], v[36:39], v[164:167]
ds_read_b128 a[224:227], v8 offset:10240
v_add_f32 v245, v243, v245
v_mfma_f32_16x16x32_bf16 v[164:167], a[208:211], v[40:43], v[164:167]
ds_read_b128 a[228:231], v9 offset:10240
v_add_f32 v244, v236, v244
v_mfma_f32_16x16x32_bf16 v[164:167], a[212:215], v[44:47], v[164:167]
ds_read_b128 a[232:235], v8 offset:14336
v_add_f32 v245, v240, v245
v_mfma_f32_16x16x32_bf16 a[40:43], a[216:219], v[200:203], a[40:43]
ds_read_b128 a[236:239], v9 offset:14336
v_add_u32 v8, s46, v8
v_mfma_f32_16x16x32_bf16 a[104:107], a[216:219], v[204:207], a[104:107]
ds_read_b64_tr_b16 a[240:241], v12 offset:12288
v_cvt_pk_bf16_f32 v177, v238, v239
v_mfma_f32_16x16x32_bf16 v[168:171], a[200:203], v[64:67], v[228:231]
ds_read_b64_tr_b16 a[242:243], v12 offset:14336
v_add_u32 v12, s43, v12
v_mfma_f32_16x16x32_bf16 v[168:171], a[204:207], v[68:71], v[168:171]
ds_read_b64_tr_b16 a[244:245], v13 offset:12288
v_cvt_pk_bf16_f32 v181, v242, v243
v_mfma_f32_16x16x32_bf16 v[168:171], a[208:211], v[72:75], v[168:171]
buffer_load_dwordx4 v2, s[12:15], s38 offen offset:0 nt lds
v_mfma_f32_16x16x32_bf16 v[168:171], a[212:215], v[76:79], v[168:171]
ds_read_b64_tr_b16 a[246:247], v13 offset:14336
v_add_u32 v13, s43, v13
s_waitcnt lgkmcnt(6)
v_mfma_f32_16x16x32_bf16 a[44:47], a[220:223], v[200:203], a[44:47]
v_exp_f32 v241, v145
v_mfma_f32_16x16x32_bf16 a[108:111], a[220:223], v[204:207], a[108:111]
v_exp_f32 v238, v142
v_mfma_f32_16x16x32_bf16 v[172:175], a[200:203], v[96:99], v[232:235]
v_exp_f32 v242, v146
v_mfma_f32_16x16x32_bf16 v[172:175], a[204:207], v[100:103], v[172:175]
ds_read_b64_tr_b16 a[248:249], v14 offset:12288
v_add_f32 v244, v237, v244
v_mfma_f32_16x16x32_bf16 v[172:175], a[208:211], v[104:107], v[172:175]
buffer_load_dwordx4 v3, s[12:15], s38 offen offset:1024 nt lds
v_mfma_f32_16x16x32_bf16 v[172:175], a[212:215], v[108:111], v[172:175]
ds_read_b64_tr_b16 a[250:251], v14 offset:14336
v_add_f32 v245, v241, v245
v_mfma_f32_16x16x32_bf16 v[172:175], a[224:227], v[112:115], v[172:175]
v_exp_f32 v239, v143
v_mfma_f32_16x16x32_bf16 v[172:175], a[228:231], v[116:119], v[172:175]
s_waitcnt lgkmcnt(2)
v_exp_f32 v243, v147
v_mfma_f32_16x16x32_bf16 v[172:175], a[232:235], v[120:123], v[172:175]
v_add_u32 v9, s46, v9
v_add_f32 v244, v238, v244
v_mfma_f32_16x16x32_bf16 v[172:175], a[236:239], v[124:127], v[172:175]
ds_read_b64_tr_b16 a[252:253], v15 offset:12288
v_add_f32 v245, v242, v245
v_mfma_f32_16x16x32_bf16 a[48:51], a[240:243], v[200:203], a[48:51]
buffer_load_dwordx4 v2, s[12:15], s38 offen offset:2048 nt lds
v_mfma_f32_16x16x32_bf16 a[112:115], a[240:243], v[204:207], a[112:115]
ds_read_b64_tr_b16 a[254:255], v15 offset:14336
v_add_f32 v244, v239, v244
v_mfma_f32_16x16x32_bf16 a[52:55], a[244:247], v[200:203], a[52:55]
ds_read_b64_tr_b16 a[192:193], v12 offset:0
v_add_f32 v245, v243, v245
v_mfma_f32_16x16x32_bf16 a[116:119], a[244:247], v[204:207], a[116:119]
ds_read_b64_tr_b16 a[194:195], v12 offset:2048
v_max_f32 v253, v244, v245
v_mfma_f32_16x16x32_bf16 v[168:171], a[224:227], v[80:83], v[168:171]
ds_read_b64_tr_b16 a[196:197], v13 offset:0
v_add_u32 v14, s43, v14
v_mfma_f32_16x16x32_bf16 v[168:171], a[228:231], v[84:87], v[168:171]
s_waitcnt vmcnt(15)
s_barrier
v_cmp_lt_f32 vcc, s54, v253
v_mfma_f32_16x16x32_bf16 v[168:171], a[232:235], v[88:91], v[168:171]
buffer_load_dwordx4 v3, s[12:15], s38 offen offset:3072 nt lds
v_mfma_f32_16x16x32_bf16 v[168:171], a[236:239], v[92:95], v[168:171]
ds_read_b64_tr_b16 a[198:199], v13 offset:2048
s_add_u32 s38, s38, 16384
s_waitcnt lgkmcnt(5)
v_mfma_f32_16x16x32_bf16 a[56:59], a[248:251], v[200:203], a[56:59]
ds_read_b128 a[200:203], v8 offset:0
s_add_u32 s40, s40, 32768
v_mfma_f32_16x16x32_bf16 a[120:123], a[248:251], v[204:207], a[120:123]
ds_read_b128 a[204:207], v9 offset:0
s_cmp_eq_u32 s40, s41
s_cselect_b32 s40, s42, s40
v_mfma_f32_16x16x32_bf16 v[164:167], a[224:227], v[48:51], v[164:167]
ds_read_b128 a[208:211], v8 offset:4096
v_cvt_pk_bf16_f32 v178, v236, v237
v_mfma_f32_16x16x32_bf16 v[164:167], a[228:231], v[52:55], v[164:167]
ds_read_b128 a[212:215], v9 offset:4096
v_cvt_pk_bf16_f32 v179, v238, v239
v_mfma_f32_16x16x32_bf16 v[164:167], a[232:235], v[56:59], v[164:167]
ds_read_b64_tr_b16 a[216:217], v14 offset:0
v_cvt_pk_bf16_f32 v182, v240, v241
v_mfma_f32_16x16x32_bf16 v[164:167], a[236:239], v[60:63], v[164:167]
ds_read_b64_tr_b16 a[218:219], v14 offset:2048
v_cvt_pk_bf16_f32 v183, v242, v243
s_waitcnt lgkmcnt(7)
v_mfma_f32_16x16x32_bf16 a[60:63], a[252:255], v[200:203], a[60:63]
s_cbranch_vccnz L_slow_4
L_ret_4:
v_add_u32 v15, s43, v15
v_add_f32 v250, v244, v250
v_mfma_f32_16x16x32_bf16 a[124:127], a[252:255], v[204:207], a[124:127]
ds_read_b64_tr_b16 a[220:221], v15 offset:0
v_add_f32 v251, v245, v251
s_mov_b32 s55, 6
L_loop0:
v_mfma_f32_16x16x32_bf16 a[0:3], a[192:195], v[212:215], a[0:3]
ds_read_b64_tr_b16 a[222:223], v15 offset:2048
v_mfma_f32_16x16x32_bf16 a[64:67], a[192:195], v[216:219], a[64:67]
s_mov_b32 m0, s40
v_exp_f32 v236, v152
v_mfma_f32_16x16x32_bf16 a[128:131], a[192:195], v[220:223], a[128:131]
buffer_load_dwordx4 v4, s[16:19], s39 offen offset:0 nt lds
s_waitcnt lgkmcnt(4)
v_mfma_f32_16x16x32_bf16 a[4:7], a[196:199], v[212:215], a[4:7]
v_exp_f32 v237, v153
v_mfma_f32_16x16x32_bf16 a[68:71], a[196:199], v[216:219], a[68:71]
s_waitcnt lgkmcnt(2)
v_exp_f32 v238, v154
v_mfma_f32_16x16x32_bf16 a[132:135], a[196:199], v[220:223], a[132:135]
ds_read_b128 a[224:227], v8 offset:8192
v_cvt_pk_bf16_f32 v188, v236, v237
v_mfma_f32_16x16x32_bf16 v[128:131], a[200:203], v[32:35], v[224:227]
ds_read_b128 a[228:231], v9 offset:8192
v_add_f32 v247, v236, v237
v_mfma_f32_16x16x32_bf16 v[128:131], a[204:207], v[36:39], v[128:131]
ds_read_b128 a[232:235], v8 offset:12288
v_add_f32 v247, v238, v247
v_mfma_f32_16x16x32_bf16 v[128:131], a[208:211], v[40:43], v[128:131]
ds_read_b128 a[236:239], v9 offset:12288
s_bitcmp1_b64 s[48:49], 0
s_cselect_b32 s46, s45, s44
v_mfma_f32_16x16x32_bf16 v[128:131], a[212:215], v[44:47], v[128:131]
ds_read_b64_tr_b16 a[240:241], v12 offset:4096
s_lshr_b64 s[48:49], s[48:49], 1
v_mfma_f32_16x16x32_bf16 a[8:11], a[216:219], v[212:215], a[8:11]
ds_read_b64_tr_b16 a[242:243], v12 offset:6144
v_mfma_f32_16x16x32_bf16 a[72:75], a[216:219], v[216:219], a[72:75]
buffer_load_dwordx4 v4, s[16:19], s39 offen offset:1024 nt lds
v_mfma_f32_16x16x32_bf16 a[136:139], a[216:219], v[220:223], a[136:139]
ds_read_b64_tr_b16 a[244:245], v13 offset:4096
s_waitcnt lgkmcnt(6)
v_mfma_f32_16x16x32_bf16 a[12:15], a[220:223], v[212:215], a[12:15]
ds_read_b64_tr_b16 a[246:247], v13 offset:6144
v_mfma_f32_16x16x32_bf16 a[76:79], a[220:223], v[216:219], a[76:79]
v_exp_f32 v239, v155
v_mfma_f32_16x16x32_bf16 a[140:143], a[220:223], v[220:223], a[140:143]
v_exp_f32 v240, v156
v_mfma_f32_16x16x32_bf16 v[132:135], a[200:203], v[64:67], v[228:231]
v_exp_f32 v241, v157
v_mfma_f32_16x16x32_bf16 v[132:135], a[204:207], v[68:71], v[132:135]
buffer_load_dwordx4 v4, s[16:19], s39 offen offset:2048 nt lds
v_mfma_f32_16x16x32_bf16 v[132:135], a[208:211], v[72:75], v[132:135]
s_waitcnt lgkmcnt(2)
v_exp_f32 v236, v160
v_mfma_f32_16x16x32_bf16 v[132:135], a[212:215], v[76:79], v[132:135]
ds_read_b64_tr_b16 a[248:249], v14 offset:4096
v_cvt_pk_bf16_f32 v189, v238, v239
v_mfma_f32_16x16x32_bf16 v[132:135], a[224:227], v[80:83], v[132:135]
ds_read_b64_tr_b16 a[250:251], v14 offset:6144
v_add_f32 v248, v240, v241
v_mfma_f32_16x16x32_bf16 v[132:135], a[228:231], v[84:87], v[132:135]
s_waitcnt lgkmcnt(2)
v_exp_f32 v237, v161
v_mfma_f32_16x16x32_bf16 v[132:135], a[232:235], v[88:91], v[132:135]
ds_read_b64_tr_b16 a[252:253], v15 offset:4096
v_add_f32 v249, v236, v237
v_mfma_f32_16x16x32_bf16 v[132:135], a[236:239], v[92:95], v[132:135]
ds_read_b64_tr_b16 a[254:255], v15 offset:6144
v_add_f32 v247, v239, v247
v_mfma_f32_16x16x32_bf16 a[16:19], a[240:243], v[212:215], a[16:19]
buffer_load_dwordx4 v4, s[16:19], s39 offen offset:3072 nt lds
v_mfma_f32_16x16x32_bf16 a[80:83], a[240:243], v[216:219], a[80:83]
ds_read_b64_tr_b16 a[192:193], v12 offset:8192
s_add_u32 m0, s40, 16384
v_mfma_f32_16x16x32_bf16 a[144:147], a[240:243], v[220:223], a[144:147]
ds_read_b64_tr_b16 a[194:195], v12 offset:10240
s_add_u32 s39, s39, 16384
v_mfma_f32_16x16x32_bf16 a[20:23], a[244:247], v[212:215], a[20:23]
v_exp_f32 v242, v158
v_mfma_f32_16x16x32_bf16 a[84:87], a[244:247], v[216:219], a[84:87]
ds_read_b64_tr_b16 a[196:197], v13 offset:8192
v_cvt_pk_bf16_f32 v192, v240, v241
v_mfma_f32_16x16x32_bf16 a[148:151], a[244:247], v[220:223], a[148:151]
ds_read_b64_tr_b16 a[198:199], v13 offset:10240
v_add_f32 v248, v242, v248
v_mfma_f32_16x16x32_bf16 v[128:131], a[224:227], v[48:51], v[128:131]
buffer_load_dwordx4 v4, s[16:19], s39 offen offset:0 nt lds
v_mfma_f32_16x16x32_bf16 v[128:131], a[228:231], v[52:55], v[128:131]
ds_read_b128 a[200:203], v8 offset:2048
v_cvt_pk_bf16_f32 v196, v236, v237
v_mfma_f32_16x16x32_bf16 v[128:131], a[232:235], v[56:59], v[128:131]
ds_read_b128 a[204:207], v9 offset:2048
v_mfma_f32_16x16x32_bf16 v[128:131], a[236:239], v[60:63], v[128:131]
ds_read_b128 a[208:211], v8 offset:6144
s_waitcnt lgkmcnt(5)
v_mfma_f32_16x16x32_bf16 a[24:27], a[248:251], v[212:215], a[24:27]
ds_read_b128 a[212:215], v9 offset:6144
v_mfma_f32_16x16x32_bf16 a[88:91], a[248:251], v[216:219], a[88:91]
ds_read_b64_tr_b16 a[216:217], v14 offset:8192
v_mfma_f32_16x16x32_bf16 a[152:155], a[248:251], v[220:223], a[152:155]
ds_read_b64_tr_b16 a[218:219], v14 offset:10240
v_mfma_f32_16x16x32_bf16 a[28:31], a[252:255], v[212:215], a[28:31]
buffer_load_dwordx4 v4, s[16:19], s39 offen offset:1024 nt lds
v_mfma_f32_16x16x32_bf16 a[92:95], a[252:255], v[216:219], a[92:95]
ds_read_b64_tr_b16 a[220:221], v15 offset:8192
v_mfma_f32_16x16x32_bf16 a[156:159], a[252:255], v[220:223], a[156:159]
ds_read_b64_tr_b16 a[222:223], v15 offset:10240
v_mfma_f32_16x16x32_bf16 a[32:35], a[192:195], v[212:215], a[32:35]
v_exp_f32 v238, v162
v_mfma_f32_16x16x32_bf16 a[96:99], a[192:195], v[216:219], a[96:99]
v_exp_f32 v243, v159
v_mfma_f32_16x16x32_bf16 a[160:163], a[192:195], v[220:223], a[160:163]
s_waitcnt lgkmcnt(3)
v_exp_f32 v239, v163
v_mfma_f32_16x16x32_bf16 a[36:39], a[196:199], v[212:215], a[36:39]
buffer_load_dwordx4 v4, s[16:19], s39 offen offset:2048 nt lds
v_mfma_f32_16x16x32_bf16 a[100:103], a[196:199], v[216:219], a[100:103]
s_waitcnt lgkmcnt(2)
v_exp_f32 v240, v164
v_mfma_f32_16x16x32_bf16 a[164:167], a[196:199], v[220:223], a[164:167]
ds_read_b128 a[224:227], v8 offset:10240
v_add_f32 v249, v238, v249
v_mfma_f32_16x16x32_bf16 v[140:143], a[200:203], v[32:35], v[224:227]
ds_read_b128 a[228:231], v9 offset:10240
v_add_f32 v248, v243, v248
v_mfma_f32_16x16x32_bf16 v[140:143], a[204:207], v[36:39], v[140:143]
ds_read_b128 a[232:235], v8 offset:14336
v_add_f32 v249, v239, v249
v_mfma_f32_16x16x32_bf16 v[140:143], a[208:211], v[40:43], v[140:143]
ds_read_b128 a[236:239], v9 offset:14336
v_add_f32 v247, v240, v247
v_mfma_f32_16x16x32_bf16 v[140:143], a[212:215], v[44:47], v[140:143]
ds_read_b64_tr_b16 a[240:241], v12 offset:12288
v_cvt_pk_bf16_f32 v193, v242, v243
v_mfma_f32_16x16x32_bf16 a[40:43], a[216:219], v[212:215], a[40:43]
ds_read_b64_tr_b16 a[242:243], v12 offset:14336
v_add_u32 v12, s46, v12
v_mfma_f32_16x16x32_bf16 a[104:107], a[216:219], v[216:219], a[104:107]
buffer_load_dwordx4 v4, s[16:19], s39 offen offset:3072 nt lds
v_mfma_f32_16x16x32_bf16 a[168:171], a[216:219], v[220:223], a[168:171]
ds_read_b64_tr_b16 a[244:245], v13 offset:12288
v_add_u32 v8, s43, v8
s_waitcnt lgkmcnt(6)
v_mfma_f32_16x16x32_bf16 a[44:47], a[220:223], v[212:215], a[44:47]
ds_read_b64_tr_b16 a[246:247], v13 offset:14336
v_add_u32 v13, s46, v13
v_mfma_f32_16x16x32_bf16 a[108:111], a[220:223], v[216:219], a[108:111]
s_add_u32 s39, s39, 16384
v_exp_f32 v241, v165
v_mfma_f32_16x16x32_bf16 a[172:175], a[220:223], v[220:223], a[172:175]
s_add_u32 s40, s40, 32768
v_exp_f32 v236, v168
v_mfma_f32_16x16x32_bf16 v[144:147], a[200:203], v[64:67], v[228:231]
s_cmp_eq_u32 s40, s41
s_cselect_b32 s40, s42, s40
v_exp_f32 v242, v166
v_mfma_f32_16x16x32_bf16 v[144:147], a[204:207], v[68:71], v[144:147]
v_exp_f32 v243, v167
v_mfma_f32_16x16x32_bf16 v[144:147], a[208:211], v[72:75], v[144:147]
s_waitcnt lgkmcnt(2)
v_exp_f32 v237, v169
v_mfma_f32_16x16x32_bf16 v[144:147], a[212:215], v[76:79], v[144:147]
ds_read_b64_tr_b16 a[248:249], v14 offset:12288
v_cvt_pk_bf16_f32 v190, v240, v241
v_mfma_f32_16x16x32_bf16 v[144:147], a[224:227], v[80:83], v[144:147]
ds_read_b64_tr_b16 a[250:251], v14 offset:14336
v_add_f32 v247, v241, v247
v_mfma_f32_16x16x32_bf16 v[144:147], a[228:231], v[84:87], v[144:147]
v_exp_f32 v240, v172
v_mfma_f32_16x16x32_bf16 v[144:147], a[232:235], v[88:91], v[144:147]
ds_read_b64_tr_b16 a[252:253], v15 offset:12288
v_add_f32 v248, v236, v248
v_mfma_f32_16x16x32_bf16 v[144:147], a[236:239], v[92:95], v[144:147]
ds_read_b64_tr_b16 a[254:255], v15 offset:14336
v_add_f32 v249, v240, v249
v_mfma_f32_16x16x32_bf16 a[48:51], a[240:243], v[212:215], a[48:51]
v_exp_f32 v241, v173
v_mfma_f32_16x16x32_bf16 a[112:115], a[240:243], v[216:219], a[112:115]
v_cvt_pk_bf16_f32 v197, v238, v239
v_cvt_pk_bf16_f32 v191, v242, v243
v_mfma_f32_16x16x32_bf16 a[176:179], a[240:243], v[220:223], a[176:179]
s_waitcnt lgkmcnt(3)
v_exp_f32 v238, v170
v_mfma_f32_16x16x32_bf16 a[52:55], a[244:247], v[212:215], a[52:55]
v_exp_f32 v239, v171
v_mfma_f32_16x16x32_bf16 a[116:119], a[244:247], v[216:219], a[116:119]
v_add_f32 v247, v242, v247
v_add_f32 v248, v237, v248
v_mfma_f32_16x16x32_bf16 a[180:183], a[244:247], v[220:223], a[180:183]
s_waitcnt vmcnt(16) lgkmcnt(0)
s_barrier
v_add_f32 v249, v241, v249
v_mfma_f32_16x16x32_bf16 v[140:143], a[224:227], v[48:51], v[140:143]
ds_read_b64_tr_b16 a[192:193], v12 offset:0
v_add_u32 v9, s43, v9
v_mfma_f32_16x16x32_bf16 v[140:143], a[228:231], v[52:55], v[140:143]
ds_read_b64_tr_b16 a[194:195], v12 offset:2048
v_add_f32 v247, v243, v247
v_mfma_f32_16x16x32_bf16 v[140:143], a[232:235], v[56:59], v[140:143]
ds_read_b64_tr_b16 a[196:197], v13 offset:0
v_add_f32 v248, v238, v248
v_mfma_f32_16x16x32_bf16 v[140:143], a[236:239], v[60:63], v[140:143]
ds_read_b64_tr_b16 a[198:199], v13 offset:2048
v_add_f32 v248, v239, v248
v_mfma_f32_16x16x32_bf16 a[56:59], a[248:251], v[212:215], a[56:59]
ds_read_b128 a[200:203], v8 offset:0
v_add_u32 v14, s46, v14
v_mfma_f32_16x16x32_bf16 a[120:123], a[248:251], v[216:219], a[120:123]
ds_read_b128 a[204:207], v9 offset:0
v_cvt_pk_bf16_f32 v194, v236, v237
v_mfma_f32_16x16x32_bf16 a[184:187], a[248:251], v[220:223], a[184:187]
ds_read_b128 a[208:211], v8 offset:4096
v_cvt_pk_bf16_f32 v195, v238, v239
v_mfma_f32_16x16x32_bf16 a[60:63], a[252:255], v[212:215], a[60:63]
ds_read_b128 a[212:215], v9 offset:4096
v_cvt_pk_bf16_f32 v198, v240, v241
v_mfma_f32_16x16x32_bf16 a[124:127], a[252:255], v[216:219], a[124:127]
s_waitcnt lgkmcnt(4)
v_exp_f32 v242, v174
v_mfma_f32_16x16x32_bf16 a[188:191], a[252:255], v[220:223], a[188:191]
s_waitcnt lgkmcnt(5)
v_exp_f32 v243, v175
v_add_f32 v249, v242, v249
v_mfma_f32_16x16x32_bf16 a[0:3], a[192:195], v[176:179], a[0:3]
ds_read_b64_tr_b16 a[216:217], v14 offset:0
v_add_f32 v249, v243, v249
v_mfma_f32_16x16x32_bf16 a[64:67], a[192:195], v[180:183], a[64:67]
ds_read_b64_tr_b16 a[218:219], v14 offset:2048
v_max3_f32 v253, v247, v248, v249
v_mfma_f32_16x16x32_bf16 a[4:7], a[196:199], v[176:179], a[4:7]
v_cmp_lt_f32 vcc, s54, v253
v_cvt_pk_bf16_f32 v199, v242, v243
v_mfma_f32_16x16x32_bf16 a[68:71], a[196:199], v[180:183], a[68:71]
s_cbranch_vccnz L_slow_5
L_ret_5:
v_add_u32 v15, s46, v15
v_add_f32 v250, v247, v250
s_waitcnt lgkmcnt(3)
v_mfma_f32_16x16x32_bf16 v[152:155], a[200:203], v[32:35], v[224:227]
ds_read_b64_tr_b16 a[220:221], v15 offset:0
v_add_f32 v251, v248, v251
v_mfma_f32_16x16x32_bf16 v[152:155], a[204:207], v[36:39], v[152:155]
ds_read_b64_tr_b16 a[222:223], v15 offset:2048
v_add_f32 v252, v249, v252
v_mfma_f32_16x16x32_bf16 v[152:155], a[208:211], v[40:43], v[152:155]
ds_read_b128 a[224:227], v8 offset:8192
s_mov_b32 m0, s40
s_waitcnt lgkmcnt(5)
v_mfma_f32_16x16x32_bf16 v[152:155], a[212:215], v[44:47], v[152:155]
ds_read_b128 a[228:231], v9 offset:8192
s_waitcnt lgkmcnt(4)
v_mfma_f32_16x16x32_bf16 a[8:11], a[216:219], v[176:179], a[8:11]
ds_read_b128 a[232:235], v8 offset:12288
s_bitcmp1_b64 s[48:49], 0
s_cselect_b32 s46, s45, s44
v_mfma_f32_16x16x32_bf16 a[72:75], a[216:219], v[180:183], a[72:75]
ds_read_b128 a[236:239], v9 offset:12288
s_lshr_b64 s[48:49], s[48:49], 1
v_mfma_f32_16x16x32_bf16 v[156:159], a[200:203], v[64:67], v[228:231]
ds_read_b64_tr_b16 a[240:241], v12 offset:4096
v_mfma_f32_16x16x32_bf16 v[156:159], a[204:207], v[68:71], v[156:159]
ds_read_b64_tr_b16 a[242:243], v12 offset:6144
v_mfma_f32_16x16x32_bf16 v[156:159], a[208:211], v[72:75], v[156:159]
ds_read_b64_tr_b16 a[244:245], v13 offset:4096
v_mfma_f32_16x16x32_bf16 v[156:159], a[212:215], v[76:79], v[156:159]
ds_read_b64_tr_b16 a[246:247], v13 offset:6144
s_waitcnt lgkmcnt(7)
v_mfma_f32_16x16x32_bf16 a[12:15], a[220:223], v[176:179], a[12:15]
buffer_load_dwordx4 v2, s[12:15], s38 offen offset:0 nt lds
v_mfma_f32_16x16x32_bf16 a[76:79], a[220:223], v[180:183], a[76:79]
v_exp_f32 v236, v128
v_mfma_f32_16x16x32_bf16 v[160:163], a[200:203], v[96:99], v[232:235]
v_exp_f32 v237, v129
v_mfma_f32_16x16x32_bf16 v[160:163], a[204:207], v[100:103], v[160:163]
ds_read_b64_tr_b16 a[248:249], v14 offset:4096
v_add_f32 v244, v236, v237
v_mfma_f32_16x16x32_bf16 v[160:163], a[208:211], v[104:107], v[160:163]
ds_read_b64_tr_b16 a[250:251], v14 offset:6144
v_cvt_pk_bf16_f32 v200, v236, v237
v_mfma_f32_16x16x32_bf16 v[160:163], a[212:215], v[108:111], v[160:163]
s_waitcnt lgkmcnt(3)
v_exp_f32 v240, v132
v_mfma_f32_16x16x32_bf16 v[160:163], a[224:227], v[112:115], v[160:163]
buffer_load_dwordx4 v3, s[12:15], s38 offen offset:1024 nt lds
v_mfma_f32_16x16x32_bf16 v[160:163], a[228:231], v[116:119], v[160:163]
v_exp_f32 v241, v133
v_mfma_f32_16x16x32_bf16 v[160:163], a[232:235], v[120:123], v[160:163]
s_waitcnt lgkmcnt(2)
v_exp_f32 v238, v130
v_mfma_f32_16x16x32_bf16 v[160:163], a[236:239], v[124:127], v[160:163]
ds_read_b64_tr_b16 a[252:253], v15 offset:4096
v_add_f32 v245, v240, v241
v_mfma_f32_16x16x32_bf16 a[16:19], a[240:243], v[176:179], a[16:19]
ds_read_b64_tr_b16 a[254:255], v15 offset:6144
v_add_f32 v244, v238, v244
v_mfma_f32_16x16x32_bf16 a[80:83], a[240:243], v[180:183], a[80:83]
ds_read_b64_tr_b16 a[192:193], v12 offset:8192
v_cvt_pk_bf16_f32 v204, v240, v241
v_mfma_f32_16x16x32_bf16 a[20:23], a[244:247], v[176:179], a[20:23]
ds_read_b64_tr_b16 a[194:195], v12 offset:10240
v_mfma_f32_16x16x32_bf16 a[84:87], a[244:247], v[180:183], a[84:87]
ds_read_b64_tr_b16 a[196:197], v13 offset:8192
v_mfma_f32_16x16x32_bf16 v[156:159], a[224:227], v[80:83], v[156:159]
ds_read_b64_tr_b16 a[198:199], v13 offset:10240
v_mfma_f32_16x16x32_bf16 v[156:159], a[228:231], v[84:87], v[156:159]
ds_read_b128 a[200:203], v8 offset:2048
v_mfma_f32_16x16x32_bf16 v[156:159], a[232:235], v[88:91], v[156:159]
ds_read_b128 a[204:207], v9 offset:2048
v_mfma_f32_16x16x32_bf16 v[156:159], a[236:239], v[92:95], v[156:159]
ds_read_b128 a[208:211], v8 offset:6144
s_waitcnt lgkmcnt(7)
v_mfma_f32_16x16x32_bf16 a[24:27], a[248:251], v[176:179], a[24:27]
ds_read_b128 a[212:215], v9 offset:6144
v_mfma_f32_16x16x32_bf16 a[88:91], a[248:251], v[180:183], a[88:91]
ds_read_b64_tr_b16 a[216:217], v14 offset:8192
v_mfma_f32_16x16x32_bf16 v[152:155], a[224:227], v[48:51], v[152:155]
ds_read_b64_tr_b16 a[218:219], v14 offset:10240
v_mfma_f32_16x16x32_bf16 v[152:155], a[228:231], v[52:55], v[152:155]
buffer_load_dwordx4 v2, s[12:15], s38 offen offset:2048 nt lds
v_mfma_f32_16x16x32_bf16 v[152:155], a[232:235], v[56:59], v[152:155]
v_exp_f32 v242, v134
v_mfma_f32_16x16x32_bf16 v[152:155], a[236:239], v[60:63], v[152:155]
v_exp_f32 v239, v131
v_mfma_f32_16x16x32_bf16 a[28:31], a[252:255], v[176:179], a[28:31]
s_waitcnt lgkmcnt(3)
v_exp_f32 v243, v135
v_mfma_f32_16x16x32_bf16 a[92:95], a[252:255], v[180:183], a[92:95]
ds_read_b64_tr_b16 a[220:221], v15 offset:8192
v_add_f32 v245, v242, v245
v_mfma_f32_16x16x32_bf16 a[32:35], a[192:195], v[176:179], a[32:35]
ds_read_b64_tr_b16 a[222:223], v15 offset:10240
v_add_f32 v244, v239, v244
v_mfma_f32_16x16x32_bf16 a[96:99], a[192:195], v[180:183], a[96:99]
buffer_load_dwordx4 v3, s[12:15], s38 offen offset:3072 nt lds
v_mfma_f32_16x16x32_bf16 a[36:39], a[196:199], v[176:179], a[36:39]
s_add_u32 m0, s40, 16384
v_exp_f32 v236, v140
v_mfma_f32_16x16x32_bf16 a[100:103], a[196:199], v[180:183], a[100:103]
s_add_u32 s38, s38, 16384
v_exp_f32 v240, v144
v_mfma_f32_16x16x32_bf16 v[164:167], a[200:203], v[32:35], v[224:227]
s_waitcnt lgkmcnt(2)
v_exp_f32 v237, v141
v_mfma_f32_16x16x32_bf16 v[164:167], a[204:207], v[36:39], v[164:167]
ds_read_b128 a[224:227], v8 offset:10240
v_add_f32 v245, v243, v245
v_mfma_f32_16x16x32_bf16 v[164:167], a[208:211], v[40:43], v[164:167]
ds_read_b128 a[228:231], v9 offset:10240
v_add_f32 v244, v236, v244
v_mfma_f32_16x16x32_bf16 v[164:167], a[212:215], v[44:47], v[164:167]
ds_read_b128 a[232:235], v8 offset:14336
v_add_f32 v245, v240, v245
v_mfma_f32_16x16x32_bf16 a[40:43], a[216:219], v[176:179], a[40:43]
ds_read_b128 a[236:239], v9 offset:14336
v_add_u32 v8, s46, v8
v_mfma_f32_16x16x32_bf16 a[104:107], a[216:219], v[180:183], a[104:107]
ds_read_b64_tr_b16 a[240:241], v12 offset:12288
v_cvt_pk_bf16_f32 v201, v238, v239
v_mfma_f32_16x16x32_bf16 v[168:171], a[200:203], v[64:67], v[228:231]
ds_read_b64_tr_b16 a[242:243], v12 offset:14336
v_add_u32 v12, s43, v12
v_mfma_f32_16x16x32_bf16 v[168:171], a[204:207], v[68:71], v[168:171]
ds_read_b64_tr_b16 a[244:245], v13 offset:12288
v_cvt_pk_bf16_f32 v205, v242, v243
v_mfma_f32_16x16x32_bf16 v[168:171], a[208:211], v[72:75], v[168:171]
buffer_load_dwordx4 v2, s[12:15], s38 offen offset:0 nt lds
v_mfma_f32_16x16x32_bf16 v[168:171], a[212:215], v[76:79], v[168:171]
ds_read_b64_tr_b16 a[246:247], v13 offset:14336
v_add_u32 v13, s43, v13
s_waitcnt lgkmcnt(6)
v_mfma_f32_16x16x32_bf16 a[44:47], a[220:223], v[176:179], a[44:47]
v_exp_f32 v241, v145
v_mfma_f32_16x16x32_bf16 a[108:111], a[220:223], v[180:183], a[108:111]
v_exp_f32 v238, v142
v_mfma_f32_16x16x32_bf16 v[172:175], a[200:203], v[96:99], v[232:235]
v_exp_f32 v242, v146
v_mfma_f32_16x16x32_bf16 v[172:175], a[204:207], v[100:103], v[172:175]
ds_read_b64_tr_b16 a[248:249], v14 offset:12288
v_add_f32 v244, v237, v244
v_mfma_f32_16x16x32_bf16 v[172:175], a[208:211], v[104:107], v[172:175]
buffer_load_dwordx4 v3, s[12:15], s38 offen offset:1024 nt lds
v_mfma_f32_16x16x32_bf16 v[172:175], a[212:215], v[108:111], v[172:175]
ds_read_b64_tr_b16 a[250:251], v14 offset:14336
v_add_f32 v245, v241, v245
v_mfma_f32_16x16x32_bf16 v[172:175], a[224:227], v[112:115], v[172:175]
v_exp_f32 v239, v143
v_mfma_f32_16x16x32_bf16 v[172:175], a[228:231], v[116:119], v[172:175]
s_waitcnt lgkmcnt(2)
v_exp_f32 v243, v147
v_mfma_f32_16x16x32_bf16 v[172:175], a[232:235], v[120:123], v[172:175]
v_add_u32 v9, s46, v9
v_add_f32 v244, v238, v244
v_mfma_f32_16x16x32_bf16 v[172:175], a[236:239], v[124:127], v[172:175]
ds_read_b64_tr_b16 a[252:253], v15 offset:12288
v_add_f32 v245, v242, v245
v_mfma_f32_16x16x32_bf16 a[48:51], a[240:243], v[176:179], a[48:51]
buffer_load_dwordx4 v2, s[12:15], s38 offen offset:2048 nt lds
v_mfma_f32_16x16x32_bf16 a[112:115], a[240:243], v[180:183], a[112:115]
ds_read_b64_tr_b16 a[254:255], v15 offset:14336
v_add_f32 v244, v239, v244
v_mfma_f32_16x16x32_bf16 a[52:55], a[244:247], v[176:179], a[52:55]
ds_read_b64_tr_b16 a[192:193], v12 offset:0
v_add_f32 v245, v243, v245
v_mfma_f32_16x16x32_bf16 a[116:119], a[244:247], v[180:183], a[116:119]
ds_read_b64_tr_b16 a[194:195], v12 offset:2048
v_max_f32 v253, v244, v245
v_mfma_f32_16x16x32_bf16 v[168:171], a[224:227], v[80:83], v[168:171]
ds_read_b64_tr_b16 a[196:197], v13 offset:0
v_add_u32 v14, s43, v14
v_mfma_f32_16x16x32_bf16 v[168:171], a[228:231], v[84:87], v[168:171]
s_waitcnt vmcnt(15)
s_barrier
v_cmp_lt_f32 vcc, s54, v253
v_mfma_f32_16x16x32_bf16 v[168:171], a[232:235], v[88:91], v[168:171]
buffer_load_dwordx4 v3, s[12:15], s38 offen offset:3072 nt lds
v_mfma_f32_16x16x32_bf16 v[168:171], a[236:239], v[92:95], v[168:171]
ds_read_b64_tr_b16 a[198:199], v13 offset:2048
s_add_u32 s38, s38, 16384
s_waitcnt lgkmcnt(5)
v_mfma_f32_16x16x32_bf16 a[56:59], a[248:251], v[176:179], a[56:59]
ds_read_b128 a[200:203], v8 offset:0
s_add_u32 s40, s40, 32768
v_mfma_f32_16x16x32_bf16 a[120:123], a[248:251], v[180:183], a[120:123]
ds_read_b128 a[204:207], v9 offset:0
s_cmp_eq_u32 s40, s41
s_cselect_b32 s40, s42, s40
v_mfma_f32_16x16x32_bf16 v[164:167], a[224:227], v[48:51], v[164:167]
ds_read_b128 a[208:211], v8 offset:4096
v_cvt_pk_bf16_f32 v202, v236, v237
v_mfma_f32_16x16x32_bf16 v[164:167], a[228:231], v[52:55], v[164:167]
ds_read_b128 a[212:215], v9 offset:4096
v_cvt_pk_bf16_f32 v203, v238, v239
v_mfma_f32_16x16x32_bf16 v[164:167], a[232:235], v[56:59], v[164:167]
ds_read_b64_tr_b16 a[216:217], v14 offset:0
v_cvt_pk_bf16_f32 v206, v240, v241
v_mfma_f32_16x16x32_bf16 v[164:167], a[236:239], v[60:63], v[164:167]
ds_read_b64_tr_b16 a[218:219], v14 offset:2048
v_cvt_pk_bf16_f32 v207, v242, v243
s_waitcnt lgkmcnt(7)
v_mfma_f32_16x16x32_bf16 a[60:63], a[252:255], v[176:179], a[60:63]
s_cbranch_vccnz L_slow_6
L_ret_6:
v_add_u32 v15, s43, v15
v_add_f32 v250, v244, v250
v_mfma_f32_16x16x32_bf16 a[124:127], a[252:255], v[180:183], a[124:127]
ds_read_b64_tr_b16 a[220:221], v15 offset:0
v_add_f32 v251, v245, v251
v_mfma_f32_16x16x32_bf16 a[0:3], a[192:195], v[188:191], a[0:3]
ds_read_b64_tr_b16 a[222:223], v15 offset:2048
v_mfma_f32_16x16x32_bf16 a[64:67], a[192:195], v[192:195], a[64:67]
s_mov_b32 m0, s40
v_exp_f32 v236, v152
v_mfma_f32_16x16x32_bf16 a[128:131], a[192:195], v[196:199], a[128:131]
buffer_load_dwordx4 v4, s[16:19], s39 offen offset:0 nt lds
s_waitcnt lgkmcnt(4)
v_mfma_f32_16x16x32_bf16 a[4:7], a[196:199], v[188:191], a[4:7]
v_exp_f32 v237, v153
v_mfma_f32_16x16x32_bf16 a[68:71], a[196:199], v[192:195], a[68:71]
s_waitcnt lgkmcnt(2)
v_exp_f32 v238, v154
v_mfma_f32_16x16x32_bf16 a[132:135], a[196:199], v[196:199], a[132:135]
ds_read_b128 a[224:227], v8 offset:8192
v_cvt_pk_bf16_f32 v212, v236, v237
v_mfma_f32_16x16x32_bf16 v[128:131], a[200:203], v[32:35], v[224:227]
ds_read_b128 a[228:231], v9 offset:8192
v_add_f32 v247, v236, v237
v_mfma_f32_16x16x32_bf16 v[128:131], a[204:207], v[36:39], v[128:131]
ds_read_b128 a[232:235], v8 offset:12288
v_add_f32 v247, v238, v247
v_mfma_f32_16x16x32_bf16 v[128:131], a[208:211], v[40:43], v[128:131]
ds_read_b128 a[236:239], v9 offset:12288
s_bitcmp1_b64 s[48:49], 0
s_cselect_b32 s46, s45, s44
v_mfma_f32_16x16x32_bf16 v[128:131], a[212:215], v[44:47], v[128:131]
ds_read_b64_tr_b16 a[240:241], v12 offset:4096
s_lshr_b64 s[48:49], s[48:49], 1
v_mfma_f32_16x16x32_bf16 a[8:11], a[216:219], v[188:191], a[8:11]
ds_read_b64_tr_b16 a[242:243], v12 offset:6144
v_mfma_f32_16x16x32_bf16 a[72:75], a[216:219], v[192:195], a[72:75]
buffer_load_dwordx4 v4, s[16:19], s39 offen offset:1024 nt lds
v_mfma_f32_16x16x32_bf16 a[136:139], a[216:219], v[196:199], a[136:139]
ds_read_b64_tr_b16 a[244:245], v13 offset:4096
s_waitcnt lgkmcnt(6)
v_mfma_f32_16x16x32_bf16 a[12:15], a[220:223], v[188:191], a[12:15]
ds_read_b64_tr_b16 a[246:247], v13 offset:6144
v_mfma_f32_16x16x32_bf16 a[76:79], a[220:223], v[192:195], a[76:79]
v_exp_f32 v239, v155
v_mfma_f32_16x16x32_bf16 a[140:143], a[220:223], v[196:199], a[140:143]
v_exp_f32 v240, v156
v_mfma_f32_16x16x32_bf16 v[132:135], a[200:203], v[64:67], v[228:231]
v_exp_f32 v241, v157
v_mfma_f32_16x16x32_bf16 v[132:135], a[204:207], v[68:71], v[132:135]
buffer_load_dwordx4 v4, s[16:19], s39 offen offset:2048 nt lds
v_mfma_f32_16x16x32_bf16 v[132:135], a[208:211], v[72:75], v[132:135]
s_waitcnt lgkmcnt(2)
v_exp_f32 v236, v160
v_mfma_f32_16x16x32_bf16 v[132:135], a[212:215], v[76:79], v[132:135]
ds_read_b64_tr_b16 a[248:249], v14 offset:4096
v_cvt_pk_bf16_f32 v213, v238, v239
v_mfma_f32_16x16x32_bf16 v[132:135], a[224:227], v[80:83], v[132:135]
ds_read_b64_tr_b16 a[250:251], v14 offset:6144
v_add_f32 v248, v240, v241
v_mfma_f32_16x16x32_bf16 v[132:135], a[228:231], v[84:87], v[132:135]
s_waitcnt lgkmcnt(2)
v_exp_f32 v237, v161
v_mfma_f32_16x16x32_bf16 v[132:135], a[232:235], v[88:91], v[132:135]
ds_read_b64_tr_b16 a[252:253], v15 offset:4096
v_add_f32 v249, v236, v237
v_mfma_f32_16x16x32_bf16 v[132:135], a[236:239], v[92:95], v[132:135]
ds_read_b64_tr_b16 a[254:255], v15 offset:6144
v_add_f32 v247, v239, v247
v_mfma_f32_16x16x32_bf16 a[16:19], a[240:243], v[188:191], a[16:19]
buffer_load_dwordx4 v4, s[16:19], s39 offen offset:3072 nt lds
v_mfma_f32_16x16x32_bf16 a[80:83], a[240:243], v[192:195], a[80:83]
ds_read_b64_tr_b16 a[192:193], v12 offset:8192
s_add_u32 m0, s40, 16384
v_mfma_f32_16x16x32_bf16 a[144:147], a[240:243], v[196:199], a[144:147]
ds_read_b64_tr_b16 a[194:195], v12 offset:10240
s_add_u32 s39, s39, 16384
v_mfma_f32_16x16x32_bf16 a[20:23], a[244:247], v[188:191], a[20:23]
v_exp_f32 v242, v158
v_mfma_f32_16x16x32_bf16 a[84:87], a[244:247], v[192:195], a[84:87]
ds_read_b64_tr_b16 a[196:197], v13 offset:8192
v_cvt_pk_bf16_f32 v216, v240, v241
v_mfma_f32_16x16x32_bf16 a[148:151], a[244:247], v[196:199], a[148:151]
ds_read_b64_tr_b16 a[198:199], v13 offset:10240
v_add_f32 v248, v242, v248
v_mfma_f32_16x16x32_bf16 v[128:131], a[224:227], v[48:51], v[128:131]
buffer_load_dwordx4 v4, s[16:19], s39 offen offset:0 nt lds
v_mfma_f32_16x16x32_bf16 v[128:131], a[228:231], v[52:55], v[128:131]
ds_read_b128 a[200:203], v8 offset:2048
v_cvt_pk_bf16_f32 v220, v236, v237
v_mfma_f32_16x16x32_bf16 v[128:131], a[232:235], v[56:59], v[128:131]
ds_read_b128 a[204:207], v9 offset:2048
v_mfma_f32_16x16x32_bf16 v[128:131], a[236:239], v[60:63], v[128:131]
ds_read_b128 a[208:211], v8 offset:6144
s_waitcnt lgkmcnt(5)
v_mfma_f32_16x16x32_bf16 a[24:27], a[248:251], v[188:191], a[24:27]
ds_read_b128 a[212:215], v9 offset:6144
v_mfma_f32_16x16x32_bf16 a[88:91], a[248:251], v[192:195], a[88:91]
ds_read_b64_tr_b16 a[216:217], v14 offset:8192
v_mfma_f32_16x16x32_bf16 a[152:155], a[248:251], v[196:199], a[152:155]
ds_read_b64_tr_b16 a[218:219], v14 offset:10240
v_mfma_f32_16x16x32_bf16 a[28:31], a[252:255], v[188:191], a[28:31]
buffer_load_dwordx4 v4, s[16:19], s39 offen offset:1024 nt lds
v_mfma_f32_16x16x32_bf16 a[92:95], a[252:255], v[192:195], a[92:95]
ds_read_b64_tr_b16 a[220:221], v15 offset:8192
v_mfma_f32_16x16x32_bf16 a[156:159], a[252:255], v[196:199], a[156:159]
ds_read_b64_tr_b16 a[222:223], v15 offset:10240
v_mfma_f32_16x16x32_bf16 a[32:35], a[192:195], v[188:191], a[32:35]
v_exp_f32 v238, v162
v_mfma_f32_16x16x32_bf16 a[96:99], a[192:195], v[192:195], a[96:99]
v_exp_f32 v243, v159
v_mfma_f32_16x16x32_bf16 a[160:163], a[192:195], v[196:199], a[160:163]
s_waitcnt lgkmcnt(3)
v_exp_f32 v239, v163
v_mfma_f32_16x16x32_bf16 a[36:39], a[196:199], v[188:191], a[36:39]
buffer_load_dwordx4 v4, s[16:19], s39 offen offset:2048 nt lds
v_mfma_f32_16x16x32_bf16 a[100:103], a[196:199], v[192:195], a[100:103]
s_waitcnt lgkmcnt(2)
v_exp_f32 v240, v164
v_mfma_f32_16x16x32_bf16 a[164:167], a[196:199], v[196:199], a[164:167]
ds_read_b128 a[224:227], v8 offset:10240
v_add_f32 v249, v238, v249
v_mfma_f32_16x16x32_bf16 v[140:143], a[200:203], v[32:35], v[224:227]
ds_read_b128 a[228:231], v9 offset:10240
v_add_f32 v248, v243, v248
v_mfma_f32_16x16x32_bf16 v[140:143], a[204:207], v[36:39], v[140:143]
ds_read_b128 a[232:235], v8 offset:14336
v_add_f32 v249, v239, v249
v_mfma_f32_16x16x32_bf16 v[140:143], a[208:211], v[40:43], v[140:143]
ds_read_b128 a[236:239], v9 offset:14336
v_add_f32 v247, v240, v247
v_mfma_f32_16x16x32_bf16 v[140:143], a[212:215], v[44:47], v[140:143]
ds_read_b64_tr_b16 a[240:241], v12 offset:12288
v_cvt_pk_bf16_f32 v217, v242, v243
v_mfma_f32_16x16x32_bf16 a[40:43], a[216:219], v[188:191], a[40:43]
ds_read_b64_tr_b16 a[242:243], v12 offset:14336
v_add_u32 v12, s46, v12
v_mfma_f32_16x16x32_bf16 a[104:107], a[216:219], v[192:195], a[104:107]
buffer_load_dwordx4 v4, s[16:19], s39 offen offset:3072 nt lds
v_mfma_f32_16x16x32_bf16 a[168:171], a[216:219], v[196:199], a[168:171]
ds_read_b64_tr_b16 a[244:245], v13 offset:12288
v_add_u32 v8, s43, v8
s_waitcnt lgkmcnt(6)
v_mfma_f32_16x16x32_bf16 a[44:47], a[220:223], v[188:191], a[44:47]
ds_read_b64_tr_b16 a[246:247], v13 offset:14336
v_add_u32 v13, s46, v13
v_mfma_f32_16x16x32_bf16 a[108:111], a[220:223], v[192:195], a[108:111]
s_add_u32 s39, s39, 16384
v_exp_f32 v241, v165
v_mfma_f32_16x16x32_bf16 a[172:175], a[220:223], v[196:199], a[172:175]
s_add_u32 s40, s40, 32768
v_exp_f32 v236, v168
v_mfma_f32_16x16x32_bf16 v[144:147], a[200:203], v[64:67], v[228:231]
s_cmp_eq_u32 s40, s41
s_cselect_b32 s40, s42, s40
v_exp_f32 v242, v166
v_mfma_f32_16x16x32_bf16 v[144:147], a[204:207], v[68:71], v[144:147]
v_exp_f32 v243, v167
v_mfma_f32_16x16x32_bf16 v[144:147], a[208:211], v[72:75], v[144:147]
s_waitcnt lgkmcnt(2)
v_exp_f32 v237, v169
v_mfma_f32_16x16x32_bf16 v[144:147], a[212:215], v[76:79], v[144:147]
ds_read_b64_tr_b16 a[248:249], v14 offset:12288
v_cvt_pk_bf16_f32 v214, v240, v241
v_mfma_f32_16x16x32_bf16 v[144:147], a[224:227], v[80:83], v[144:147]
ds_read_b64_tr_b16 a[250:251], v14 offset:14336
v_add_f32 v247, v241, v247
v_mfma_f32_16x16x32_bf16 v[144:147], a[228:231], v[84:87], v[144:147]
v_exp_f32 v240, v172
v_mfma_f32_16x16x32_bf16 v[144:147], a[232:235], v[88:91], v[144:147]
ds_read_b64_tr_b16 a[252:253], v15 offset:12288
v_add_f32 v248, v236, v248
v_mfma_f32_16x16x32_bf16 v[144:147], a[236:239], v[92:95], v[144:147]
ds_read_b64_tr_b16 a[254:255], v15 offset:14336
v_add_f32 v249, v240, v249
v_mfma_f32_16x16x32_bf16 a[48:51], a[240:243], v[188:191], a[48:51]
v_exp_f32 v241, v173
v_mfma_f32_16x16x32_bf16 a[112:115], a[240:243], v[192:195], a[112:115]
v_cvt_pk_bf16_f32 v221, v238, v239
v_cvt_pk_bf16_f32 v215, v242, v243
v_mfma_f32_16x16x32_bf16 a[176:179], a[240:243], v[196:199], a[176:179]
s_waitcnt lgkmcnt(3)
v_exp_f32 v238, v170
v_mfma_f32_16x16x32_bf16 a[52:55], a[244:247], v[188:191], a[52:55]
v_exp_f32 v239, v171
v_mfma_f32_16x16x32_bf16 a[116:119], a[244:247], v[192:195], a[116:119]
v_add_f32 v247, v242, v247
v_add_f32 v248, v237, v248
v_mfma_f32_16x16x32_bf16 a[180:183], a[244:247], v[196:199], a[180:183]
s_waitcnt vmcnt(16) lgkmcnt(0)
s_barrier
v_add_f32 v249, v241, v249
v_mfma_f32_16x16x32_bf16 v[140:143], a[224:227], v[48:51], v[140:143]
ds_read_b64_tr_b16 a[192:193], v12 offset:0
v_add_u32 v9, s43, v9
v_mfma_f32_16x16x32_bf16 v[140:143], a[228:231], v[52:55], v[140:143]
ds_read_b64_tr_b16 a[194:195], v12 offset:2048
v_add_f32 v247, v243, v247
v_mfma_f32_16x16x32_bf16 v[140:143], a[232:235], v[56:59], v[140:143]
ds_read_b64_tr_b16 a[196:197], v13 offset:0
v_add_f32 v248, v238, v248
v_mfma_f32_16x16x32_bf16 v[140:143], a[236:239], v[60:63], v[140:143]
ds_read_b64_tr_b16 a[198:199], v13 offset:2048
v_add_f32 v248, v239, v248
v_mfma_f32_16x16x32_bf16 a[56:59], a[248:251], v[188:191], a[56:59]
ds_read_b128 a[200:203], v8 offset:0
v_add_u32 v14, s46, v14
v_mfma_f32_16x16x32_bf16 a[120:123], a[248:251], v[192:195], a[120:123]
ds_read_b128 a[204:207], v9 offset:0
v_cvt_pk_bf16_f32 v218, v236, v237
v_mfma_f32_16x16x32_bf16 a[184:187], a[248:251], v[196:199], a[184:187]
ds_read_b128 a[208:211], v8 offset:4096
v_cvt_pk_bf16_f32 v219, v238, v239
v_mfma_f32_16x16x32_bf16 a[60:63], a[252:255], v[188:191], a[60:63]
ds_read_b128 a[212:215], v9 offset:4096
v_cvt_pk_bf16_f32 v222, v240, v241
v_mfma_f32_16x16x32_bf16 a[124:127], a[252:255], v[192:195], a[124:127]
s_waitcnt lgkmcnt(4)
v_exp_f32 v242, v174
v_mfma_f32_16x16x32_bf16 a[188:191], a[252:255], v[196:199], a[188:191]
s_waitcnt lgkmcnt(5)
v_exp_f32 v243, v175
v_add_f32 v249, v242, v249
s_sub_u32 s55, s55, 1
s_cmp_eq_u32 s55, 0
s_cbranch_scc1 L_exit0
v_mfma_f32_16x16x32_bf16 a[0:3], a[192:195], v[200:203], a[0:3]
ds_read_b64_tr_b16 a[216:217], v14 offset:0
v_add_f32 v249, v243, v249
v_mfma_f32_16x16x32_bf16 a[64:67], a[192:195], v[204:207], a[64:67]
ds_read_b64_tr_b16 a[218:219], v14 offset:2048
v_max3_f32 v253, v247, v248, v249
v_mfma_f32_16x16x32_bf16 a[4:7], a[196:199], v[200:203], a[4:7]
v_cmp_lt_f32 vcc, s54, v253
v_cvt_pk_bf16_f32 v223, v242, v243
v_mfma_f32_16x16x32_bf16 a[68:71], a[196:199], v[204:207], a[68:71]
s_cbranch_vccnz L_slow_7
L_ret_7:
v_add_u32 v15, s46, v15
v_add_f32 v250, v247, v250
s_waitcnt lgkmcnt(3)
v_mfma_f32_16x16x32_bf16 v[152:155], a[200:203], v[32:35], v[224:227]
ds_read_b64_tr_b16 a[220:221], v15 offset:0
v_add_f32 v251, v248, v251
v_mfma_f32_16x16x32_bf16 v[152:155], a[204:207], v[36:39], v[152:155]
ds_read_b64_tr_b16 a[222:223], v15 offset:2048
v_add_f32 v252, v249, v252
v_mfma_f32_16x16x32_bf16 v[152:155], a[208:211], v[40:43], v[152:155]
ds_read_b128 a[224:227], v8 offset:8192
s_mov_b32 m0, s40
s_waitcnt lgkmcnt(5)
v_mfma_f32_16x16x32_bf16 v[152:155], a[212:215], v[44:47], v[152:155]
ds_read_b128 a[228:231], v9 offset:8192
s_waitcnt lgkmcnt(4)
v_mfma_f32_16x16x32_bf16 a[8:11], a[216:219], v[200:203], a[8:11]
ds_read_b128 a[232:235], v8 offset:12288
s_bitcmp1_b64 s[48:49], 0
s_cselect_b32 s46, s45, s44
v_mfma_f32_16x16x32_bf16 a[72:75], a[216:219], v[204:207], a[72:75]
ds_read_b128 a[236:239], v9 offset:12288
s_lshr_b64 s[48:49], s[48:49], 1
v_mfma_f32_16x16x32_bf16 v[156:159], a[200:203], v[64:67], v[228:231]
ds_read_b64_tr_b16 a[240:241], v12 offset:4096
v_mfma_f32_16x16x32_bf16 v[156:159], a[204:207], v[68:71], v[156:159]
ds_read_b64_tr_b16 a[242:243], v12 offset:6144
v_mfma_f32_16x16x32_bf16 v[156:159], a[208:211], v[72:75], v[156:159]
ds_read_b64_tr_b16 a[244:245], v13 offset:4096
v_mfma_f32_16x16x32_bf16 v[156:159], a[212:215], v[76:79], v[156:159]
ds_read_b64_tr_b16 a[246:247], v13 offset:6144
s_waitcnt lgkmcnt(7)
v_mfma_f32_16x16x32_bf16 a[12:15], a[220:223], v[200:203], a[12:15]
buffer_load_dwordx4 v2, s[12:15], s38 offen offset:0 nt lds
v_mfma_f32_16x16x32_bf16 a[76:79], a[220:223], v[204:207], a[76:79]
v_exp_f32 v236, v128
v_mfma_f32_16x16x32_bf16 v[160:163], a[200:203], v[96:99], v[232:235]
v_exp_f32 v237, v129
v_mfma_f32_16x16x32_bf16 v[160:163], a[204:207], v[100:103], v[160:163]
ds_read_b64_tr_b16 a[248:249], v14 offset:4096
v_add_f32 v244, v236, v237
v_mfma_f32_16x16x32_bf16 v[160:163], a[208:211], v[104:107], v[160:163]
ds_read_b64_tr_b16 a[250:251], v14 offset:6144
v_cvt_pk_bf16_f32 v176, v236, v237
v_mfma_f32_16x16x32_bf16 v[160:163], a[212:215], v[108:111], v[160:163]
s_waitcnt lgkmcnt(3)
v_exp_f32 v240, v132
v_mfma_f32_16x16x32_bf16 v[160:163], a[224:227], v[112:115], v[160:163]
buffer_load_dwordx4 v3, s[12:15], s38 offen offset:1024 nt lds
v_mfma_f32_16x16x32_bf16 v[160:163], a[228:231], v[116:119], v[160:163]
v_exp_f32 v241, v133
v_mfma_f32_16x16x32_bf16 v[160:163], a[232:235], v[120:123], v[160:163]
s_waitcnt lgkmcnt(2)
v_exp_f32 v238, v130
v_mfma_f32_16x16x32_bf16 v[160:163], a[236:239], v[124:127], v[160:163]
ds_read_b64_tr_b16 a[252:253], v15 offset:4096
v_add_f32 v245, v240, v241
v_mfma_f32_16x16x32_bf16 a[16:19], a[240:243], v[200:203], a[16:19]
ds_read_b64_tr_b16 a[254:255], v15 offset:6144
v_add_f32 v244, v238, v244
v_mfma_f32_16x16x32_bf16 a[80:83], a[240:243], v[204:207], a[80:83]
ds_read_b64_tr_b16 a[192:193], v12 offset:8192
v_cvt_pk_bf16_f32 v180, v240, v241
v_mfma_f32_16x16x32_bf16 a[20:23], a[244:247], v[200:203], a[20:23]
ds_read_b64_tr_b16 a[194:195], v12 offset:10240
v_mfma_f32_16x16x32_bf16 a[84:87], a[244:247], v[204:207], a[84:87]
ds_read_b64_tr_b16 a[196:197], v13 offset:8192
v_mfma_f32_16x16x32_bf16 v[156:159], a[224:227], v[80:83], v[156:159]
ds_read_b64_tr_b16 a[198:199], v13 offset:10240
v_mfma_f32_16x16x32_bf16 v[156:159], a[228:231], v[84:87], v[156:159]
ds_read_b128 a[200:203], v8 offset:2048
v_mfma_f32_16x16x32_bf16 v[156:159], a[232:235], v[88:91], v[156:159]
ds_read_b128 a[204:207], v9 offset:2048
v_mfma_f32_16x16x32_bf16 v[156:159], a[236:239], v[92:95], v[156:159]
ds_read_b128 a[208:211], v8 offset:6144
s_waitcnt lgkmcnt(7)
v_mfma_f32_16x16x32_bf16 a[24:27], a[248:251], v[200:203], a[24:27]
ds_read_b128 a[212:215], v9 offset:6144
v_mfma_f32_16x16x32_bf16 a[88:91], a[248:251], v[204:207], a[88:91]
ds_read_b64_tr_b16 a[216:217], v14 offset:8192
v_mfma_f32_16x16x32_bf16 v[152:155], a[224:227], v[48:51], v[152:155]
ds_read_b64_tr_b16 a[218:219], v14 offset:10240
v_mfma_f32_16x16x32_bf16 v[152:155], a[228:231], v[52:55], v[152:155]
buffer_load_dwordx4 v2, s[12:15], s38 offen offset:2048 nt lds
v_mfma_f32_16x16x32_bf16 v[152:155], a[232:235], v[56:59], v[152:155]
v_exp_f32 v242, v134
v_mfma_f32_16x16x32_bf16 v[152:155], a[236:239], v[60:63], v[152:155]
v_exp_f32 v239, v131
v_mfma_f32_16x16x32_bf16 a[28:31], a[252:255], v[200:203], a[28:31]
s_waitcnt lgkmcnt(3)
v_exp_f32 v243, v135
v_mfma_f32_16x16x32_bf16 a[92:95], a[252:255], v[204:207], a[92:95]
ds_read_b64_tr_b16 a[220:221], v15 offset:8192
v_add_f32 v245, v242, v245
v_mfma_f32_16x16x32_bf16 a[32:35], a[192:195], v[200:203], a[32:35]
ds_read_b64_tr_b16 a[222:223], v15 offset:10240
v_add_f32 v244, v239, v244
v_mfma_f32_16x16x32_bf16 a[96:99], a[192:195], v[204:207], a[96:99]
buffer_load_dwordx4 v3, s[12:15], s38 offen offset:3072 nt lds
v_mfma_f32_16x16x32_bf16 a[36:39], a[196:199], v[200:203], a[36:39]
s_add_u32 m0, s40, 16384
v_exp_f32 v236, v140
v_mfma_f32_16x16x32_bf16 a[100:103], a[196:199], v[204:207], a[100:103]
s_add_u32 s38, s38, 16384
v_exp_f32 v240, v144
v_mfma_f32_16x16x32_bf16 v[164:167], a[200:203], v[32:35], v[224:227]
s_waitcnt lgkmcnt(2)
v_exp_f32 v237, v141
v_mfma_f32_16x16x32_bf16 v[164:167], a[204:207], v[36:39], v[164:167]
ds_read_b128 a[224:227], v8 offset:10240
v_add_f32 v245, v243, v245
v_mfma_f32_16x16x32_bf16 v[164:167], a[208:211], v[40:43], v[164:167]
ds_read_b128 a[228:231], v9 offset:10240
v_add_f32 v244, v236, v244
v_mfma_f32_16x16x32_bf16 v[164:167], a[212:215], v[44:47], v[164:167]
ds_read_b128 a[232:235], v8 offset:14336
v_add_f32 v245, v240, v245
v_mfma_f32_16x16x32_bf16 a[40:43], a[216:219], v[200:203], a[40:43]
ds_read_b128 a[236:239], v9 offset:14336
v_add_u32 v8, s46, v8
v_mfma_f32_16x16x32_bf16 a[104:107], a[216:219], v[204:207], a[104:107]
ds_read_b64_tr_b16 a[240:241], v12 offset:12288
v_cvt_pk_bf16_f32 v177, v238, v239
v_mfma_f32_16x16x32_bf16 v[168:171], a[200:203], v[64:67], v[228:231]
ds_read_b64_tr_b16 a[242:243], v12 offset:14336
v_add_u32 v12, s43, v12
v_mfma_f32_16x16x32_bf16 v[168:171], a[204:207], v[68:71], v[168:171]
ds_read_b64_tr_b16 a[244:245], v13 offset:12288
v_cvt_pk_bf16_f32 v181, v242, v243
v_mfma_f32_16x16x32_bf16 v[168:171], a[208:211], v[72:75], v[168:171]
buffer_load_dwordx4 v2, s[12:15], s38 offen offset:0 nt lds
v_mfma_f32_16x16x32_bf16 v[168:171], a[212:215], v[76:79], v[168:171]
ds_read_b64_tr_b16 a[246:247], v13 offset:14336
v_add_u32 v13, s43, v13
s_waitcnt lgkmcnt(6)
v_mfma_f32_16x16x32_bf16 a[44:47], a[220:223], v[200:203], a[44:47]
v_exp_f32 v241, v145
v_mfma_f32_16x16x32_bf16 a[108:111], a[220:223], v[204:207], a[108:111]
v_exp_f32 v238, v142
v_mfma_f32_16x16x32_bf16 v[172:175], a[200:203], v[96:99], v[232:235]
v_exp_f32 v242, v146
v_mfma_f32_16x16x32_bf16 v[172:175], a[204:207], v[100:103], v[172:175]
ds_read_b64_tr_b16 a[248:249], v14 offset:12288
v_add_f32 v244, v237, v244
v_mfma_f32_16x16x32_bf16 v[172:175], a[208:211], v[104:107], v[172:175]
buffer_load_dwordx4 v3, s[12:15], s38 offen offset:1024 nt lds
v_mfma_f32_16x16x32_bf16 v[172:175], a[212:215], v[108:111], v[172:175]
ds_read_b64_tr_b16 a[250:251], v14 offset:14336
v_add_f32 v245, v241, v245
v_mfma_f32_16x16x32_bf16 v[172:175], a[224:227], v[112:115], v[172:175]
v_exp_f32 v239, v143
v_mfma_f32_16x16x32_bf16 v[172:175], a[228:231], v[116:119], v[172:175]
s_waitcnt lgkmcnt(2)
v_exp_f32 v243, v147
v_mfma_f32_16x16x32_bf16 v[172:175], a[232:235], v[120:123], v[172:175]
v_add_u32 v9, s46, v9
v_add_f32 v244, v238, v244
v_mfma_f32_16x16x32_bf16 v[172:175], a[236:239], v[124:127], v[172:175]
ds_read_b64_tr_b16 a[252:253], v15 offset:12288
v_add_f32 v245, v242, v245
v_mfma_f32_16x16x32_bf16 a[48:51], a[240:243], v[200:203], a[48:51]
buffer_load_dwordx4 v2, s[12:15], s38 offen offset:2048 nt lds
v_mfma_f32_16x16x32_bf16 a[112:115], a[240:243], v[204:207], a[112:115]
ds_read_b64_tr_b16 a[254:255], v15 offset:14336
v_add_f32 v244, v239, v244
v_mfma_f32_16x16x32_bf16 a[52:55], a[244:247], v[200:203], a[52:55]
ds_read_b64_tr_b16 a[192:193], v12 offset:0
v_add_f32 v245, v243, v245
v_mfma_f32_16x16x32_bf16 a[116:119], a[244:247], v[204:207], a[116:119]
ds_read_b64_tr_b16 a[194:195], v12 offset:2048
v_max_f32 v253, v244, v245
v_mfma_f32_16x16x32_bf16 v[168:171], a[224:227], v[80:83], v[168:171]
ds_read_b64_tr_b16 a[196:197], v13 offset:0
v_add_u32 v14, s43, v14
v_mfma_f32_16x16x32_bf16 v[168:171], a[228:231], v[84:87], v[168:171]
s_waitcnt vmcnt(15)
s_barrier
v_cmp_lt_f32 vcc, s54, v253
v_mfma_f32_16x16x32_bf16 v[168:171], a[232:235], v[88:91], v[168:171]
buffer_load_dwordx4 v3, s[12:15], s38 offen offset:3072 nt lds
v_mfma_f32_16x16x32_bf16 v[168:171], a[236:239], v[92:95], v[168:171]
ds_read_b64_tr_b16 a[198:199], v13 offset:2048
s_add_u32 s38, s38, 16384
s_waitcnt lgkmcnt(5)
v_mfma_f32_16x16x32_bf16 a[56:59], a[248:251], v[200:203], a[56:59]
ds_read_b128 a[200:203], v8 offset:0
s_add_u32 s40, s40, 32768
v_mfma_f32_16x16x32_bf16 a[120:123], a[248:251], v[204:207], a[120:123]
ds_read_b128 a[204:207], v9 offset:0
s_cmp_eq_u32 s40, s41
s_cselect_b32 s40, s42, s40
v_mfma_f32_16x16x32_bf16 v[164:167], a[224:227], v[48:51], v[164:167]
ds_read_b128 a[208:211], v8 offset:4096
v_cvt_pk_bf16_f32 v178, v236, v237
v_mfma_f32_16x16x32_bf16 v[164:167], a[228:231], v[52:55], v[164:167]
ds_read_b128 a[212:215], v9 offset:4096
v_cvt_pk_bf16_f32 v179, v238, v239
v_mfma_f32_16x16x32_bf16 v[164:167], a[232:235], v[56:59], v[164:167]
ds_read_b64_tr_b16 a[216:217], v14 offset:0
v_cvt_pk_bf16_f32 v182, v240, v241
v_mfma_f32_16x16x32_bf16 v[164:167], a[236:239], v[60:63], v[164:167]
ds_read_b64_tr_b16 a[218:219], v14 offset:2048
v_cvt_pk_bf16_f32 v183, v242, v243
s_waitcnt lgkmcnt(7)
v_mfma_f32_16x16x32_bf16 a[60:63], a[252:255], v[200:203], a[60:63]
s_cbranch_vccnz L_slow_8
L_ret_8:
v_add_u32 v15, s43, v15
v_add_f32 v250, v244, v250
v_mfma_f32_16x16x32_bf16 a[124:127], a[252:255], v[204:207], a[124:127]
ds_read_b64_tr_b16 a[220:221], v15 offset:0
v_add_f32 v251, v245, v251
s_branch L_loop0
L_exit0:
v_mfma_f32_16x16x32_bf16 a[0:3], a[192:195], v[200:203], a[0:3]
ds_read_b64_tr_b16 a[216:217], v14 offset:0
v_add_f32 v249, v243, v249
v_mfma_f32_16x16x32_bf16 a[64:67], a[192:195], v[204:207], a[64:67]
ds_read_b64_tr_b16 a[218:219], v14 offset:2048
v_max3_f32 v253, v247, v248, v249
v_mfma_f32_16x16x32_bf16 a[4:7], a[196:199], v[200:203], a[4:7]
v_cmp_lt_f32 vcc, s54, v253
v_cvt_pk_bf16_f32 v223, v242, v243
v_mfma_f32_16x16x32_bf16 a[68:71], a[196:199], v[204:207], a[68:71]
s_cbranch_vccnz L_slow_27
L_ret_27:
v_add_u32 v15, s46, v15
v_add_f32 v250, v247, v250
s_waitcnt lgkmcnt(3)
v_mfma_f32_16x16x32_bf16 v[152:155], a[200:203], v[32:35], v[224:227]
ds_read_b64_tr_b16 a[220:221], v15 offset:0
v_add_f32 v251, v248, v251
v_mfma_f32_16x16x32_bf16 v[152:155], a[204:207], v[36:39], v[152:155]
ds_read_b64_tr_b16 a[222:223], v15 offset:2048
v_add_f32 v252, v249, v252
v_mfma_f32_16x16x32_bf16 v[152:155], a[208:211], v[40:43], v[152:155]
ds_read_b128 a[224:227], v8 offset:8192
s_add_u32 m0, s63, 65536
s_waitcnt lgkmcnt(5)
v_mfma_f32_16x16x32_bf16 v[152:155], a[212:215], v[44:47], v[152:155]
ds_read_b128 a[228:231], v9 offset:8192
s_add_u32 s50, s47, 0
s_waitcnt lgkmcnt(4)
v_mfma_f32_16x16x32_bf16 a[8:11], a[216:219], v[200:203], a[8:11]
ds_read_b128 a[232:235], v8 offset:12288
s_bitcmp1_b64 s[48:49], 0
s_cselect_b32 s46, s45, s44
v_mfma_f32_16x16x32_bf16 a[72:75], a[216:219], v[204:207], a[72:75]
ds_read_b128 a[236:239], v9 offset:12288
s_lshr_b64 s[48:49], s[48:49], 1
v_mfma_f32_16x16x32_bf16 v[156:159], a[200:203], v[64:67], v[228:231]
ds_read_b64_tr_b16 a[240:241], v12 offset:4096
s_getpc_b64 s[52:53]
v_mfma_f32_16x16x32_bf16 v[156:159], a[204:207], v[68:71], v[156:159]
ds_read_b64_tr_b16 a[242:243], v12 offset:6144
s_lshl_b32 s51, s32, 13
v_mfma_f32_16x16x32_bf16 v[156:159], a[208:211], v[72:75], v[156:159]
ds_read_b64_tr_b16 a[244:245], v13 offset:4096
v_lshlrev_b32 v31, 7, v1
v_mfma_f32_16x16x32_bf16 v[156:159], a[212:215], v[76:79], v[156:159]
ds_read_b64_tr_b16 a[246:247], v13 offset:6144
v_add_u32 v31, s51, v31
s_waitcnt lgkmcnt(7)
v_mfma_f32_16x16x32_bf16 a[12:15], a[220:223], v[200:203], a[12:15]
buffer_load_dwordx4 v5, s[24:27], s50 offen offset:0 lds
v_mfma_f32_16x16x32_bf16 a[76:79], a[220:223], v[204:207], a[76:79]
s_add_u32 s50, s47, 6144
v_exp_f32 v236, v128
v_mfma_f32_16x16x32_bf16 v[160:163], a[200:203], v[96:99], v[232:235]
v_exp_f32 v237, v129
v_mfma_f32_16x16x32_bf16 v[160:163], a[204:207], v[100:103], v[160:163]
ds_read_b64_tr_b16 a[248:249], v14 offset:4096
v_add_f32 v244, v236, v237
v_mfma_f32_16x16x32_bf16 v[160:163], a[208:211], v[104:107], v[160:163]
ds_read_b64_tr_b16 a[250:251], v14 offset:6144
v_cvt_pk_bf16_f32 v176, v236, v237
v_mfma_f32_16x16x32_bf16 v[160:163], a[212:215], v[108:111], v[160:163]
s_waitcnt lgkmcnt(3)
v_exp_f32 v240, v132
v_mfma_f32_16x16x32_bf16 v[160:163], a[224:227], v[112:115], v[160:163]
buffer_load_dwordx4 v5, s[24:27], s50 offen offset:1024 lds
v_mfma_f32_16x16x32_bf16 v[160:163], a[228:231], v[116:119], v[160:163]
s_add_u32 s50, s47, 12288
v_exp_f32 v241, v133
v_mfma_f32_16x16x32_bf16 v[160:163], a[232:235], v[120:123], v[160:163]
s_waitcnt lgkmcnt(2)
v_exp_f32 v238, v130
v_mfma_f32_16x16x32_bf16 v[160:163], a[236:239], v[124:127], v[160:163]
ds_read_b64_tr_b16 a[252:253], v15 offset:4096
v_add_f32 v245, v240, v241
v_mfma_f32_16x16x32_bf16 a[16:19], a[240:243], v[200:203], a[16:19]
ds_read_b64_tr_b16 a[254:255], v15 offset:6144
v_add_f32 v244, v238, v244
v_mfma_f32_16x16x32_bf16 a[80:83], a[240:243], v[204:207], a[80:83]
ds_read_b64_tr_b16 a[192:193], v12 offset:8192
v_cvt_pk_bf16_f32 v180, v240, v241
v_mfma_f32_16x16x32_bf16 a[20:23], a[244:247], v[200:203], a[20:23]
ds_read_b64_tr_b16 a[194:195], v12 offset:10240
v_min_u32 v31, 23000, v31
v_mfma_f32_16x16x32_bf16 a[84:87], a[244:247], v[204:207], a[84:87]
ds_read_b64_tr_b16 a[196:197], v13 offset:8192
v_mfma_f32_16x16x32_bf16 v[156:159], a[224:227], v[80:83], v[156:159]
ds_read_b64_tr_b16 a[198:199], v13 offset:10240
v_mfma_f32_16x16x32_bf16 v[156:159], a[228:231], v[84:87], v[156:159]
ds_read_b128 a[200:203], v8 offset:2048
v_mfma_f32_16x16x32_bf16 v[156:159], a[232:235], v[88:91], v[156:159]
ds_read_b128 a[204:207], v9 offset:2048
v_mfma_f32_16x16x32_bf16 v[156:159], a[236:239], v[92:95], v[156:159]
ds_read_b128 a[208:211], v8 offset:6144
s_waitcnt lgkmcnt(7)
v_mfma_f32_16x16x32_bf16 a[24:27], a[248:251], v[200:203], a[24:27]
ds_read_b128 a[212:215], v9 offset:6144
v_mfma_f32_16x16x32_bf16 a[88:91], a[248:251], v[204:207], a[88:91]
ds_read_b64_tr_b16 a[216:217], v14 offset:8192
v_mfma_f32_16x16x32_bf16 v[152:155], a[224:227], v[48:51], v[152:155]
ds_read_b64_tr_b16 a[218:219], v14 offset:10240
v_mfma_f32_16x16x32_bf16 v[152:155], a[228:231], v[52:55], v[152:155]
buffer_load_dwordx4 v5, s[24:27], s50 offen offset:2048 lds
v_mfma_f32_16x16x32_bf16 v[152:155], a[232:235], v[56:59], v[152:155]
s_add_u32 s50, s47, 18432
v_exp_f32 v242, v134
v_mfma_f32_16x16x32_bf16 v[152:155], a[236:239], v[60:63], v[152:155]
v_exp_f32 v239, v131
v_mfma_f32_16x16x32_bf16 a[28:31], a[252:255], v[200:203], a[28:31]
s_waitcnt lgkmcnt(3)
v_exp_f32 v243, v135
v_mfma_f32_16x16x32_bf16 a[92:95], a[252:255], v[204:207], a[92:95]
ds_read_b64_tr_b16 a[220:221], v15 offset:8192
v_add_f32 v245, v242, v245
v_mfma_f32_16x16x32_bf16 a[32:35], a[192:195], v[200:203], a[32:35]
ds_read_b64_tr_b16 a[222:223], v15 offset:10240
v_add_f32 v244, v239, v244
v_mfma_f32_16x16x32_bf16 a[96:99], a[192:195], v[204:207], a[96:99]
buffer_load_dwordx4 v5, s[24:27], s50 offen offset:3072 lds
v_mfma_f32_16x16x32_bf16 a[36:39], a[196:199], v[200:203], a[36:39]
s_add_u32 m0, s63, 69632
v_exp_f32 v236, v140
v_mfma_f32_16x16x32_bf16 a[100:103], a[196:199], v[204:207], a[100:103]
s_add_u32 s50, s47, 28672
v_exp_f32 v240, v144
v_mfma_f32_16x16x32_bf16 v[164:167], a[200:203], v[32:35], v[224:227]
s_waitcnt lgkmcnt(2)
v_exp_f32 v237, v141
v_mfma_f32_16x16x32_bf16 v[164:167], a[204:207], v[36:39], v[164:167]
ds_read_b128 a[224:227], v8 offset:10240
v_add_f32 v245, v243, v245
v_mfma_f32_16x16x32_bf16 v[164:167], a[208:211], v[40:43], v[164:167]
ds_read_b128 a[228:231], v9 offset:10240
v_add_f32 v244, v236, v244
v_mfma_f32_16x16x32_bf16 v[164:167], a[212:215], v[44:47], v[164:167]
ds_read_b128 a[232:235], v8 offset:14336
v_add_f32 v245, v240, v245
v_mfma_f32_16x16x32_bf16 a[40:43], a[216:219], v[200:203], a[40:43]
ds_read_b128 a[236:239], v9 offset:14336
v_add_u32 v8, s46, v8
v_mfma_f32_16x16x32_bf16 a[104:107], a[216:219], v[204:207], a[104:107]
ds_read_b64_tr_b16 a[240:241], v12 offset:12288
v_cvt_pk_bf16_f32 v177, v238, v239
v_mfma_f32_16x16x32_bf16 v[168:171], a[200:203], v[64:67], v[228:231]
ds_read_b64_tr_b16 a[242:243], v12 offset:14336
v_add_u32 v12, s43, v12
v_mfma_f32_16x16x32_bf16 v[168:171], a[204:207], v[68:71], v[168:171]
ds_read_b64_tr_b16 a[244:245], v13 offset:12288
v_cvt_pk_bf16_f32 v181, v242, v243
v_mfma_f32_16x16x32_bf16 v[168:171], a[208:211], v[72:75], v[168:171]
buffer_load_dwordx4 v5, s[24:27], s50 offen offset:0 lds
v_mfma_f32_16x16x32_bf16 v[168:171], a[212:215], v[76:79], v[168:171]
ds_read_b64_tr_b16 a[246:247], v13 offset:14336
s_add_u32 s50, s47, 34816
s_waitcnt lgkmcnt(6)
v_mfma_f32_16x16x32_bf16 a[44:47], a[220:223], v[200:203], a[44:47]
v_exp_f32 v241, v145
v_mfma_f32_16x16x32_bf16 a[108:111], a[220:223], v[204:207], a[108:111]
v_exp_f32 v238, v142
v_mfma_f32_16x16x32_bf16 v[172:175], a[200:203], v[96:99], v[232:235]
v_exp_f32 v242, v146
v_mfma_f32_16x16x32_bf16 v[172:175], a[204:207], v[100:103], v[172:175]
ds_read_b64_tr_b16 a[248:249], v14 offset:12288
v_add_u32 v13, s43, v13
v_mfma_f32_16x16x32_bf16 v[172:175], a[208:211], v[104:107], v[172:175]
buffer_load_dwordx4 v5, s[24:27], s50 offen offset:1024 lds
v_mfma_f32_16x16x32_bf16 v[172:175], a[212:215], v[108:111], v[172:175]
ds_read_b64_tr_b16 a[250:251], v14 offset:14336
s_add_u32 s50, s47, 40960
v_mfma_f32_16x16x32_bf16 v[172:175], a[224:227], v[112:115], v[172:175]
v_exp_f32 v239, v143
v_mfma_f32_16x16x32_bf16 v[172:175], a[228:231], v[116:119], v[172:175]
s_waitcnt lgkmcnt(2)
v_exp_f32 v243, v147
v_mfma_f32_16x16x32_bf16 v[172:175], a[232:235], v[120:123], v[172:175]
global_load_dword v6, v31, s[52:53]
v_mfma_f32_16x16x32_bf16 v[172:175], a[236:239], v[124:127], v[172:175]
ds_read_b64_tr_b16 a[252:253], v15 offset:12288
v_add_f32 v244, v237, v244
v_mfma_f32_16x16x32_bf16 a[48:51], a[240:243], v[200:203], a[48:51]
buffer_load_dwordx4 v5, s[24:27], s50 offen offset:2048 lds
v_mfma_f32_16x16x32_bf16 a[112:115], a[240:243], v[204:207], a[112:115]
ds_read_b64_tr_b16 a[254:255], v15 offset:14336
s_add_u32 s50, s47, 47104
v_mfma_f32_16x16x32_bf16 a[52:55], a[244:247], v[200:203], a[52:55]
ds_read_b64_tr_b16 a[192:193], v12 offset:0
v_add_f32 v245, v241, v245
v_mfma_f32_16x16x32_bf16 a[116:119], a[244:247], v[204:207], a[116:119]
ds_read_b64_tr_b16 a[194:195], v12 offset:2048
v_add_u32 v9, s46, v9
v_mfma_f32_16x16x32_bf16 v[168:171], a[224:227], v[80:83], v[168:171]
ds_read_b64_tr_b16 a[196:197], v13 offset:0
v_add_f32 v244, v238, v244
v_mfma_f32_16x16x32_bf16 v[168:171], a[228:231], v[84:87], v[168:171]
s_waitcnt vmcnt(16)
s_barrier
v_add_f32 v245, v242, v245
v_mfma_f32_16x16x32_bf16 v[168:171], a[232:235], v[88:91], v[168:171]
buffer_load_dwordx4 v5, s[24:27], s50 offen offset:3072 lds
v_mfma_f32_16x16x32_bf16 v[168:171], a[236:239], v[92:95], v[168:171]
ds_read_b64_tr_b16 a[198:199], v13 offset:2048
s_add_u32 s40, s40, 32768
s_waitcnt lgkmcnt(5)
v_mfma_f32_16x16x32_bf16 a[56:59], a[248:251], v[200:203], a[56:59]
ds_read_b128 a[200:203], v8 offset:0
s_cmp_eq_u32 s40, s41
s_cselect_b32 s40, s42, s40
v_mfma_f32_16x16x32_bf16 a[120:123], a[248:251], v[204:207], a[120:123]
ds_read_b128 a[204:207], v9 offset:0
v_add_f32 v244, v239, v244
v_mfma_f32_16x16x32_bf16 v[164:167], a[224:227], v[48:51], v[164:167]
ds_read_b128 a[208:211], v8 offset:4096
v_add_f32 v245, v243, v245
v_mfma_f32_16x16x32_bf16 v[164:167], a[228:231], v[52:55], v[164:167]
ds_read_b128 a[212:215], v9 offset:4096
v_max_f32 v253, v244, v245
v_mfma_f32_16x16x32_bf16 v[164:167], a[232:235], v[56:59], v[164:167]
s_waitcnt lgkmcnt(5)
v_add_u32 v14, s43, v14
v_cmp_lt_f32 vcc, s54, v253
v_mfma_f32_16x16x32_bf16 v[164:167], a[236:239], v[60:63], v[164:167]
ds_read_b64_tr_b16 a[216:217], v14 offset:0
v_cvt_pk_bf16_f32 v178, v236, v237
v_mfma_f32_16x16x32_bf16 a[60:63], a[252:255], v[200:203], a[60:63]
ds_read_b64_tr_b16 a[218:219], v14 offset:2048
v_cvt_pk_bf16_f32 v179, v238, v239
v_mfma_f32_16x16x32_bf16 a[124:127], a[252:255], v[204:207], a[124:127]
v_cvt_pk_bf16_f32 v182, v240, v241
v_cvt_pk_bf16_f32 v183, v242, v243
v_mfma_f32_16x16x32_bf16 a[0:3], a[192:195], v[212:215], a[0:3]
s_cbranch_vccnz L_slow_28
L_ret_28:
v_add_u32 v15, s43, v15
v_add_f32 v250, v244, v250
v_mfma_f32_16x16x32_bf16 a[64:67], a[192:195], v[216:219], a[64:67]
ds_read_b64_tr_b16 a[220:221], v15 offset:0
v_add_f32 v251, v245, v251
v_mfma_f32_16x16x32_bf16 a[128:131], a[192:195], v[220:223], a[128:131]
ds_read_b64_tr_b16 a[222:223], v15 offset:2048
s_waitcnt lgkmcnt(4)
v_mfma_f32_16x16x32_bf16 a[4:7], a[196:199], v[212:215], a[4:7]
s_mov_b32 m0, s40
v_exp_f32 v236, v152
v_mfma_f32_16x16x32_bf16 a[68:71], a[196:199], v[216:219], a[68:71]
buffer_load_dwordx4 v4, s[16:19], s39 offen offset:0 nt lds
v_mfma_f32_16x16x32_bf16 a[132:135], a[196:199], v[220:223], a[132:135]
ds_read_b128 a[224:227], v8 offset:8192
v_and_b32 v20, 7, v1
v_mfma_f32_16x16x32_bf16 v[128:131], a[200:203], v[32:35], v[224:227]
ds_read_b128 a[228:231], v9 offset:8192
v_lshlrev_b32 v20, 2, v20
v_mfma_f32_16x16x32_bf16 v[128:131], a[204:207], v[36:39], v[128:131]
ds_read_b128 a[232:235], v8 offset:12288
s_lshl_b32 s91, s35, 5
v_mfma_f32_16x16x32_bf16 v[128:131], a[208:211], v[40:43], v[128:131]
ds_read_b128 a[236:239], v9 offset:12288
s_bitcmp1_b64 s[48:49], 0
s_cselect_b32 s46, s45, s44
v_mfma_f32_16x16x32_bf16 v[128:131], a[212:215], v[44:47], v[128:131]
ds_read_b64_tr_b16 a[240:241], v12 offset:4096
s_mov_b32 s83, 0x01010101
s_waitcnt lgkmcnt(5)
v_mfma_f32_16x16x32_bf16 a[8:11], a[216:219], v[212:215], a[8:11]
ds_read_b64_tr_b16 a[242:243], v12 offset:6144
s_lshr_b64 s[48:49], s[48:49], 1
v_mfma_f32_16x16x32_bf16 a[72:75], a[216:219], v[216:219], a[72:75]
buffer_load_dwordx4 v4, s[16:19], s39 offen offset:1024 nt lds
v_mfma_f32_16x16x32_bf16 a[136:139], a[216:219], v[220:223], a[136:139]
ds_read_b64_tr_b16 a[244:245], v13 offset:4096
v_mfma_f32_16x16x32_bf16 a[12:15], a[220:223], v[212:215], a[12:15]
ds_read_b64_tr_b16 a[246:247], v13 offset:6144
v_mfma_f32_16x16x32_bf16 a[76:79], a[220:223], v[216:219], a[76:79]
v_exp_f32 v237, v153
v_mfma_f32_16x16x32_bf16 a[140:143], a[220:223], v[220:223], a[140:143]
v_exp_f32 v238, v154
v_mfma_f32_16x16x32_bf16 v[132:135], a[200:203], v[64:67], v[228:231]
v_exp_f32 v239, v155
v_mfma_f32_16x16x32_bf16 v[132:135], a[204:207], v[68:71], v[132:135]
buffer_load_dwordx4 v4, s[16:19], s39 offen offset:2048 nt lds
v_mfma_f32_16x16x32_bf16 v[132:135], a[208:211], v[72:75], v[132:135]
s_waitcnt lgkmcnt(2)
v_exp_f32 v240, v156
v_mfma_f32_16x16x32_bf16 v[132:135], a[212:215], v[76:79], v[132:135]
ds_read_b64_tr_b16 a[248:249], v14 offset:4096
v_cvt_pk_bf16_f32 v188, v236, v237
v_mfma_f32_16x16x32_bf16 v[132:135], a[224:227], v[80:83], v[132:135]
ds_read_b64_tr_b16 a[250:251], v14 offset:6144
v_add_f32 v247, v236, v237
v_mfma_f32_16x16x32_bf16 v[132:135], a[228:231], v[84:87], v[132:135]
s_waitcnt lgkmcnt(2)
v_exp_f32 v241, v157
v_mfma_f32_16x16x32_bf16 v[132:135], a[232:235], v[88:91], v[132:135]
ds_read_b64_tr_b16 a[252:253], v15 offset:4096
v_cvt_pk_bf16_f32 v189, v238, v239
v_mfma_f32_16x16x32_bf16 v[132:135], a[236:239], v[92:95], v[132:135]
ds_read_b64_tr_b16 a[254:255], v15 offset:6144
v_add_f32 v247, v238, v247
v_mfma_f32_16x16x32_bf16 a[16:19], a[240:243], v[212:215], a[16:19]
buffer_load_dwordx4 v4, s[16:19], s39 offen offset:3072 nt lds
v_mfma_f32_16x16x32_bf16 a[80:83], a[240:243], v[216:219], a[80:83]
ds_read_b64_tr_b16 a[192:193], v12 offset:8192
s_add_u32 m0, s40, 16384
v_mfma_f32_16x16x32_bf16 a[144:147], a[240:243], v[220:223], a[144:147]
ds_read_b64_tr_b16 a[194:195], v12 offset:10240
s_add_u32 s39, s39, 16384
v_mfma_f32_16x16x32_bf16 a[20:23], a[244:247], v[212:215], a[20:23]
v_exp_f32 v236, v160
v_mfma_f32_16x16x32_bf16 a[84:87], a[244:247], v[216:219], a[84:87]
ds_read_b64_tr_b16 a[196:197], v13 offset:8192
v_add_f32 v248, v240, v241
v_mfma_f32_16x16x32_bf16 a[148:151], a[244:247], v[220:223], a[148:151]
ds_read_b64_tr_b16 a[198:199], v13 offset:10240
v_add_f32 v247, v239, v247
v_mfma_f32_16x16x32_bf16 v[128:131], a[224:227], v[48:51], v[128:131]
buffer_load_dwordx4 v4, s[16:19], s39 offen offset:0 nt lds
v_mfma_f32_16x16x32_bf16 v[128:131], a[228:231], v[52:55], v[128:131]
ds_read_b128 a[200:203], v8 offset:2048
v_cvt_pk_bf16_f32 v192, v240, v241
v_mfma_f32_16x16x32_bf16 v[128:131], a[232:235], v[56:59], v[128:131]
ds_read_b128 a[204:207], v9 offset:2048
v_mfma_f32_16x16x32_bf16 v[128:131], a[236:239], v[60:63], v[128:131]
ds_read_b128 a[208:211], v8 offset:6144
s_waitcnt lgkmcnt(5)
v_mfma_f32_16x16x32_bf16 a[24:27], a[248:251], v[212:215], a[24:27]
ds_read_b128 a[212:215], v9 offset:6144
v_mfma_f32_16x16x32_bf16 a[88:91], a[248:251], v[216:219], a[88:91]
ds_read_b64_tr_b16 a[216:217], v14 offset:8192
v_mfma_f32_16x16x32_bf16 a[152:155], a[248:251], v[220:223], a[152:155]
ds_read_b64_tr_b16 a[218:219], v14 offset:10240
v_mfma_f32_16x16x32_bf16 a[28:31], a[252:255], v[212:215], a[28:31]
buffer_load_dwordx4 v4, s[16:19], s39 offen offset:1024 nt lds
v_mfma_f32_16x16x32_bf16 a[92:95], a[252:255], v[216:219], a[92:95]
ds_read_b64_tr_b16 a[220:221], v15 offset:8192
v_mfma_f32_16x16x32_bf16 a[156:159], a[252:255], v[220:223], a[156:159]
ds_read_b64_tr_b16 a[222:223], v15 offset:10240
v_mfma_f32_16x16x32_bf16 a[32:35], a[192:195], v[212:215], a[32:35]
v_exp_f32 v237, v161
v_mfma_f32_16x16x32_bf16 a[96:99], a[192:195], v[216:219], a[96:99]
v_exp_f32 v242, v158
v_mfma_f32_16x16x32_bf16 a[160:163], a[192:195], v[220:223], a[160:163]
s_waitcnt lgkmcnt(3)
v_exp_f32 v238, v162
v_mfma_f32_16x16x32_bf16 a[36:39], a[196:199], v[212:215], a[36:39]
buffer_load_dwordx4 v4, s[16:19], s39 offen offset:2048 nt lds
v_mfma_f32_16x16x32_bf16 a[100:103], a[196:199], v[216:219], a[100:103]
s_waitcnt lgkmcnt(2)
v_exp_f32 v243, v159
v_mfma_f32_16x16x32_bf16 a[164:167], a[196:199], v[220:223], a[164:167]
ds_read_b128 a[224:227], v8 offset:10240
v_add_f32 v249, v236, v237
v_mfma_f32_16x16x32_bf16 v[140:143], a[200:203], v[32:35], v[224:227]
ds_read_b128 a[228:231], v9 offset:10240
v_add_f32 v248, v242, v248
v_mfma_f32_16x16x32_bf16 v[140:143], a[204:207], v[36:39], v[140:143]
ds_read_b128 a[232:235], v8 offset:14336
v_add_f32 v249, v238, v249
v_mfma_f32_16x16x32_bf16 v[140:143], a[208:211], v[40:43], v[140:143]
ds_read_b128 a[236:239], v9 offset:14336
v_add_f32 v248, v243, v248
v_mfma_f32_16x16x32_bf16 v[140:143], a[212:215], v[44:47], v[140:143]
ds_read_b64_tr_b16 a[240:241], v12 offset:12288
v_cvt_pk_bf16_f32 v196, v236, v237
v_mfma_f32_16x16x32_bf16 a[40:43], a[216:219], v[212:215], a[40:43]
ds_read_b64_tr_b16 a[242:243], v12 offset:14336
v_add_u32 v12, s46, v12
v_mfma_f32_16x16x32_bf16 a[104:107], a[216:219], v[216:219], a[104:107]
buffer_load_dwordx4 v4, s[16:19], s39 offen offset:3072 nt lds
v_mfma_f32_16x16x32_bf16 a[168:171], a[216:219], v[220:223], a[168:171]
ds_read_b64_tr_b16 a[244:245], v13 offset:12288
v_cvt_pk_bf16_f32 v193, v242, v243
s_waitcnt lgkmcnt(6)
v_mfma_f32_16x16x32_bf16 a[44:47], a[220:223], v[212:215], a[44:47]
ds_read_b64_tr_b16 a[246:247], v13 offset:14336
v_add_u32 v13, s46, v13
v_mfma_f32_16x16x32_bf16 a[108:111], a[220:223], v[216:219], a[108:111]
s_add_u32 s39, s39, 16384
v_exp_f32 v239, v163
v_mfma_f32_16x16x32_bf16 a[172:175], a[220:223], v[220:223], a[172:175]
s_add_u32 s40, s40, 32768
v_exp_f32 v240, v164
v_mfma_f32_16x16x32_bf16 v[144:147], a[200:203], v[64:67], v[228:231]
s_cmp_eq_u32 s40, s41
s_cselect_b32 s40, s42, s40
v_exp_f32 v241, v165
v_mfma_f32_16x16x32_bf16 v[144:147], a[204:207], v[68:71], v[144:147]
v_exp_f32 v236, v168
v_mfma_f32_16x16x32_bf16 v[144:147], a[208:211], v[72:75], v[144:147]
s_waitcnt lgkmcnt(2)
v_exp_f32 v242, v166
v_mfma_f32_16x16x32_bf16 v[144:147], a[212:215], v[76:79], v[144:147]
ds_read_b64_tr_b16 a[248:249], v14 offset:12288
v_add_f32 v249, v239, v249
v_mfma_f32_16x16x32_bf16 v[144:147], a[224:227], v[80:83], v[144:147]
ds_read_b64_tr_b16 a[250:251], v14 offset:14336
v_cvt_pk_bf16_f32 v190, v240, v241
v_mfma_f32_16x16x32_bf16 v[144:147], a[228:231], v[84:87], v[144:147]
v_exp_f32 v243, v167
v_mfma_f32_16x16x32_bf16 v[144:147], a[232:235], v[88:91], v[144:147]
ds_read_b64_tr_b16 a[252:253], v15 offset:12288
v_add_f32 v247, v240, v247
v_mfma_f32_16x16x32_bf16 v[144:147], a[236:239], v[92:95], v[144:147]
ds_read_b64_tr_b16 a[254:255], v15 offset:14336
v_add_f32 v247, v241, v247
v_mfma_f32_16x16x32_bf16 a[48:51], a[240:243], v[212:215], a[48:51]
v_exp_f32 v240, v172
v_mfma_f32_16x16x32_bf16 a[112:115], a[240:243], v[216:219], a[112:115]
v_exp_f32 v237, v169
v_mfma_f32_16x16x32_bf16 a[176:179], a[240:243], v[220:223], a[176:179]
s_waitcnt lgkmcnt(3)
v_exp_f32 v241, v173
v_mfma_f32_16x16x32_bf16 a[52:55], a[244:247], v[212:215], a[52:55]
buffer_load_dword v19, v20, s[4:7], s91 offen offset:0 sc0 sc1
v_mfma_f32_16x16x32_bf16 a[116:119], a[244:247], v[216:219], a[116:119]
s_mov_b32 s20, s74
v_add_f32 v248, v236, v248
v_add_f32 v249, v240, v249
v_mfma_f32_16x16x32_bf16 a[180:183], a[244:247], v[220:223], a[180:183]
s_waitcnt vmcnt(18) lgkmcnt(0)
s_barrier
v_add_u32 v8, s43, v8
v_mfma_f32_16x16x32_bf16 v[140:143], a[224:227], v[48:51], v[140:143]
ds_read_b64_tr_b16 a[192:193], v12 offset:0
v_cvt_pk_bf16_f32 v197, v238, v239
v_mfma_f32_16x16x32_bf16 v[140:143], a[228:231], v[52:55], v[140:143]
ds_read_b64_tr_b16 a[194:195], v12 offset:2048
v_cvt_pk_bf16_f32 v191, v242, v243
v_mfma_f32_16x16x32_bf16 v[140:143], a[232:235], v[56:59], v[140:143]
ds_read_b64_tr_b16 a[196:197], v13 offset:0
v_add_f32 v247, v242, v247
v_mfma_f32_16x16x32_bf16 v[140:143], a[236:239], v[60:63], v[140:143]
ds_read_b64_tr_b16 a[198:199], v13 offset:2048
v_add_f32 v248, v237, v248
v_mfma_f32_16x16x32_bf16 a[56:59], a[248:251], v[212:215], a[56:59]
ds_read_b128 a[200:203], v8 offset:0
v_add_f32 v249, v241, v249
v_mfma_f32_16x16x32_bf16 a[120:123], a[248:251], v[216:219], a[120:123]
ds_read_b128 a[208:211], v8 offset:4096
v_add_u32 v9, s43, v9
v_mfma_f32_16x16x32_bf16 a[184:187], a[248:251], v[220:223], a[184:187]
ds_read_b128 a[204:207], v9 offset:0
v_add_f32 v247, v243, v247
v_mfma_f32_16x16x32_bf16 a[60:63], a[252:255], v[212:215], a[60:63]
ds_read_b128 a[212:215], v9 offset:4096
v_add_u32 v14, s46, v14
v_mfma_f32_16x16x32_bf16 a[124:127], a[252:255], v[216:219], a[124:127]
s_mov_b32 s21, s75
v_exp_f32 v238, v170
v_exp_f32 v242, v174
v_mfma_f32_16x16x32_bf16 a[188:191], a[252:255], v[220:223], a[188:191]
s_mov_b32 s22, 1146880
v_exp_f32 v239, v171
v_add_f32 v248, v238, v248
v_exp_f32 v243, v175
v_add_f32 v249, v242, v249
s_waitcnt lgkmcnt(5)
v_mfma_f32_16x16x32_bf16 a[0:3], a[192:195], v[176:179], a[0:3]
ds_read_b64_tr_b16 a[216:217], v14 offset:0
v_add_f32 v248, v239, v248
v_add_f32 v249, v243, v249
v_mfma_f32_16x16x32_bf16 a[64:67], a[192:195], v[180:183], a[64:67]
ds_read_b64_tr_b16 a[218:219], v14 offset:2048
v_max3_f32 v253, v247, v248, v249
s_waitcnt lgkmcnt(5)
v_mfma_f32_16x16x32_bf16 a[4:7], a[196:199], v[176:179], a[4:7]
v_cmp_lt_f32 vcc, s54, v253
v_cvt_pk_bf16_f32 v194, v236, v237
v_mfma_f32_16x16x32_bf16 a[68:71], a[196:199], v[180:183], a[68:71]
s_add_u32 s47, s47, 128
v_cvt_pk_bf16_f32 v195, v238, v239
v_cvt_pk_bf16_f32 v198, v240, v241
v_cvt_pk_bf16_f32 v199, v242, v243
s_cbranch_vccnz L_slow_29
L_ret_29:
v_mfma_f32_16x16x32_bf16 v[152:155], a[200:203], v[32:35], v[224:227]
s_cmp_eq_u32 s47, s90
s_cselect_b32 s50, 896, 0
v_exp_f32 v236, v128
s_waitcnt lgkmcnt(2)
v_mfma_f32_16x16x32_bf16 v[152:155], a[204:207], v[36:39], v[152:155]
ds_read_b128 a[224:227], v8 offset:8192
v_add_u32 v15, s46, v15
v_mfma_f32_16x16x32_bf16 v[152:155], a[208:211], v[40:43], v[152:155]
ds_read_b64_tr_b16 a[220:221], v15 offset:0
v_add_f32 v250, v247, v250
v_mfma_f32_16x16x32_bf16 v[152:155], a[212:215], v[44:47], v[152:155]
ds_read_b64_tr_b16 a[222:223], v15 offset:2048
v_add_f32 v251, v248, v251
s_waitcnt lgkmcnt(3)
v_mfma_f32_16x16x32_bf16 a[8:11], a[216:219], v[176:179], a[8:11]
ds_read_b128 a[228:231], v9 offset:8192
v_add_f32 v252, v249, v252
v_mfma_f32_16x16x32_bf16 a[72:75], a[216:219], v[180:183], a[72:75]
ds_read_b128 a[232:235], v8 offset:12288
s_sub_u32 s47, s47, s50
v_mfma_f32_16x16x32_bf16 v[156:159], a[200:203], v[64:67], v[228:231]
ds_read_b128 a[236:239], v9 offset:12288
s_add_u32 m0, s63, 131072
v_mfma_f32_16x16x32_bf16 v[156:159], a[204:207], v[68:71], v[156:159]
ds_read_b64_tr_b16 a[240:241], v12 offset:4096
s_add_u32 s50, s47, 0
v_mfma_f32_16x16x32_bf16 v[156:159], a[208:211], v[72:75], v[156:159]
ds_read_b64_tr_b16 a[242:243], v12 offset:6144
s_mov_b32 s23, 0x20000
v_mfma_f32_16x16x32_bf16 v[156:159], a[212:215], v[76:79], v[156:159]
ds_read_b64_tr_b16 a[244:245], v13 offset:4096
s_mul_i32 s57, s3, 49152
s_waitcnt lgkmcnt(6)
v_mfma_f32_16x16x32_bf16 a[12:15], a[220:223], v[176:179], a[12:15]
ds_read_b64_tr_b16 a[246:247], v13 offset:6144
s_xor_b32 s51, s3, 16
v_mfma_f32_16x16x32_bf16 a[76:79], a[220:223], v[180:183], a[76:79]
buffer_load_dwordx4 v5, s[24:27], s50 offen offset:0 lds
v_mfma_f32_16x16x32_bf16 v[160:163], a[200:203], v[96:99], v[232:235]
s_add_u32 s50, s47, 6144
v_exp_f32 v237, v129
v_mfma_f32_16x16x32_bf16 v[160:163], a[204:207], v[100:103], v[160:163]
ds_read_b64_tr_b16 a[248:249], v14 offset:4096
s_mul_i32 s58, s51, 49152
v_mfma_f32_16x16x32_bf16 v[160:163], a[208:211], v[104:107], v[160:163]
ds_read_b64_tr_b16 a[250:251], v14 offset:6144
s_add_u32 s61, s57, s63
v_mfma_f32_16x16x32_bf16 v[160:163], a[212:215], v[108:111], v[160:163]
s_add_u32 s62, s61, 4096
v_exp_f32 v240, v132
v_mfma_f32_16x16x32_bf16 v[160:163], a[224:227], v[112:115], v[160:163]
s_lshl_b32 s53, s32, 9
v_exp_f32 v241, v133
s_waitcnt lgkmcnt(3)
v_mfma_f32_16x16x32_bf16 v[160:163], a[228:231], v[116:119], v[160:163]
buffer_load_dwordx4 v5, s[24:27], s50 offen offset:1024 lds
v_mfma_f32_16x16x32_bf16 v[160:163], a[232:235], v[120:123], v[160:163]
s_add_u32 s50, s47, 12288
v_exp_f32 v238, v130
v_mfma_f32_16x16x32_bf16 v[160:163], a[236:239], v[124:127], v[160:163]
ds_read_b64_tr_b16 a[252:253], v15 offset:4096
s_add_u32 s52, s53, 131072
v_mfma_f32_16x16x32_bf16 a[16:19], a[240:243], v[176:179], a[16:19]
ds_read_b64_tr_b16 a[254:255], v15 offset:6144
s_add_u32 s53, s53, s57
v_mfma_f32_16x16x32_bf16 a[80:83], a[240:243], v[180:183], a[80:83]
ds_read_b64_tr_b16 a[192:193], v12 offset:8192
s_add_u32 s53, s53, 40960
s_waitcnt lgkmcnt(3)
v_mfma_f32_16x16x32_bf16 a[20:23], a[244:247], v[176:179], a[20:23]
ds_read_b64_tr_b16 a[194:195], v12 offset:10240
v_lshlrev_b32 v31, 3, v1
v_mfma_f32_16x16x32_bf16 a[84:87], a[244:247], v[180:183], a[84:87]
ds_read_b64_tr_b16 a[196:197], v13 offset:8192
v_add_u32 v10, s52, v31
v_mfma_f32_16x16x32_bf16 v[156:159], a[224:227], v[80:83], v[156:159]
ds_read_b64_tr_b16 a[198:199], v13 offset:10240
v_xor_b32 v11, 1024, v10
v_mfma_f32_16x16x32_bf16 v[156:159], a[228:231], v[84:87], v[156:159]
ds_read_b128 a[200:203], v8 offset:2048
s_lshl_b32 s51, s32, 5
v_mfma_f32_16x16x32_bf16 v[156:159], a[232:235], v[88:91], v[156:159]
ds_read_b128 a[204:207], v9 offset:2048
v_xor_b32 v21, s51, v24
v_mfma_f32_16x16x32_bf16 v[156:159], a[236:239], v[92:95], v[156:159]
ds_read_b128 a[208:211], v8 offset:6144
v_add_u32 v22, 0x10000, v21
v_mfma_f32_16x16x32_bf16 a[24:27], a[248:251], v[176:179], a[24:27]
ds_read_b128 a[212:215], v9 offset:6144
v_add_u32 v23, 0x20000, v21
v_mfma_f32_16x16x32_bf16 a[88:91], a[248:251], v[180:183], a[88:91]
ds_read_b64_tr_b16 a[216:217], v14 offset:8192
s_bitcmp1_b64 s[48:49], 0
s_cselect_b32 s46, s45, s44
v_mfma_f32_16x16x32_bf16 v[152:155], a[224:227], v[48:51], v[152:155]
ds_read_b64_tr_b16 a[218:219], v14 offset:10240
v_add_f32 v244, v236, v237
v_mfma_f32_16x16x32_bf16 v[152:155], a[228:231], v[52:55], v[152:155]
buffer_load_dwordx4 v5, s[24:27], s50 offen offset:2048 lds
v_mfma_f32_16x16x32_bf16 v[152:155], a[232:235], v[56:59], v[152:155]
s_add_u32 s50, s47, 18432
v_exp_f32 v242, v134
v_mfma_f32_16x16x32_bf16 v[152:155], a[236:239], v[60:63], v[152:155]
s_lshr_b64 s[48:49], s[48:49], 1
v_exp_f32 v239, v131
s_waitcnt lgkmcnt(4)
v_mfma_f32_16x16x32_bf16 a[28:31], a[252:255], v[176:179], a[28:31]
v_exp_f32 v243, v135
v_mfma_f32_16x16x32_bf16 a[92:95], a[252:255], v[180:183], a[92:95]
ds_read_b64_tr_b16 a[220:221], v15 offset:8192
v_add_f32 v245, v240, v241
v_mfma_f32_16x16x32_bf16 a[32:35], a[192:195], v[176:179], a[32:35]
ds_read_b64_tr_b16 a[222:223], v15 offset:10240
v_add_f32 v244, v238, v244
v_mfma_f32_16x16x32_bf16 a[96:99], a[192:195], v[180:183], a[96:99]
buffer_load_dwordx4 v5, s[24:27], s50 offen offset:3072 lds
v_mfma_f32_16x16x32_bf16 a[36:39], a[196:199], v[176:179], a[36:39]
s_add_u32 m0, s63, 135168
v_add_f32 v245, v242, v245
v_cvt_pk_bf16_f32 v200, v236, v237
v_mfma_f32_16x16x32_bf16 a[100:103], a[196:199], v[180:183], a[100:103]
s_add_u32 s50, s47, 28672
v_exp_f32 v236, v140
v_mfma_f32_16x16x32_bf16 v[164:167], a[200:203], v[32:35], v[224:227]
s_waitcnt lgkmcnt(2)
v_exp_f32 v237, v141
v_mfma_f32_16x16x32_bf16 v[164:167], a[204:207], v[36:39], v[164:167]
ds_read_b128 a[224:227], v8 offset:10240
v_add_f32 v244, v239, v244
v_mfma_f32_16x16x32_bf16 v[164:167], a[208:211], v[40:43], v[164:167]
ds_read_b128 a[228:231], v9 offset:10240
v_cvt_pk_bf16_f32 v204, v240, v241
v_mfma_f32_16x16x32_bf16 v[164:167], a[212:215], v[44:47], v[164:167]
ds_read_b128 a[232:235], v8 offset:14336
v_add_f32 v245, v243, v245
v_mfma_f32_16x16x32_bf16 a[40:43], a[216:219], v[176:179], a[40:43]
ds_read_b128 a[236:239], v9 offset:14336
v_add_f32 v244, v236, v244
v_mfma_f32_16x16x32_bf16 a[104:107], a[216:219], v[180:183], a[104:107]
ds_read_b64_tr_b16 a[240:241], v12 offset:12288
v_cvt_pk_bf16_f32 v201, v238, v239
v_mfma_f32_16x16x32_bf16 v[168:171], a[200:203], v[64:67], v[228:231]
ds_read_b64_tr_b16 a[242:243], v12 offset:14336
v_add_u32 v12, s43, v12
v_mfma_f32_16x16x32_bf16 v[168:171], a[204:207], v[68:71], v[168:171]
ds_read_b64_tr_b16 a[244:245], v13 offset:12288
v_cvt_pk_bf16_f32 v205, v242, v243
v_mfma_f32_16x16x32_bf16 v[168:171], a[208:211], v[72:75], v[168:171]
buffer_load_dwordx4 v5, s[24:27], s50 offen offset:0 lds
v_mfma_f32_16x16x32_bf16 v[168:171], a[212:215], v[76:79], v[168:171]
ds_read_b64_tr_b16 a[246:247], v13 offset:14336
s_add_u32 s50, s47, 34816
s_waitcnt lgkmcnt(6)
v_mfma_f32_16x16x32_bf16 a[44:47], a[220:223], v[176:179], a[44:47]
v_exp_f32 v240, v144
v_mfma_f32_16x16x32_bf16 a[108:111], a[220:223], v[180:183], a[108:111]
v_exp_f32 v241, v145
v_mfma_f32_16x16x32_bf16 v[172:175], a[200:203], v[96:99], v[232:235]
v_exp_f32 v238, v142
v_mfma_f32_16x16x32_bf16 v[172:175], a[204:207], v[100:103], v[172:175]
ds_read_b64_tr_b16 a[248:249], v14 offset:12288
v_add_u32 v13, s43, v13
v_mfma_f32_16x16x32_bf16 v[172:175], a[208:211], v[104:107], v[172:175]
buffer_load_dwordx4 v5, s[24:27], s50 offen offset:1024 lds
v_mfma_f32_16x16x32_bf16 v[172:175], a[212:215], v[108:111], v[172:175]
ds_read_b64_tr_b16 a[250:251], v14 offset:14336
s_add_u32 s50, s47, 40960
v_mfma_f32_16x16x32_bf16 v[172:175], a[224:227], v[112:115], v[172:175]
v_exp_f32 v242, v146
v_mfma_f32_16x16x32_bf16 v[172:175], a[228:231], v[116:119], v[172:175]
s_waitcnt lgkmcnt(2)
v_exp_f32 v239, v143
v_mfma_f32_16x16x32_bf16 v[172:175], a[232:235], v[120:123], v[172:175]
v_exp_f32 v243, v147
v_mfma_f32_16x16x32_bf16 v[172:175], a[236:239], v[124:127], v[172:175]
ds_read_b64_tr_b16 a[252:253], v15 offset:12288
v_add_u32 v14, s43, v14
v_mfma_f32_16x16x32_bf16 a[48:51], a[240:243], v[176:179], a[48:51]
buffer_load_dwordx4 v5, s[24:27], s50 offen offset:2048 lds
v_mfma_f32_16x16x32_bf16 a[112:115], a[240:243], v[180:183], a[112:115]
ds_read_b64_tr_b16 a[254:255], v15 offset:14336
s_add_u32 s50, s47, 47104
v_mfma_f32_16x16x32_bf16 a[52:55], a[244:247], v[176:179], a[52:55]
ds_read_b64_tr_b16 a[192:193], v12 offset:0
v_add_u32 v15, s43, v15
v_mfma_f32_16x16x32_bf16 a[116:119], a[244:247], v[180:183], a[116:119]
ds_read_b64_tr_b16 a[194:195], v12 offset:2048
v_add_f32 v245, v240, v245
v_mfma_f32_16x16x32_bf16 v[168:171], a[224:227], v[80:83], v[168:171]
ds_read_b64_tr_b16 a[196:197], v13 offset:0
v_add_f32 v244, v237, v244
v_mfma_f32_16x16x32_bf16 v[168:171], a[228:231], v[84:87], v[168:171]
s_waitcnt vmcnt(16)
s_barrier
v_add_f32 v245, v241, v245
v_mfma_f32_16x16x32_bf16 v[168:171], a[232:235], v[88:91], v[168:171]
buffer_load_dwordx4 v5, s[24:27], s50 offen offset:3072 lds
v_mfma_f32_16x16x32_bf16 v[168:171], a[236:239], v[92:95], v[168:171]
ds_read_b64_tr_b16 a[198:199], v13 offset:2048
s_add_u32 s40, s40, 32768
s_waitcnt lgkmcnt(5)
v_mfma_f32_16x16x32_bf16 a[56:59], a[248:251], v[176:179], a[56:59]
ds_read_b64_tr_b16 a[200:201], v14 offset:0
s_cmp_eq_u32 s40, s41
s_cselect_b32 s40, s42, s40
v_mfma_f32_16x16x32_bf16 a[120:123], a[248:251], v[180:183], a[120:123]
ds_read_b64_tr_b16 a[202:203], v14 offset:2048
v_add_f32 v244, v238, v244
v_mfma_f32_16x16x32_bf16 v[164:167], a[224:227], v[48:51], v[164:167]
ds_read_b64_tr_b16 a[204:205], v15 offset:0
v_add_f32 v245, v242, v245
v_mfma_f32_16x16x32_bf16 v[164:167], a[228:231], v[52:55], v[164:167]
ds_read_b64_tr_b16 a[206:207], v15 offset:2048
v_add_f32 v244, v239, v244
v_mfma_f32_16x16x32_bf16 v[164:167], a[232:235], v[56:59], v[164:167]
s_waitcnt lgkmcnt(5)
v_add_f32 v245, v243, v245
v_cvt_pk_bf16_f32 v202, v236, v237
v_mfma_f32_16x16x32_bf16 v[164:167], a[236:239], v[60:63], v[164:167]
ds_read_b64_tr_b16 a[208:209], v12 offset:4096
v_max_f32 v253, v244, v245
v_mfma_f32_16x16x32_bf16 a[60:63], a[252:255], v[176:179], a[60:63]
ds_read_b64_tr_b16 a[210:211], v12 offset:6144
v_cmp_lt_f32 vcc, s54, v253
v_mfma_f32_16x16x32_bf16 a[124:127], a[252:255], v[180:183], a[124:127]
s_waitcnt lgkmcnt(5)
v_cvt_pk_bf16_f32 v203, v238, v239
v_cvt_pk_bf16_f32 v206, v240, v241
v_mfma_f32_16x16x32_bf16 a[0:3], a[192:195], v[188:191], a[0:3]
ds_read_b64_tr_b16 a[212:213], v13 offset:4096
v_mfma_f32_16x16x32_bf16 a[64:67], a[192:195], v[192:195], a[64:67]
ds_read_b64_tr_b16 a[214:215], v13 offset:6144
s_add_u32 s47, s47, 128
v_mfma_f32_16x16x32_bf16 a[128:131], a[192:195], v[196:199], a[128:131]
ds_read_b64_tr_b16 v[32:33], v22 offset:0
s_cmp_eq_u32 s47, s90
s_cselect_b32 s50, 896, 0
v_mfma_f32_16x16x32_bf16 a[4:7], a[196:199], v[188:191], a[4:7]
ds_read_b64_tr_b16 a[216:217], v14 offset:4096
s_sub_u32 s47, s47, s50
v_mfma_f32_16x16x32_bf16 a[68:71], a[196:199], v[192:195], a[68:71]
ds_read_b64_tr_b16 a[218:219], v14 offset:6144
s_add_u32 m0, s63, 0
v_mfma_f32_16x16x32_bf16 a[132:135], a[196:199], v[196:199], a[132:135]
ds_read_b64_tr_b16 v[34:35], v22 offset:2048
s_add_u32 s50, s47, 0
s_waitcnt lgkmcnt(6)
v_mfma_f32_16x16x32_bf16 a[8:11], a[200:203], v[188:191], a[8:11]
ds_read_b64_tr_b16 a[220:221], v15 offset:4096
v_cvt_pk_bf16_f32 v207, v242, v243
v_mfma_f32_16x16x32_bf16 a[72:75], a[200:203], v[192:195], a[72:75]
ds_read_b64_tr_b16 a[222:223], v15 offset:6144
s_cbranch_vccnz L_slow_30
L_ret_30:
v_mfma_f32_16x16x32_bf16 a[136:139], a[200:203], v[196:199], a[136:139]
ds_read_b64_tr_b16 v[36:37], v22 offset:4096
s_bitcmp1_b64 s[48:49], 0
s_cselect_b32 s46, s45, s44
v_mfma_f32_16x16x32_bf16 a[12:15], a[204:207], v[188:191], a[12:15]
ds_read_b64_tr_b16 a[224:225], v12 offset:8192
v_add_f32 v250, v244, v250
v_mfma_f32_16x16x32_bf16 a[76:79], a[204:207], v[192:195], a[76:79]
ds_read_b64_tr_b16 a[226:227], v12 offset:10240
v_add_f32 v251, v245, v251
v_mfma_f32_16x16x32_bf16 a[140:143], a[204:207], v[196:199], a[140:143]
ds_read_b64_tr_b16 v[38:39], v22 offset:6144
s_lshr_b64 s[48:49], s[48:49], 1
v_mfma_f32_16x16x32_bf16 a[16:19], a[208:211], v[188:191], a[16:19]
ds_read_b64_tr_b16 a[228:229], v13 offset:8192
v_mfma_f32_16x16x32_bf16 a[80:83], a[208:211], v[192:195], a[80:83]
ds_read_b64_tr_b16 a[230:231], v13 offset:10240
v_mfma_f32_16x16x32_bf16 a[144:147], a[208:211], v[196:199], a[144:147]
ds_read_b64_tr_b16 v[40:41], v22 offset:8192
s_waitcnt lgkmcnt(7)
v_mfma_f32_16x16x32_bf16 a[20:23], a[212:215], v[188:191], a[20:23]
ds_read_b64_tr_b16 a[232:233], v14 offset:8192
v_mfma_f32_16x16x32_bf16 a[84:87], a[212:215], v[192:195], a[84:87]
ds_read_b64_tr_b16 a[234:235], v14 offset:10240
v_mfma_f32_16x16x32_bf16 a[148:151], a[212:215], v[196:199], a[148:151]
ds_read_b64_tr_b16 v[42:43], v22 offset:10240
v_mfma_f32_16x16x32_bf16 a[24:27], a[216:219], v[188:191], a[24:27]
ds_read_b64_tr_b16 a[236:237], v15 offset:8192
v_mfma_f32_16x16x32_bf16 a[88:91], a[216:219], v[192:195], a[88:91]
ds_read_b64_tr_b16 a[238:239], v15 offset:10240
v_mfma_f32_16x16x32_bf16 a[152:155], a[216:219], v[196:199], a[152:155]
ds_read_b64_tr_b16 v[44:45], v22 offset:12288
v_mfma_f32_16x16x32_bf16 a[28:31], a[220:223], v[188:191], a[28:31]
ds_read_b64_tr_b16 a[240:241], v12 offset:12288
v_mfma_f32_16x16x32_bf16 a[92:95], a[220:223], v[192:195], a[92:95]
ds_read_b64_tr_b16 a[242:243], v12 offset:14336
v_add_u32 v12, s46, v12
v_mfma_f32_16x16x32_bf16 a[156:159], a[220:223], v[196:199], a[156:159]
ds_read_b64_tr_b16 v[46:47], v22 offset:14336
s_waitcnt lgkmcnt(7)
v_mfma_f32_16x16x32_bf16 a[32:35], a[224:227], v[188:191], a[32:35]
ds_read_b64_tr_b16 a[244:245], v13 offset:12288
v_mfma_f32_16x16x32_bf16 a[96:99], a[224:227], v[192:195], a[96:99]
ds_read_b64_tr_b16 a[246:247], v13 offset:14336
v_add_u32 v13, s46, v13
v_mfma_f32_16x16x32_bf16 a[160:163], a[224:227], v[196:199], a[160:163]
ds_read_b64_tr_b16 v[48:49], v22 offset:16384
v_mfma_f32_16x16x32_bf16 a[36:39], a[228:231], v[188:191], a[36:39]
ds_read_b64_tr_b16 a[248:249], v14 offset:12288
v_mfma_f32_16x16x32_bf16 a[100:103], a[228:231], v[192:195], a[100:103]
ds_read_b64_tr_b16 a[250:251], v14 offset:14336
v_add_u32 v14, s46, v14
v_mfma_f32_16x16x32_bf16 a[164:167], a[228:231], v[196:199], a[164:167]
ds_read_b64_tr_b16 v[50:51], v22 offset:18432
v_mfma_f32_16x16x32_bf16 a[40:43], a[232:235], v[188:191], a[40:43]
ds_read_b64_tr_b16 a[252:253], v15 offset:12288
v_mfma_f32_16x16x32_bf16 a[104:107], a[232:235], v[192:195], a[104:107]
ds_read_b64_tr_b16 a[254:255], v15 offset:14336
v_add_u32 v15, s46, v15
v_mfma_f32_16x16x32_bf16 a[168:171], a[232:235], v[196:199], a[168:171]
ds_read_b64_tr_b16 v[52:53], v22 offset:20480
s_waitcnt lgkmcnt(7)
v_mfma_f32_16x16x32_bf16 a[44:47], a[236:239], v[188:191], a[44:47]
ds_read_b64_tr_b16 v[54:55], v22 offset:22528
ds_read_b64_tr_b16 v[56:57], v22 offset:24576
ds_read_b64_tr_b16 v[58:59], v22 offset:26624
ds_read_b64_tr_b16 v[60:61], v22 offset:28672
ds_read_b64_tr_b16 v[62:63], v22 offset:30720
v_mfma_f32_16x16x32_bf16 a[108:111], a[236:239], v[192:195], a[108:111]
buffer_load_dwordx4 v5, s[24:27], s50 offen offset:0 lds
v_mfma_f32_16x16x32_bf16 a[172:175], a[236:239], v[196:199], a[172:175]
s_add_u32 s50, s47, 6144
v_exp_f32 v236, v152
v_mfma_f32_16x16x32_bf16 a[48:51], a[240:243], v[188:191], a[48:51]
buffer_load_dwordx4 v5, s[24:27], s50 offen offset:1024 lds
v_mfma_f32_16x16x32_bf16 a[112:115], a[240:243], v[192:195], a[112:115]
s_waitcnt vmcnt(2) lgkmcnt(0)
s_barrier
s_add_u32 s50, s47, 12288
v_mfma_f32_16x16x32_bf16 a[176:179], a[240:243], v[196:199], a[176:179]
ds_read_b64_tr_b16 a[192:193], v12 offset:0
v_mfma_f32_16x16x32_bf16 a[52:55], a[244:247], v[188:191], a[52:55]
ds_read_b64_tr_b16 a[194:195], v12 offset:2048
v_mfma_f32_16x16x32_bf16 a[116:119], a[244:247], v[192:195], a[116:119]
ds_read_b64_tr_b16 a[196:197], v13 offset:0
v_mfma_f32_16x16x32_bf16 a[180:183], a[244:247], v[196:199], a[180:183]
ds_read_b64_tr_b16 a[198:199], v13 offset:2048
v_mfma_f32_16x16x32_bf16 a[56:59], a[248:251], v[188:191], a[56:59]
ds_read_b64_tr_b16 a[200:201], v14 offset:0
v_mfma_f32_16x16x32_bf16 a[120:123], a[248:251], v[192:195], a[120:123]
ds_read_b64_tr_b16 a[202:203], v14 offset:2048
v_mfma_f32_16x16x32_bf16 a[184:187], a[248:251], v[196:199], a[184:187]
ds_read_b64_tr_b16 a[204:205], v15 offset:0
v_mfma_f32_16x16x32_bf16 a[60:63], a[252:255], v[188:191], a[60:63]
ds_read_b64_tr_b16 a[206:207], v15 offset:2048
v_mfma_f32_16x16x32_bf16 a[124:127], a[252:255], v[192:195], a[124:127]
ds_read_b64_tr_b16 a[208:209], v12 offset:4096
v_mfma_f32_16x16x32_bf16 a[188:191], a[252:255], v[196:199], a[188:191]
ds_read_b64_tr_b16 a[210:211], v12 offset:6144
s_waitcnt lgkmcnt(7)
v_mfma_f32_16x16x32_bf16 a[0:3], a[192:195], v[200:203], a[0:3]
ds_read_b64_tr_b16 a[212:213], v13 offset:4096
v_mfma_f32_16x16x32_bf16 a[64:67], a[192:195], v[204:207], a[64:67]
ds_read_b64_tr_b16 a[214:215], v13 offset:6144
s_waitcnt lgkmcnt(7)
v_mfma_f32_16x16x32_bf16 a[4:7], a[196:199], v[200:203], a[4:7]
buffer_load_dwordx4 v5, s[24:27], s50 offen offset:2048 lds
v_mfma_f32_16x16x32_bf16 a[68:71], a[196:199], v[204:207], a[68:71]
ds_read_b64_tr_b16 a[216:217], v14 offset:4096
s_add_u32 s50, s47, 18432
s_waitcnt lgkmcnt(6)
v_mfma_f32_16x16x32_bf16 a[8:11], a[200:203], v[200:203], a[8:11]
ds_read_b64_tr_b16 a[218:219], v14 offset:6144
v_mfma_f32_16x16x32_bf16 a[72:75], a[200:203], v[204:207], a[72:75]
buffer_load_dwordx4 v5, s[24:27], s50 offen offset:3072 lds
s_waitcnt lgkmcnt(5)
v_mfma_f32_16x16x32_bf16 a[12:15], a[204:207], v[200:203], a[12:15]
ds_read_b64_tr_b16 a[220:221], v15 offset:4096
s_add_u32 m0, s63, 4096
v_mfma_f32_16x16x32_bf16 a[76:79], a[204:207], v[204:207], a[76:79]
ds_read_b64_tr_b16 a[222:223], v15 offset:6144
s_add_u32 s50, s47, 28672
s_waitcnt lgkmcnt(5)
v_mfma_f32_16x16x32_bf16 a[16:19], a[208:211], v[200:203], a[16:19]
buffer_load_dwordx4 v5, s[24:27], s50 offen offset:0 lds
v_mfma_f32_16x16x32_bf16 a[80:83], a[208:211], v[204:207], a[80:83]
ds_read_b64_tr_b16 a[224:225], v12 offset:8192
s_add_u32 s50, s47, 34816
s_waitcnt lgkmcnt(5)
v_mfma_f32_16x16x32_bf16 a[20:23], a[212:215], v[200:203], a[20:23]
ds_read_b64_tr_b16 a[226:227], v12 offset:10240
s_bitcmp1_b64 s[48:49], 0
s_cselect_b32 s46, s45, s44
v_mfma_f32_16x16x32_bf16 a[84:87], a[212:215], v[204:207], a[84:87]
buffer_load_dwordx4 v5, s[24:27], s50 offen offset:1024 lds
s_waitcnt lgkmcnt(4)
v_mfma_f32_16x16x32_bf16 a[24:27], a[216:219], v[200:203], a[24:27]
ds_read_b64_tr_b16 a[228:229], v13 offset:8192
s_add_u32 s50, s47, 40960
v_mfma_f32_16x16x32_bf16 a[88:91], a[216:219], v[204:207], a[88:91]
ds_read_b64_tr_b16 a[230:231], v13 offset:10240
s_lshr_b64 s[48:49], s[48:49], 1
s_waitcnt lgkmcnt(4)
v_mfma_f32_16x16x32_bf16 a[28:31], a[220:223], v[200:203], a[28:31]
buffer_load_dwordx4 v5, s[24:27], s50 offen offset:2048 lds
v_mfma_f32_16x16x32_bf16 a[92:95], a[220:223], v[204:207], a[92:95]
ds_read_b64_tr_b16 a[232:233], v14 offset:8192
s_add_u32 s50, s47, 47104
ds_read_b64_tr_b16 a[234:235], v14 offset:10240
s_waitcnt lgkmcnt(4)
v_mfma_f32_16x16x32_bf16 a[32:35], a[224:227], v[200:203], a[32:35]
ds_read_b64_tr_b16 a[236:237], v15 offset:8192
v_mfma_f32_16x16x32_bf16 a[96:99], a[224:227], v[204:207], a[96:99]
ds_read_b64_tr_b16 a[238:239], v15 offset:10240
buffer_load_dwordx4 v5, s[24:27], s50 offen offset:3072 lds
v_exp_f32 v237, v153
ds_read_b64_tr_b16 v[64:65], v23 offset:0
ds_read_b64_tr_b16 v[66:67], v23 offset:2048
ds_read_b64_tr_b16 v[68:69], v23 offset:4096
ds_read_b64_tr_b16 v[70:71], v23 offset:6144
ds_read_b64_tr_b16 v[72:73], v23 offset:8192
ds_read_b64_tr_b16 v[74:75], v23 offset:10240
ds_read_b64_tr_b16 v[76:77], v23 offset:12288
ds_read_b64_tr_b16 v[78:79], v23 offset:14336
ds_read_b64_tr_b16 v[80:81], v23 offset:16384
ds_read_b64_tr_b16 v[82:83], v23 offset:18432
ds_read_b64_tr_b16 v[84:85], v23 offset:20480
ds_read_b64_tr_b16 v[86:87], v23 offset:22528
ds_read_b64_tr_b16 v[88:89], v23 offset:24576
ds_read_b64_tr_b16 v[90:91], v23 offset:26624
ds_read_b64_tr_b16 v[92:93], v23 offset:28672
ds_read_b64_tr_b16 v[94:95], v23 offset:30720
s_waitcnt lgkmcnt(15)
v_mfma_f32_16x16x32_bf16 a[36:39], a[228:231], v[200:203], a[36:39]
v_exp_f32 v238, v154
v_cvt_pk_bf16_f32 v212, v236, v237
v_add_f32 v247, v236, v237
v_exp_f32 v239, v155
v_exp_f32 v240, v156
v_exp_f32 v241, v157
v_exp_f32 v236, v160
v_exp_f32 v237, v161
v_mfma_f32_16x16x32_bf16 a[100:103], a[228:231], v[204:207], a[100:103]
ds_read_b64_tr_b16 a[240:241], v12 offset:12288
v_cvt_pk_bf16_f32 v213, v238, v239
ds_read_b64_tr_b16 a[242:243], v12 offset:14336
v_add_f32 v247, v238, v247
v_add_f32 v248, v240, v241
v_exp_f32 v242, v158
v_add_f32 v249, v236, v237
v_exp_f32 v238, v162
v_mfma_f32_16x16x32_bf16 a[40:43], a[232:235], v[200:203], a[40:43]
s_add_u32 s47, s47, 128
v_exp_f32 v243, v159
v_add_f32 v247, v239, v247
v_cvt_pk_bf16_f32 v216, v240, v241
v_add_f32 v248, v242, v248
v_exp_f32 v239, v163
v_add_f32 v249, v238, v249
v_exp_f32 v240, v164
v_exp_f32 v241, v165
v_mfma_f32_16x16x32_bf16 a[104:107], a[232:235], v[204:207], a[104:107]
s_waitcnt lgkmcnt(2)
s_barrier
v_add_f32 v248, v243, v248
ds_read_b64_tr_b16 a[244:245], v13 offset:12288
ds_read_b64_tr_b16 a[246:247], v13 offset:14336
v_cvt_pk_bf16_f32 v220, v236, v237
v_add_f32 v249, v239, v249
v_cvt_pk_bf16_f32 v214, v240, v241
v_add_f32 v247, v240, v247
v_exp_f32 v236, v168
v_exp_f32 v240, v172
v_mfma_f32_16x16x32_bf16 a[44:47], a[236:239], v[200:203], a[44:47]
s_cmp_eq_u32 s47, s90
s_cselect_b32 s50, 896, 0
v_exp_f32 v237, v169
v_cvt_pk_bf16_f32 v217, v242, v243
v_add_f32 v247, v241, v247
v_exp_f32 v242, v166
v_exp_f32 v243, v167
v_add_f32 v248, v236, v248
v_exp_f32 v241, v173
v_add_f32 v249, v240, v249
v_mfma_f32_16x16x32_bf16 a[108:111], a[236:239], v[204:207], a[108:111]
ds_read_b64_tr_b16 a[248:249], v14 offset:12288
v_cvt_pk_bf16_f32 v221, v238, v239
ds_read_b64_tr_b16 a[250:251], v14 offset:14336
v_cvt_pk_bf16_f32 v215, v242, v243
v_add_f32 v247, v242, v247
v_add_f32 v248, v237, v248
v_exp_f32 v238, v170
v_add_f32 v249, v241, v249
v_exp_f32 v242, v174
s_waitcnt lgkmcnt(4)
v_mfma_f32_16x16x32_bf16 a[48:51], a[240:243], v[200:203], a[48:51]
s_sub_u32 s47, s47, s50
v_exp_f32 v239, v171
v_add_f32 v247, v243, v247
v_add_f32 v248, v238, v248
v_exp_f32 v243, v175
v_add_f32 v249, v242, v249
v_mfma_f32_16x16x32_bf16 a[112:115], a[240:243], v[204:207], a[112:115]
ds_read_b64_tr_b16 a[252:253], v15 offset:12288
v_add_f32 v248, v239, v248
ds_read_b64_tr_b16 a[254:255], v15 offset:14336
v_add_f32 v249, v243, v249
s_waitcnt lgkmcnt(4)
v_mfma_f32_16x16x32_bf16 a[52:55], a[244:247], v[200:203], a[52:55]
s_add_u32 m0, s63, 65536
v_add_u32 v12, s43, v12
v_max3_f32 v253, v247, v248, v249
v_mfma_f32_16x16x32_bf16 a[116:119], a[244:247], v[204:207], a[116:119]
ds_read_b64_tr_b16 a[192:193], v12 offset:0
v_cmp_lt_f32 vcc, s54, v253
ds_read_b64_tr_b16 a[194:195], v12 offset:2048
s_waitcnt lgkmcnt(4)
v_mfma_f32_16x16x32_bf16 a[56:59], a[248:251], v[200:203], a[56:59]
s_add_u32 s50, s47, 0
v_cvt_pk_bf16_f32 v218, v236, v237
v_cvt_pk_bf16_f32 v219, v238, v239
v_cvt_pk_bf16_f32 v222, v240, v241
v_cvt_pk_bf16_f32 v223, v242, v243
s_cbranch_vccnz L_slow_31
L_ret_31:
v_mfma_f32_16x16x32_bf16 a[120:123], a[248:251], v[204:207], a[120:123]
ds_read_b64_tr_b16 a[208:209], v12 offset:4096
v_add_u32 v13, s43, v13
s_waitcnt lgkmcnt(3)
v_mfma_f32_16x16x32_bf16 a[60:63], a[252:255], v[200:203], a[60:63]
ds_read_b64_tr_b16 a[196:197], v13 offset:0
v_add_u32 v14, s43, v14
ds_read_b64_tr_b16 a[198:199], v13 offset:2048
v_mfma_f32_16x16x32_bf16 a[124:127], a[252:255], v[204:207], a[124:127]
ds_read_b64_tr_b16 a[200:201], v14 offset:0
v_add_u32 v15, s43, v15
s_waitcnt lgkmcnt(4)
v_mfma_f32_16x16x32_bf16 a[0:3], a[192:195], v[212:215], a[0:3]
ds_read_b64_tr_b16 a[202:203], v14 offset:2048
v_add_f32 v250, v247, v250
v_mfma_f32_16x16x32_bf16 a[64:67], a[192:195], v[216:219], a[64:67]
ds_read_b64_tr_b16 a[204:205], v15 offset:0
v_add_f32 v251, v248, v251
v_mfma_f32_16x16x32_bf16 a[128:131], a[192:195], v[220:223], a[128:131]
ds_read_b64_tr_b16 a[206:207], v15 offset:2048
v_add_f32 v252, v249, v252
s_waitcnt lgkmcnt(4)
v_mfma_f32_16x16x32_bf16 a[4:7], a[196:199], v[212:215], a[4:7]
ds_read_b64_tr_b16 a[210:211], v12 offset:6144
v_mov_b32 v30, v251
v_mfma_f32_16x16x32_bf16 a[68:71], a[196:199], v[216:219], a[68:71]
ds_read_b64_tr_b16 a[212:213], v13 offset:4096
v_permlane32_swap_b32 v251, v30
v_mfma_f32_16x16x32_bf16 a[132:135], a[196:199], v[220:223], a[132:135]
ds_read_b64_tr_b16 a[214:215], v13 offset:6144
v_add_f32 v251, v251, v30
s_waitcnt lgkmcnt(5)
v_mfma_f32_16x16x32_bf16 a[8:11], a[200:203], v[212:215], a[8:11]
ds_read_b64_tr_b16 a[216:217], v14 offset:4096
v_mov_b32 v30, v251
v_mfma_f32_16x16x32_bf16 a[72:75], a[200:203], v[216:219], a[72:75]
ds_read_b64_tr_b16 a[218:219], v14 offset:6144
v_permlane16_swap_b32 v251, v30
v_mfma_f32_16x16x32_bf16 a[136:139], a[200:203], v[220:223], a[136:139]
ds_read_b64_tr_b16 a[220:221], v15 offset:4096
v_add_f32 v251, v251, v30
s_waitcnt lgkmcnt(6)
v_mfma_f32_16x16x32_bf16 a[12:15], a[204:207], v[212:215], a[12:15]
ds_read_b64_tr_b16 a[222:223], v15 offset:6144
v_mov_b32 v30, v252
v_mfma_f32_16x16x32_bf16 a[76:79], a[204:207], v[216:219], a[76:79]
ds_read_b64_tr_b16 a[224:225], v12 offset:8192
v_permlane32_swap_b32 v252, v30
v_mfma_f32_16x16x32_bf16 a[140:143], a[204:207], v[220:223], a[140:143]
ds_read_b64_tr_b16 a[226:227], v12 offset:10240
v_add_f32 v252, v252, v30
s_waitcnt lgkmcnt(7)
v_mfma_f32_16x16x32_bf16 a[16:19], a[208:211], v[212:215], a[16:19]
buffer_load_dwordx4 v5, s[24:27], s50 offen offset:0 lds
v_mfma_f32_16x16x32_bf16 a[80:83], a[208:211], v[216:219], a[80:83]
ds_read_b64_tr_b16 a[228:229], v13 offset:8192
s_add_u32 s50, s47, 6144
v_mfma_f32_16x16x32_bf16 a[144:147], a[208:211], v[220:223], a[144:147]
ds_read_b64_tr_b16 a[230:231], v13 offset:10240
v_mov_b32 v30, v252
s_waitcnt lgkmcnt(6)
v_mfma_f32_16x16x32_bf16 a[20:23], a[212:215], v[212:215], a[20:23]
buffer_load_dwordx4 v5, s[24:27], s50 offen offset:1024 lds
v_mfma_f32_16x16x32_bf16 a[84:87], a[212:215], v[216:219], a[84:87]
ds_read_b64_tr_b16 a[232:233], v14 offset:8192
s_add_u32 s50, s47, 12288
v_mfma_f32_16x16x32_bf16 a[148:151], a[212:215], v[220:223], a[148:151]
ds_read_b64_tr_b16 a[234:235], v14 offset:10240
v_permlane16_swap_b32 v252, v30
v_mfma_f32_16x16x32_bf16 a[24:27], a[216:219], v[212:215], a[24:27]
buffer_load_dwordx4 v5, s[24:27], s50 offen offset:2048 lds
v_mfma_f32_16x16x32_bf16 a[88:91], a[216:219], v[216:219], a[88:91]
ds_read_b64_tr_b16 a[236:237], v15 offset:8192
s_add_u32 s50, s47, 18432
v_mfma_f32_16x16x32_bf16 a[152:155], a[216:219], v[220:223], a[152:155]
ds_read_b64_tr_b16 a[238:239], v15 offset:10240
v_add_f32 v252, v252, v30
s_waitcnt lgkmcnt(5)
v_mfma_f32_16x16x32_bf16 a[28:31], a[220:223], v[212:215], a[28:31]
buffer_load_dwordx4 v5, s[24:27], s50 offen offset:3072 lds
v_mfma_f32_16x16x32_bf16 a[92:95], a[220:223], v[216:219], a[92:95]
ds_read_b64_tr_b16 a[240:241], v12 offset:12288
s_add_u32 m0, s63, 69632
v_mfma_f32_16x16x32_bf16 a[156:159], a[220:223], v[220:223], a[156:159]
ds_read_b64_tr_b16 a[242:243], v12 offset:14336
s_add_u32 s50, s47, 28672
v_mfma_f32_16x16x32_bf16 a[32:35], a[224:227], v[212:215], a[32:35]
buffer_load_dwordx4 v5, s[24:27], s50 offen offset:0 lds
v_mfma_f32_16x16x32_bf16 a[96:99], a[224:227], v[216:219], a[96:99]
ds_read_b64_tr_b16 a[244:245], v13 offset:12288
s_add_u32 s50, s47, 34816
v_mfma_f32_16x16x32_bf16 a[160:163], a[224:227], v[220:223], a[160:163]
ds_read_b64_tr_b16 a[246:247], v13 offset:14336
v_mov_b32 v30, v250
s_waitcnt lgkmcnt(5)
v_mfma_f32_16x16x32_bf16 a[36:39], a[228:231], v[212:215], a[36:39]
buffer_load_dwordx4 v5, s[24:27], s50 offen offset:1024 lds
v_mfma_f32_16x16x32_bf16 a[100:103], a[228:231], v[216:219], a[100:103]
ds_read_b64_tr_b16 a[248:249], v14 offset:12288
s_add_u32 s50, s47, 40960
v_mfma_f32_16x16x32_bf16 a[164:167], a[228:231], v[220:223], a[164:167]
ds_read_b64_tr_b16 a[250:251], v14 offset:14336
v_mov_b32 v236, v228
v_mfma_f32_16x16x32_bf16 a[40:43], a[232:235], v[212:215], a[40:43]
buffer_load_dwordx4 v5, s[24:27], s50 offen offset:2048 lds
v_mfma_f32_16x16x32_bf16 a[104:107], a[232:235], v[216:219], a[104:107]
ds_read_b64_tr_b16 a[252:253], v15 offset:12288
s_add_u32 s50, s47, 47104
v_mfma_f32_16x16x32_bf16 a[168:171], a[232:235], v[220:223], a[168:171]
ds_read_b64_tr_b16 a[254:255], v15 offset:14336
v_mov_b32 v237, v251
s_waitcnt lgkmcnt(5)
v_mfma_f32_16x16x32_bf16 a[44:47], a[236:239], v[212:215], a[44:47]
buffer_load_dwordx4 v5, s[24:27], s50 offen offset:3072 lds
v_mfma_f32_16x16x32_bf16 a[108:111], a[236:239], v[216:219], a[108:111]
buffer_store_dwordx2 v[236:237], v31, s[28:31], s53 offen offset:0 sc1
v_mfma_f32_16x16x32_bf16 a[172:175], a[236:239], v[220:223], a[172:175]
v_permlane32_swap_b32 v250, v30
v_add_f32 v250, v250, v30
v_mfma_f32_16x16x32_bf16 a[48:51], a[240:243], v[212:215], a[48:51]
v_mov_b32 v30, v250
v_accvgpr_read_b32 v128, a64
v_mfma_f32_16x16x32_bf16 a[112:115], a[240:243], v[216:219], a[112:115]
v_accvgpr_read_b32 v129, a65
v_accvgpr_read_b32 v130, a66
v_mfma_f32_16x16x32_bf16 a[176:179], a[240:243], v[220:223], a[176:179]
s_waitcnt lgkmcnt(1)
v_accvgpr_read_b32 v131, a67
v_cvt_pk_bf16_f32 v96, v128, v129
v_mfma_f32_16x16x32_bf16 a[52:55], a[244:247], v[212:215], a[52:55]
v_cvt_pk_bf16_f32 v97, v130, v131
v_accvgpr_read_b32 v132, a68
v_mfma_f32_16x16x32_bf16 a[116:119], a[244:247], v[216:219], a[116:119]
v_accvgpr_read_b32 v133, a69
v_accvgpr_read_b32 v134, a70
v_mfma_f32_16x16x32_bf16 a[180:183], a[244:247], v[220:223], a[180:183]
v_accvgpr_read_b32 v135, a71
v_cvt_pk_bf16_f32 v98, v132, v133
v_mfma_f32_16x16x32_bf16 a[56:59], a[248:251], v[212:215], a[56:59]
v_cvt_pk_bf16_f32 v99, v134, v135
v_accvgpr_read_b32 v136, a72
v_mfma_f32_16x16x32_bf16 a[120:123], a[248:251], v[216:219], a[120:123]
buffer_store_dwordx4 v[96:99], v7, s[28:31], s61 offen offset:0 sc1
v_mfma_f32_16x16x32_bf16 a[184:187], a[248:251], v[220:223], a[184:187]
s_waitcnt lgkmcnt(0)
v_accvgpr_read_b32 v137, a73
v_accvgpr_read_b32 v138, a74
v_mfma_f32_16x16x32_bf16 a[60:63], a[252:255], v[212:215], a[60:63]
v_accvgpr_read_b32 v139, a75
v_cvt_pk_bf16_f32 v100, v136, v137
v_mfma_f32_16x16x32_bf16 a[124:127], a[252:255], v[216:219], a[124:127]
v_cvt_pk_bf16_f32 v101, v138, v139
v_accvgpr_read_b32 v140, a76
v_mfma_f32_16x16x32_bf16 a[188:191], a[252:255], v[220:223], a[188:191]
v_accvgpr_read_b32 v141, a77
v_accvgpr_read_b32 v142, a78
v_permlane16_swap_b32 v250, v30
v_add_f32 v250, v250, v30
v_accvgpr_read_b32 v143, a79
v_cvt_pk_bf16_f32 v102, v140, v141
v_cvt_pk_bf16_f32 v103, v142, v143
buffer_store_dwordx4 v[100:103], v7, s[28:31], s61 offen offset:1024 sc1
v_accvgpr_read_b32 v128, a80
v_accvgpr_read_b32 v129, a81
v_accvgpr_read_b32 v130, a82
v_accvgpr_read_b32 v131, a83
v_cvt_pk_bf16_f32 v104, v128, v129
v_cvt_pk_bf16_f32 v105, v130, v131
v_accvgpr_read_b32 v132, a84
v_accvgpr_read_b32 v133, a85
v_accvgpr_read_b32 v134, a86
v_accvgpr_read_b32 v135, a87
v_cvt_pk_bf16_f32 v106, v132, v133
v_cvt_pk_bf16_f32 v107, v134, v135
buffer_store_dwordx4 v[104:107], v7, s[28:31], s61 offen offset:2048 sc1
v_accvgpr_read_b32 v136, a88
v_accvgpr_read_b32 v137, a89
v_accvgpr_read_b32 v138, a90
v_accvgpr_read_b32 v139, a91
v_cvt_pk_bf16_f32 v108, v136, v137
v_cvt_pk_bf16_f32 v109, v138, v139
v_accvgpr_read_b32 v140, a92
v_accvgpr_read_b32 v141, a93
v_accvgpr_read_b32 v142, a94
v_accvgpr_read_b32 v143, a95
v_cvt_pk_bf16_f32 v110, v140, v141
v_cvt_pk_bf16_f32 v111, v142, v143
buffer_store_dwordx4 v[108:111], v7, s[28:31], s61 offen offset:3072 sc1
v_accvgpr_read_b32 v128, a96
v_accvgpr_read_b32 v129, a97
v_accvgpr_read_b32 v130, a98
v_accvgpr_read_b32 v131, a99
v_cvt_pk_bf16_f32 v112, v128, v129
v_cvt_pk_bf16_f32 v113, v130, v131
v_accvgpr_read_b32 v132, a100
v_accvgpr_read_b32 v133, a101
v_accvgpr_read_b32 v134, a102
v_accvgpr_read_b32 v135, a103
v_cvt_pk_bf16_f32 v114, v132, v133
v_cvt_pk_bf16_f32 v115, v134, v135
buffer_store_dwordx4 v[112:115], v7, s[28:31], s62 offen offset:0 sc1
v_accvgpr_read_b32 v136, a104
v_accvgpr_read_b32 v137, a105
v_accvgpr_read_b32 v138, a106
v_accvgpr_read_b32 v139, a107
v_cvt_pk_bf16_f32 v116, v136, v137
v_cvt_pk_bf16_f32 v117, v138, v139
v_accvgpr_read_b32 v140, a108
v_accvgpr_read_b32 v141, a109
v_accvgpr_read_b32 v142, a110
v_accvgpr_read_b32 v143, a111
v_cvt_pk_bf16_f32 v118, v140, v141
v_cvt_pk_bf16_f32 v119, v142, v143
buffer_store_dwordx4 v[116:119], v7, s[28:31], s62 offen offset:1024 sc1
v_accvgpr_read_b32 v128, a112
v_accvgpr_read_b32 v129, a113
v_accvgpr_read_b32 v130, a114
v_accvgpr_read_b32 v131, a115
v_cvt_pk_bf16_f32 v120, v128, v129
v_cvt_pk_bf16_f32 v121, v130, v131
v_accvgpr_read_b32 v132, a116
v_accvgpr_read_b32 v133, a117
v_accvgpr_read_b32 v134, a118
v_accvgpr_read_b32 v135, a119
v_cvt_pk_bf16_f32 v122, v132, v133
v_cvt_pk_bf16_f32 v123, v134, v135
buffer_store_dwordx4 v[120:123], v7, s[28:31], s62 offen offset:2048 sc1
v_accvgpr_read_b32 v136, a120
v_accvgpr_read_b32 v137, a121
v_accvgpr_read_b32 v138, a122
v_accvgpr_read_b32 v139, a123
v_cvt_pk_bf16_f32 v124, v136, v137
v_cvt_pk_bf16_f32 v125, v138, v139
v_accvgpr_read_b32 v140, a124
v_accvgpr_read_b32 v141, a125
v_accvgpr_read_b32 v142, a126
v_accvgpr_read_b32 v143, a127
v_cvt_pk_bf16_f32 v126, v140, v141
v_cvt_pk_bf16_f32 v127, v142, v143
buffer_store_dwordx4 v[124:127], v7, s[28:31], s62 offen offset:3072 sc1
v_add_u32 v8, s63, v7
v_xor_b32 v9, 16384, v8
v_mov_b32 v246, v232
v_mov_b32 v247, v252
v_mov_b32 v244, v224
ds_write_b64 v10, v[246:247] offset:0
s_cmp_eq_u32 s33, 0
s_cbranch_scc1 L_h0
ds_write_b128 v8, a[128:131] offset:32768
ds_write_b128 v8, a[132:135] offset:33792
ds_write_b128 v8, a[136:139] offset:34816
ds_write_b128 v8, a[140:143] offset:35840
ds_write_b128 v8, a[144:147] offset:36864
ds_write_b128 v8, a[148:151] offset:37888
ds_write_b128 v8, a[152:155] offset:38912
ds_write_b128 v8, a[156:159] offset:39936
v_accvgpr_read_b32 v192, a160
v_accvgpr_read_b32 v193, a161
v_accvgpr_read_b32 v194, a162
v_accvgpr_read_b32 v195, a163
v_accvgpr_read_b32 v196, a164
v_accvgpr_read_b32 v197, a165
v_accvgpr_read_b32 v198, a166
v_accvgpr_read_b32 v199, a167
v_accvgpr_read_b32 v200, a168
v_accvgpr_read_b32 v201, a169
v_accvgpr_read_b32 v202, a170
v_accvgpr_read_b32 v203, a171
v_accvgpr_read_b32 v204, a172
v_accvgpr_read_b32 v205, a173
v_accvgpr_read_b32 v206, a174
v_accvgpr_read_b32 v207, a175
v_accvgpr_read_b32 v208, a176
v_accvgpr_read_b32 v209, a177
v_accvgpr_read_b32 v210, a178
v_accvgpr_read_b32 v211, a179
v_accvgpr_read_b32 v212, a180
v_accvgpr_read_b32 v213, a181
v_accvgpr_read_b32 v214, a182
v_accvgpr_read_b32 v215, a183
v_accvgpr_read_b32 v216, a184
v_accvgpr_read_b32 v217, a185
v_accvgpr_read_b32 v218, a186
v_accvgpr_read_b32 v219, a187
v_accvgpr_read_b32 v220, a188
v_accvgpr_read_b32 v221, a189
v_accvgpr_read_b32 v222, a190
v_accvgpr_read_b32 v223, a191
s_branch L_h1
L_h0:
ds_write_b128 v8, a[160:163] offset:32768
ds_write_b128 v8, a[164:167] offset:33792
ds_write_b128 v8, a[168:171] offset:34816
ds_write_b128 v8, a[172:175] offset:35840
ds_write_b128 v8, a[176:179] offset:36864
ds_write_b128 v8, a[180:183] offset:37888
ds_write_b128 v8, a[184:187] offset:38912
ds_write_b128 v8, a[188:191] offset:39936
v_accvgpr_read_b32 v192, a128
v_accvgpr_read_b32 v193, a129
v_accvgpr_read_b32 v194, a130
v_accvgpr_read_b32 v195, a131
v_accvgpr_read_b32 v196, a132
v_accvgpr_read_b32 v197, a133
v_accvgpr_read_b32 v198, a134
v_accvgpr_read_b32 v199, a135
v_accvgpr_read_b32 v200, a136
v_accvgpr_read_b32 v201, a137
v_accvgpr_read_b32 v202, a138
v_accvgpr_read_b32 v203, a139
v_accvgpr_read_b32 v204, a140
v_accvgpr_read_b32 v205, a141
v_accvgpr_read_b32 v206, a142
v_accvgpr_read_b32 v207, a143
v_accvgpr_read_b32 v208, a144
v_accvgpr_read_b32 v209, a145
v_accvgpr_read_b32 v210, a146
v_accvgpr_read_b32 v211, a147
v_accvgpr_read_b32 v212, a148
v_accvgpr_read_b32 v213, a149
v_accvgpr_read_b32 v214, a150
v_accvgpr_read_b32 v215, a151
v_accvgpr_read_b32 v216, a152
v_accvgpr_read_b32 v217, a153
v_accvgpr_read_b32 v218, a154
v_accvgpr_read_b32 v219, a155
v_accvgpr_read_b32 v220, a156
v_accvgpr_read_b32 v221, a157
v_accvgpr_read_b32 v222, a158
v_accvgpr_read_b32 v223, a159
L_h1:
s_lshl_b32 s50, s33, 12
s_add_u32 s50, s50, 32768
s_lshl_b32 s51, s33, 9
s_add_u32 s51, s51, 43008
s_cmp_eq_u32 s34, 1
s_cselect_b32 s52, s57, 0x7ff00000
s_cselect_b32 s53, 0x7ff00000, s58
s_add_u32 s59, s53, s50
s_add_u32 s60, s53, s51
s_add_u32 s61, s52, s50
s_add_u32 s62, s52, s51
s_waitcnt lgkmcnt(0)
s_barrier
ds_read_b64 v[242:243], v11 offset:0
ds_read_b128 v[128:131], v9 offset:32768
ds_read_b128 v[132:135], v9 offset:33792
ds_read_b128 v[136:139], v9 offset:34816
ds_read_b128 v[140:143], v9 offset:35840
ds_read_b128 v[144:147], v9 offset:36864
ds_read_b128 v[148:151], v9 offset:37888
ds_read_b128 v[152:155], v9 offset:38912
ds_read_b128 v[156:159], v9 offset:39936
s_waitcnt vmcnt(0)
s_mov_b32 s55, 0
L_an:
v_cmp_ne_u32 vcc, s83, v19
s_add_u32 s55, s55, 1
s_cbranch_vccz L_and
buffer_load_dword v19, v20, s[4:7], s91 offen sc0 sc1
s_waitcnt vmcnt(0)
s_cmp_lt_u32 s55, 300000
s_cbranch_scc1 L_an
L_and:
s_xor_b32 s44, s82, 4096
s_lshl_b32 s51, s32, 2
s_add_u32 s44, s44, s51
v_mov_b32 v29, 1
v_mov_b32 v30, 0
buffer_store_dword v29, v30, s[28:31], s44 offen offset:64 sc1
s_waitcnt lgkmcnt(8)
v_min_f32 v253, v246, v242
v_sub_f32 v248, v253, v246
v_sub_f32 v236, v253, v242
v_exp_f32 v248, v248
v_exp_f32 v236, v236
v_mov_b32 v246, v253
v_mul_f32 v247, v248, v247
v_fmac_f32 v247, v236, v243
v_mov_b32 v249, v248
v_mov_b32 v237, v236
buffer_store_dwordx2 v[246:247], v31, s[28:31], s62 offen offset:0 sc1
v_pk_mul_f32 v[192:193], v[192:193], v[248:249]
v_pk_mul_f32 v[194:195], v[194:195], v[248:249]
v_pk_mul_f32 v[196:197], v[196:197], v[248:249]
v_pk_mul_f32 v[198:199], v[198:199], v[248:249]
v_pk_mul_f32 v[200:201], v[200:201], v[248:249]
v_pk_mul_f32 v[202:203], v[202:203], v[248:249]
v_pk_mul_f32 v[204:205], v[204:205], v[248:249]
v_pk_mul_f32 v[206:207], v[206:207], v[248:249]
v_pk_mul_f32 v[208:209], v[208:209], v[248:249]
v_pk_mul_f32 v[210:211], v[210:211], v[248:249]
v_pk_mul_f32 v[212:213], v[212:213], v[248:249]
v_pk_mul_f32 v[214:215], v[214:215], v[248:249]
v_pk_mul_f32 v[216:217], v[216:217], v[248:249]
v_pk_mul_f32 v[218:219], v[218:219], v[248:249]
v_pk_mul_f32 v[220:221], v[220:221], v[248:249]
v_pk_mul_f32 v[222:223], v[222:223], v[248:249]
s_waitcnt lgkmcnt(7)
v_pk_fma_f32 v[192:193], v[128:129], v[236:237], v[192:193]
v_pk_fma_f32 v[194:195], v[130:131], v[236:237], v[194:195]
v_cvt_pk_bf16_f32 v160, v192, v193
v_cvt_pk_bf16_f32 v161, v194, v195
s_waitcnt lgkmcnt(6)
v_pk_fma_f32 v[196:197], v[132:133], v[236:237], v[196:197]
v_pk_fma_f32 v[198:199], v[134:135], v[236:237], v[198:199]
v_cvt_pk_bf16_f32 v162, v196, v197
v_cvt_pk_bf16_f32 v163, v198, v199
buffer_store_dwordx4 v[160:163], v7, s[28:31], s61 offen offset:0 sc1
s_waitcnt lgkmcnt(5)
v_pk_fma_f32 v[200:201], v[136:137], v[236:237], v[200:201]
v_pk_fma_f32 v[202:203], v[138:139], v[236:237], v[202:203]
v_cvt_pk_bf16_f32 v164, v200, v201
v_cvt_pk_bf16_f32 v165, v202, v203
s_waitcnt lgkmcnt(4)
v_pk_fma_f32 v[204:205], v[140:141], v[236:237], v[204:205]
v_pk_fma_f32 v[206:207], v[142:143], v[236:237], v[206:207]
v_cvt_pk_bf16_f32 v166, v204, v205
v_cvt_pk_bf16_f32 v167, v206, v207
buffer_store_dwordx4 v[164:167], v7, s[28:31], s61 offen offset:1024 sc1
s_waitcnt lgkmcnt(3)
v_pk_fma_f32 v[208:209], v[144:145], v[236:237], v[208:209]
v_pk_fma_f32 v[210:211], v[146:147], v[236:237], v[210:211]
v_cvt_pk_bf16_f32 v168, v208, v209
v_cvt_pk_bf16_f32 v169, v210, v211
s_waitcnt lgkmcnt(2)
v_pk_fma_f32 v[212:213], v[148:149], v[236:237], v[212:213]
v_pk_fma_f32 v[214:215], v[150:151], v[236:237], v[214:215]
v_cvt_pk_bf16_f32 v170, v212, v213
v_cvt_pk_bf16_f32 v171, v214, v215
buffer_store_dwordx4 v[168:171], v7, s[28:31], s61 offen offset:2048 sc1
s_waitcnt lgkmcnt(1)
v_pk_fma_f32 v[216:217], v[152:153], v[236:237], v[216:217]
v_pk_fma_f32 v[218:219], v[154:155], v[236:237], v[218:219]
v_cvt_pk_bf16_f32 v172, v216, v217
v_cvt_pk_bf16_f32 v173, v218, v219
s_waitcnt lgkmcnt(0)
v_pk_fma_f32 v[220:221], v[156:157], v[236:237], v[220:221]
v_pk_fma_f32 v[222:223], v[158:159], v[236:237], v[222:223]
v_cvt_pk_bf16_f32 v174, v220, v221
v_cvt_pk_bf16_f32 v175, v222, v223
buffer_store_dwordx4 v[172:175], v7, s[28:31], s61 offen offset:3072 sc1
v_accvgpr_read_b32 v128, a0
v_accvgpr_read_b32 v129, a1
v_accvgpr_read_b32 v130, a2
v_accvgpr_read_b32 v131, a3
v_accvgpr_read_b32 v132, a4
v_accvgpr_read_b32 v133, a5
v_accvgpr_read_b32 v134, a6
v_accvgpr_read_b32 v135, a7
v_accvgpr_read_b32 v136, a8
v_accvgpr_read_b32 v137, a9
v_accvgpr_read_b32 v138, a10
v_accvgpr_read_b32 v139, a11
v_accvgpr_read_b32 v140, a12
v_accvgpr_read_b32 v141, a13
v_accvgpr_read_b32 v142, a14
v_accvgpr_read_b32 v143, a15
v_accvgpr_read_b32 v144, a16
v_accvgpr_read_b32 v145, a17
v_accvgpr_read_b32 v146, a18
v_accvgpr_read_b32 v147, a19
v_accvgpr_read_b32 v148, a20
v_accvgpr_read_b32 v149, a21
v_accvgpr_read_b32 v150, a22
v_accvgpr_read_b32 v151, a23
v_accvgpr_read_b32 v152, a24
v_accvgpr_read_b32 v153, a25
v_accvgpr_read_b32 v154, a26
v_accvgpr_read_b32 v155, a27
v_accvgpr_read_b32 v156, a28
v_accvgpr_read_b32 v157, a29
v_accvgpr_read_b32 v158, a30
v_accvgpr_read_b32 v159, a31
v_accvgpr_read_b32 v160, a32
v_accvgpr_read_b32 v161, a33
v_accvgpr_read_b32 v162, a34
v_accvgpr_read_b32 v163, a35
v_accvgpr_read_b32 v164, a36
v_accvgpr_read_b32 v165, a37
v_accvgpr_read_b32 v166, a38
v_accvgpr_read_b32 v167, a39
v_accvgpr_read_b32 v168, a40
v_accvgpr_read_b32 v169, a41
v_accvgpr_read_b32 v170, a42
v_accvgpr_read_b32 v171, a43
v_accvgpr_read_b32 v172, a44
v_accvgpr_read_b32 v173, a45
v_accvgpr_read_b32 v174, a46
v_accvgpr_read_b32 v175, a47
v_accvgpr_read_b32 v176, a48
v_accvgpr_read_b32 v177, a49
v_accvgpr_read_b32 v178, a50
v_accvgpr_read_b32 v179, a51
v_accvgpr_read_b32 v180, a52
v_accvgpr_read_b32 v181, a53
v_accvgpr_read_b32 v182, a54
v_accvgpr_read_b32 v183, a55
v_accvgpr_read_b32 v184, a56
v_accvgpr_read_b32 v185, a57
v_accvgpr_read_b32 v186, a58
v_accvgpr_read_b32 v187, a59
v_accvgpr_read_b32 v188, a60
v_accvgpr_read_b32 v189, a61
v_accvgpr_read_b32 v190, a62
v_accvgpr_read_b32 v191, a63
s_add_u32 s51, s58, s63
s_add_u32 s52, s51, 4096
s_lshl_b32 s53, s32, 9
s_add_u32 s53, s53, s58
s_add_u32 s53, s53, 40960
s_lshl_b32 s50, s32, 2
s_add_u32 s50, s50, s82
s_or_b32 s45, s50, 4
s_mov_b32 s55, 0
buffer_load_dword v253, v30, s[28:31], s50 offen offset:64 sc1
s_waitcnt vmcnt(0)
buffer_store_dword v29, v30, s[28:31], s44 offen offset:80 sc1
s_branch L_p1c
L_p1:
buffer_load_dword v253, v30, s[28:31], s50 offen offset:64 sc1
s_add_u32 s55, s55, 1
s_waitcnt vmcnt(0)
L_p1c:
v_readfirstlane_b32 s46, v253
s_cmp_gt_u32 s55, 300000
s_cbranch_scc1 L_p1d
s_cmp_eq_u32 s46, 0
s_cbranch_scc1 L_p1
L_p1d:
buffer_load_dwordx2 v[240:241], v31, s[28:31], s53 offen offset:0 sc1
buffer_load_dwordx4 v[96:99], v7, s[28:31], s51 offen offset:0 sc1
buffer_load_dwordx4 v[100:103], v7, s[28:31], s51 offen offset:1024 sc1
buffer_load_dwordx4 v[104:107], v7, s[28:31], s51 offen offset:2048 sc1
buffer_load_dwordx4 v[108:111], v7, s[28:31], s51 offen offset:3072 sc1
buffer_load_dwordx4 v[112:115], v7, s[28:31], s52 offen offset:0 sc1
buffer_load_dwordx4 v[116:119], v7, s[28:31], s52 offen offset:1024 sc1
buffer_load_dwordx4 v[120:123], v7, s[28:31], s52 offen offset:2048 sc1
buffer_load_dwordx4 v[124:127], v7, s[28:31], s52 offen offset:3072 sc1
s_barrier
ds_read_b64_tr_b16 a[96:97], v21 offset:0
ds_read_b64_tr_b16 a[98:99], v21 offset:2048
ds_read_b64_tr_b16 a[100:101], v21 offset:4096
ds_read_b64_tr_b16 a[102:103], v21 offset:6144
ds_read_b64_tr_b16 a[104:105], v21 offset:8192
ds_read_b64_tr_b16 a[106:107], v21 offset:10240
ds_read_b64_tr_b16 a[108:109], v21 offset:12288
ds_read_b64_tr_b16 a[110:111], v21 offset:14336
ds_read_b64_tr_b16 a[112:113], v21 offset:16384
ds_read_b64_tr_b16 a[114:115], v21 offset:18432
ds_read_b64_tr_b16 a[116:117], v21 offset:20480
ds_read_b64_tr_b16 a[118:119], v21 offset:22528
s_add_u32 s47, s47, 128
s_cmp_eq_u32 s47, s90
s_cselect_b32 s50, 896, 0
s_sub_u32 s47, s47, s50
s_add_u32 m0, s63, 98304
s_add_u32 s50, s47, 0
buffer_load_dwordx4 v5, s[24:27], s50 offen offset:0 lds
ds_read_b64_tr_b16 a[120:121], v21 offset:24576
ds_read_b64_tr_b16 a[122:123], v21 offset:26624
ds_read_b64_tr_b16 a[124:125], v21 offset:28672
ds_read_b64_tr_b16 a[126:127], v21 offset:30720
ds_read_b64_tr_b16 a[128:129], v22 offset:0
ds_read_b64_tr_b16 a[130:131], v22 offset:2048
ds_read_b64_tr_b16 a[132:133], v22 offset:4096
ds_read_b64_tr_b16 a[134:135], v22 offset:6144
ds_read_b64_tr_b16 a[136:137], v22 offset:8192
ds_read_b64_tr_b16 a[138:139], v22 offset:10240
ds_read_b64_tr_b16 a[140:141], v22 offset:12288
ds_read_b64_tr_b16 a[142:143], v22 offset:14336
s_add_u32 s50, s47, 6144
buffer_load_dwordx4 v5, s[24:27], s50 offen offset:1024 lds
ds_read_b64_tr_b16 a[144:145], v22 offset:16384
ds_read_b64_tr_b16 a[146:147], v22 offset:18432
ds_read_b64_tr_b16 a[148:149], v22 offset:20480
ds_read_b64_tr_b16 a[150:151], v22 offset:22528
ds_read_b64_tr_b16 a[152:153], v22 offset:24576
ds_read_b64_tr_b16 a[154:155], v22 offset:26624
ds_read_b64_tr_b16 a[156:157], v22 offset:28672
ds_read_b64_tr_b16 a[158:159], v22 offset:30720
s_mul_i32 s44, s36, 288
s_mul_i32 s51, s32, 72
s_add_u32 s44, s44, s51
s_lshr_b32 s51, s36, 2
s_add_u32 s50, s47, 12288
buffer_load_dwordx4 v5, s[24:27], s50 offen offset:2048 lds
s_mul_i32 s52, s51, 18
s_lshl_b32 s51, s51, 5
s_mul_i32 s53, s35, 160
s_lshl_b32 s46, s37, 4
s_add_u32 s53, s53, s46
s_mul_i32 s53, s53, 896
s_add_u32 s53, s53, s51
s_mov_b32 s46, 73728
v_add_u32 v2, s44, v1
v_lshlrev_b32 v16, 4, v2
v_lshrrev_b32 v3, 6, v2
v_subrev_u32 v3, s52, v3
s_add_u32 s50, s47, 18432
buffer_load_dwordx4 v5, s[24:27], s50 offen offset:3072 lds
v_and_b32 v4, 15, v2
v_mul_u32_u24 v4, 896, v4
v_bfe_u32 v29, v2, 4, 2
v_lshl_add_u32 v4, v29, 3, v4
v_add_u32 v4, s53, v4
v_lshrrev_b32 v29, 1, v3
v_lshlrev_b32 v2, 1, v3
v_subrev_u32 v2, 28, v2
v_cmp_gt_u32 vcc, 14, v3
s_nop 1
v_cndmask_b32 v29, v2, v29, vcc
v_add_u32 v2, 1, v29
v_cndmask_b32 v13, v2, v29, vcc
s_add_u32 m0, s63, 102400
s_add_u32 s50, s47, 28672
buffer_load_dwordx4 v5, s[24:27], s50 offen offset:0 lds
v_and_b32 v2, 1, v3
v_mul_u32_u24 v2, 57344, v2
v_mov_b32 v20, 114688
v_cndmask_b32 v2, v20, v2, vcc
v_add_u32 v18, v4, v2
v_mov_b32 v2, 28672
v_cndmask_b32 v2, 0, v2, vcc
v_add_u32 v20, v18, v2
v_add_u32 v29, s88, v29
v_subrev_u32 v2, 7, v29
v_min_u32 v29, v29, v2
v_lshl_add_u32 v18, v29, 7, v18
s_add_u32 s50, s47, 34816
buffer_load_dwordx4 v5, s[24:27], s50 offen offset:1024 lds
v_add_u32 v13, s88, v13
v_subrev_u32 v2, 7, v13
v_min_u32 v13, v13, v2
v_lshl_add_u32 v20, v13, 7, v20
v_mov_b32 v2, 0x7ff00000
v_cmp_eq_u32 vcc, 17, v3
s_nop 1
v_cndmask_b32 v20, v20, v2, vcc
v_and_b32 v2, 7, v1
v_add_u32 v2, s44, v2
v_add_u32 v2, 64, v2
v_lshrrev_b32 v3, 3, v1
v_mul_lo_u32 v3, v3, s46
s_add_u32 s50, s47, 40960
buffer_load_dwordx4 v5, s[24:27], s50 offen offset:2048 lds
v_lshl_add_u32 v17, v2, 4, v3
v_lshrrev_b32 v3, 6, v2
v_subrev_u32 v3, s52, v3
v_and_b32 v4, 15, v2
v_mul_u32_u24 v4, 896, v4
v_bfe_u32 v29, v2, 4, 2
v_lshl_add_u32 v4, v29, 3, v4
v_add_u32 v4, s53, v4
v_lshrrev_b32 v29, 1, v3
v_lshlrev_b32 v2, 1, v3
v_subrev_u32 v2, 28, v2
v_cmp_gt_u32 vcc, 14, v3
s_add_u32 s50, s47, 47104
buffer_load_dwordx4 v5, s[24:27], s50 offen offset:3072 lds
v_cndmask_b32 v29, v2, v29, vcc
v_add_u32 v2, 1, v29
v_cndmask_b32 v13, v2, v29, vcc
v_and_b32 v2, 1, v3
v_mul_u32_u24 v2, 57344, v2
v_mov_b32 v6, 114688
v_cndmask_b32 v2, v6, v2, vcc
v_add_u32 v19, v4, v2
v_mov_b32 v2, 28672
v_cndmask_b32 v2, 0, v2, vcc
v_add_u32 v6, v19, v2
v_add_u32 v29, s88, v29
v_subrev_u32 v2, 7, v29
v_min_u32 v29, v29, v2
v_lshl_add_u32 v19, v29, 7, v19
v_add_u32 v13, s88, v13
v_subrev_u32 v2, 7, v13
v_min_u32 v13, v13, v2
v_lshl_add_u32 v6, v13, 7, v6
v_mov_b32 v2, 0x7ff00000
v_cmp_eq_u32 vcc, 17, v3
s_nop 1
v_cndmask_b32 v6, v6, v2, vcc
v_cmp_gt_u32 vcc, 8, v1
s_nop 1
v_cndmask_b32 v19, v2, v19, vcc
v_cndmask_b32 v6, v2, v6, vcc
s_mov_b32 s55, 0
L_p1h:
buffer_load_dword v253, v30, s[28:31], s45 offen offset:80 sc1
s_add_u32 s55, s55, 1
s_waitcnt vmcnt(0)
L_p1hc:
v_readfirstlane_b32 s46, v253
s_cmp_gt_u32 s55, 300000
s_cbranch_scc1 L_p1hd
s_cmp_eq_u32 s46, 0
s_cbranch_scc1 L_p1h
L_p1hd:
buffer_load_dwordx2 v[242:243], v31, s[28:31], s60 offen offset:0 sc1
buffer_load_dwordx4 v[224:227], v7, s[28:31], s59 offen offset:0 sc1
buffer_load_dwordx4 v[228:231], v7, s[28:31], s59 offen offset:1024 sc1
buffer_load_dwordx4 v[232:235], v7, s[28:31], s59 offen offset:2048 sc1
buffer_load_dwordx4 v[236:239], v7, s[28:31], s59 offen offset:3072 sc1
s_waitcnt lgkmcnt(0)
s_barrier
s_lshl_b32 s50, s33, 12
s_lshl_b32 s51, s34, 13
s_add_u32 s50, s50, s51
s_add_u32 s50, s50, 65536
v_add_u32 v9, s50, v7
s_mul_i32 s57, s3, 73728
s_mul_i32 s50, s32, 18432
s_add_u32 s57, s57, s50
s_add_u32 s57, s57, 16777216
s_add_u32 s58, s57, 14336
v_add_u32 v10, 65536, v7
v_min_f32 v253, v244, v240
v_sub_f32 v248, v253, v244
v_sub_f32 v254, v253, v240
v_exp_f32 v248, v248
v_exp_f32 v254, v254
v_mul_f32 v253, v248, v250
v_fmac_f32 v253, v254, v241
v_rcp_f32 v253, v253
s_nop 0
v_mul_f32 v248, v248, v253
v_mul_f32 v254, v254, v253
v_mov_b32 v249, v248
v_mov_b32 v255, v254
v_pk_mul_f32 v[128:129], v[128:129], v[248:249]
v_lshlrev_b32 v240, 16, v96
v_and_b32 v241, 0xffff0000, v96
v_pk_fma_f32 v[128:129], v[240:241], v[254:255], v[128:129]
v_cvt_pk_bf16_f32 v96, v128, v129
v_pk_mul_f32 v[130:131], v[130:131], v[248:249]
v_lshlrev_b32 v244, 16, v97
v_and_b32 v245, 0xffff0000, v97
v_pk_fma_f32 v[130:131], v[244:245], v[254:255], v[130:131]
v_cvt_pk_bf16_f32 v97, v130, v131
v_pk_mul_f32 v[132:133], v[132:133], v[248:249]
v_lshlrev_b32 v240, 16, v98
v_and_b32 v241, 0xffff0000, v98
v_pk_fma_f32 v[132:133], v[240:241], v[254:255], v[132:133]
v_cvt_pk_bf16_f32 v98, v132, v133
v_pk_mul_f32 v[134:135], v[134:135], v[248:249]
v_lshlrev_b32 v244, 16, v99
v_and_b32 v245, 0xffff0000, v99
v_pk_fma_f32 v[134:135], v[244:245], v[254:255], v[134:135]
v_cvt_pk_bf16_f32 v99, v134, v135
ds_write_b128 v8, v[96:99] offset:0
v_pk_mul_f32 v[136:137], v[136:137], v[248:249]
v_lshlrev_b32 v240, 16, v100
v_and_b32 v241, 0xffff0000, v100
v_pk_fma_f32 v[136:137], v[240:241], v[254:255], v[136:137]
v_cvt_pk_bf16_f32 v100, v136, v137
v_pk_mul_f32 v[138:139], v[138:139], v[248:249]
v_lshlrev_b32 v244, 16, v101
v_and_b32 v245, 0xffff0000, v101
v_pk_fma_f32 v[138:139], v[244:245], v[254:255], v[138:139]
v_cvt_pk_bf16_f32 v101, v138, v139
v_pk_mul_f32 v[140:141], v[140:141], v[248:249]
v_lshlrev_b32 v240, 16, v102
v_and_b32 v241, 0xffff0000, v102
v_pk_fma_f32 v[140:141], v[240:241], v[254:255], v[140:141]
v_cvt_pk_bf16_f32 v102, v140, v141
v_pk_mul_f32 v[142:143], v[142:143], v[248:249]
v_lshlrev_b32 v244, 16, v103
v_and_b32 v245, 0xffff0000, v103
v_pk_fma_f32 v[142:143], v[244:245], v[254:255], v[142:143]
v_cvt_pk_bf16_f32 v103, v142, v143
ds_write_b128 v8, v[100:103] offset:1024
v_pk_mul_f32 v[144:145], v[144:145], v[248:249]
v_lshlrev_b32 v240, 16, v104
v_and_b32 v241, 0xffff0000, v104
v_pk_fma_f32 v[144:145], v[240:241], v[254:255], v[144:145]
v_cvt_pk_bf16_f32 v104, v144, v145
v_pk_mul_f32 v[146:147], v[146:147], v[248:249]
v_lshlrev_b32 v244, 16, v105
v_and_b32 v245, 0xffff0000, v105
v_pk_fma_f32 v[146:147], v[244:245], v[254:255], v[146:147]
v_cvt_pk_bf16_f32 v105, v146, v147
v_pk_mul_f32 v[148:149], v[148:149], v[248:249]
v_lshlrev_b32 v240, 16, v106
v_and_b32 v241, 0xffff0000, v106
v_pk_fma_f32 v[148:149], v[240:241], v[254:255], v[148:149]
v_cvt_pk_bf16_f32 v106, v148, v149
v_pk_mul_f32 v[150:151], v[150:151], v[248:249]
v_lshlrev_b32 v244, 16, v107
v_and_b32 v245, 0xffff0000, v107
v_pk_fma_f32 v[150:151], v[244:245], v[254:255], v[150:151]
v_cvt_pk_bf16_f32 v107, v150, v151
ds_write_b128 v8, v[104:107] offset:2048
v_pk_mul_f32 v[152:153], v[152:153], v[248:249]
v_lshlrev_b32 v240, 16, v108
v_and_b32 v241, 0xffff0000, v108
v_pk_fma_f32 v[152:153], v[240:241], v[254:255], v[152:153]
v_cvt_pk_bf16_f32 v108, v152, v153
v_pk_mul_f32 v[154:155], v[154:155], v[248:249]
v_lshlrev_b32 v244, 16, v109
v_and_b32 v245, 0xffff0000, v109
v_pk_fma_f32 v[154:155], v[244:245], v[254:255], v[154:155]
v_cvt_pk_bf16_f32 v109, v154, v155
v_pk_mul_f32 v[156:157], v[156:157], v[248:249]
v_lshlrev_b32 v240, 16, v110
v_and_b32 v241, 0xffff0000, v110
v_pk_fma_f32 v[156:157], v[240:241], v[254:255], v[156:157]
v_cvt_pk_bf16_f32 v110, v156, v157
v_pk_mul_f32 v[158:159], v[158:159], v[248:249]
v_lshlrev_b32 v244, 16, v111
v_and_b32 v245, 0xffff0000, v111
v_pk_fma_f32 v[158:159], v[244:245], v[254:255], v[158:159]
v_cvt_pk_bf16_f32 v111, v158, v159
ds_write_b128 v8, v[108:111] offset:3072
v_pk_mul_f32 v[160:161], v[160:161], v[248:249]
v_lshlrev_b32 v240, 16, v112
v_and_b32 v241, 0xffff0000, v112
v_pk_fma_f32 v[160:161], v[240:241], v[254:255], v[160:161]
v_cvt_pk_bf16_f32 v112, v160, v161
v_pk_mul_f32 v[162:163], v[162:163], v[248:249]
v_lshlrev_b32 v244, 16, v113
v_and_b32 v245, 0xffff0000, v113
v_pk_fma_f32 v[162:163], v[244:245], v[254:255], v[162:163]
v_cvt_pk_bf16_f32 v113, v162, v163
v_pk_mul_f32 v[164:165], v[164:165], v[248:249]
v_lshlrev_b32 v240, 16, v114
v_and_b32 v241, 0xffff0000, v114
v_pk_fma_f32 v[164:165], v[240:241], v[254:255], v[164:165]
v_cvt_pk_bf16_f32 v114, v164, v165
v_pk_mul_f32 v[166:167], v[166:167], v[248:249]
v_lshlrev_b32 v244, 16, v115
v_and_b32 v245, 0xffff0000, v115
v_pk_fma_f32 v[166:167], v[244:245], v[254:255], v[166:167]
v_cvt_pk_bf16_f32 v115, v166, v167
ds_write_b128 v8, v[112:115] offset:4096
v_pk_mul_f32 v[168:169], v[168:169], v[248:249]
v_lshlrev_b32 v240, 16, v116
v_and_b32 v241, 0xffff0000, v116
v_pk_fma_f32 v[168:169], v[240:241], v[254:255], v[168:169]
v_cvt_pk_bf16_f32 v116, v168, v169
v_pk_mul_f32 v[170:171], v[170:171], v[248:249]
v_lshlrev_b32 v244, 16, v117
v_and_b32 v245, 0xffff0000, v117
v_pk_fma_f32 v[170:171], v[244:245], v[254:255], v[170:171]
v_cvt_pk_bf16_f32 v117, v170, v171
v_pk_mul_f32 v[172:173], v[172:173], v[248:249]
v_lshlrev_b32 v240, 16, v118
v_and_b32 v241, 0xffff0000, v118
v_pk_fma_f32 v[172:173], v[240:241], v[254:255], v[172:173]
v_cvt_pk_bf16_f32 v118, v172, v173
v_pk_mul_f32 v[174:175], v[174:175], v[248:249]
v_lshlrev_b32 v244, 16, v119
v_and_b32 v245, 0xffff0000, v119
v_pk_fma_f32 v[174:175], v[244:245], v[254:255], v[174:175]
v_cvt_pk_bf16_f32 v119, v174, v175
ds_write_b128 v8, v[116:119] offset:5120
v_pk_mul_f32 v[176:177], v[176:177], v[248:249]
v_lshlrev_b32 v240, 16, v120
v_and_b32 v241, 0xffff0000, v120
v_pk_fma_f32 v[176:177], v[240:241], v[254:255], v[176:177]
v_cvt_pk_bf16_f32 v120, v176, v177
v_pk_mul_f32 v[178:179], v[178:179], v[248:249]
v_lshlrev_b32 v244, 16, v121
v_and_b32 v245, 0xffff0000, v121
v_pk_fma_f32 v[178:179], v[244:245], v[254:255], v[178:179]
v_cvt_pk_bf16_f32 v121, v178, v179
v_pk_mul_f32 v[180:181], v[180:181], v[248:249]
v_lshlrev_b32 v240, 16, v122
v_and_b32 v241, 0xffff0000, v122
v_pk_fma_f32 v[180:181], v[240:241], v[254:255], v[180:181]
v_cvt_pk_bf16_f32 v122, v180, v181
v_pk_mul_f32 v[182:183], v[182:183], v[248:249]
v_lshlrev_b32 v244, 16, v123
v_and_b32 v245, 0xffff0000, v123
v_pk_fma_f32 v[182:183], v[244:245], v[254:255], v[182:183]
v_cvt_pk_bf16_f32 v123, v182, v183
ds_write_b128 v8, v[120:123] offset:6144
v_pk_mul_f32 v[184:185], v[184:185], v[248:249]
v_lshlrev_b32 v240, 16, v124
v_and_b32 v241, 0xffff0000, v124
v_pk_fma_f32 v[184:185], v[240:241], v[254:255], v[184:185]
v_cvt_pk_bf16_f32 v124, v184, v185
v_pk_mul_f32 v[186:187], v[186:187], v[248:249]
v_lshlrev_b32 v244, 16, v125
v_and_b32 v245, 0xffff0000, v125
v_pk_fma_f32 v[186:187], v[244:245], v[254:255], v[186:187]
v_cvt_pk_bf16_f32 v125, v186, v187
v_pk_mul_f32 v[188:189], v[188:189], v[248:249]
v_lshlrev_b32 v240, 16, v126
v_and_b32 v241, 0xffff0000, v126
v_pk_fma_f32 v[188:189], v[240:241], v[254:255], v[188:189]
v_cvt_pk_bf16_f32 v126, v188, v189
v_pk_mul_f32 v[190:191], v[190:191], v[248:249]
v_lshlrev_b32 v244, 16, v127
v_and_b32 v245, 0xffff0000, v127
v_pk_fma_f32 v[190:191], v[244:245], v[254:255], v[190:191]
v_cvt_pk_bf16_f32 v127, v190, v191
ds_write_b128 v8, v[124:127] offset:7168
s_waitcnt vmcnt(0)
v_min_f32 v253, v246, v242
v_sub_f32 v2, v253, v246
v_sub_f32 v12, v253, v242
v_exp_f32 v2, v2
v_exp_f32 v12, v12
v_mul_f32 v253, v2, v247
v_fmac_f32 v253, v12, v243
v_rcp_f32 v253, v253
s_nop 0
v_mul_f32 v2, v2, v253
v_mul_f32 v12, v12, v253
v_mov_b32 v3, v2
v_mov_b32 v13, v12
v_pk_mul_f32 v[192:193], v[192:193], v[2:3]
v_lshlrev_b32 v240, 16, v224
v_and_b32 v241, 0xffff0000, v224
v_pk_fma_f32 v[192:193], v[240:241], v[12:13], v[192:193]
v_cvt_pk_bf16_f32 v224, v192, v193
v_pk_mul_f32 v[194:195], v[194:195], v[2:3]
v_lshlrev_b32 v244, 16, v225
v_and_b32 v245, 0xffff0000, v225
v_pk_fma_f32 v[194:195], v[244:245], v[12:13], v[194:195]
v_cvt_pk_bf16_f32 v225, v194, v195
v_pk_mul_f32 v[196:197], v[196:197], v[2:3]
v_lshlrev_b32 v240, 16, v226
v_and_b32 v241, 0xffff0000, v226
v_pk_fma_f32 v[196:197], v[240:241], v[12:13], v[196:197]
v_cvt_pk_bf16_f32 v226, v196, v197
v_pk_mul_f32 v[198:199], v[198:199], v[2:3]
v_lshlrev_b32 v244, 16, v227
v_and_b32 v245, 0xffff0000, v227
v_pk_fma_f32 v[198:199], v[244:245], v[12:13], v[198:199]
v_cvt_pk_bf16_f32 v227, v198, v199
ds_write_b128 v9, v[224:227] offset:0
v_pk_mul_f32 v[200:201], v[200:201], v[2:3]
v_lshlrev_b32 v240, 16, v228
v_and_b32 v241, 0xffff0000, v228
v_pk_fma_f32 v[200:201], v[240:241], v[12:13], v[200:201]
v_cvt_pk_bf16_f32 v228, v200, v201
v_pk_mul_f32 v[202:203], v[202:203], v[2:3]
v_lshlrev_b32 v244, 16, v229
v_and_b32 v245, 0xffff0000, v229
v_pk_fma_f32 v[202:203], v[244:245], v[12:13], v[202:203]
v_cvt_pk_bf16_f32 v229, v202, v203
v_pk_mul_f32 v[204:205], v[204:205], v[2:3]
v_lshlrev_b32 v240, 16, v230
v_and_b32 v241, 0xffff0000, v230
v_pk_fma_f32 v[204:205], v[240:241], v[12:13], v[204:205]
v_cvt_pk_bf16_f32 v230, v204, v205
v_pk_mul_f32 v[206:207], v[206:207], v[2:3]
v_lshlrev_b32 v244, 16, v231
v_and_b32 v245, 0xffff0000, v231
v_pk_fma_f32 v[206:207], v[244:245], v[12:13], v[206:207]
v_cvt_pk_bf16_f32 v231, v206, v207
ds_write_b128 v9, v[228:231] offset:1024
v_pk_mul_f32 v[208:209], v[208:209], v[2:3]
v_lshlrev_b32 v240, 16, v232
v_and_b32 v241, 0xffff0000, v232
v_pk_fma_f32 v[208:209], v[240:241], v[12:13], v[208:209]
v_cvt_pk_bf16_f32 v232, v208, v209
v_pk_mul_f32 v[210:211], v[210:211], v[2:3]
v_lshlrev_b32 v244, 16, v233
v_and_b32 v245, 0xffff0000, v233
v_pk_fma_f32 v[210:211], v[244:245], v[12:13], v[210:211]
v_cvt_pk_bf16_f32 v233, v210, v211
v_pk_mul_f32 v[212:213], v[212:213], v[2:3]
v_lshlrev_b32 v240, 16, v234
v_and_b32 v241, 0xffff0000, v234
v_pk_fma_f32 v[212:213], v[240:241], v[12:13], v[212:213]
v_cvt_pk_bf16_f32 v234, v212, v213
v_pk_mul_f32 v[214:215], v[214:215], v[2:3]
v_lshlrev_b32 v244, 16, v235
v_and_b32 v245, 0xffff0000, v235
v_pk_fma_f32 v[214:215], v[244:245], v[12:13], v[214:215]
v_cvt_pk_bf16_f32 v235, v214, v215
ds_write_b128 v9, v[232:235] offset:2048
v_pk_mul_f32 v[216:217], v[216:217], v[2:3]
v_lshlrev_b32 v240, 16, v236
v_and_b32 v241, 0xffff0000, v236
v_pk_fma_f32 v[216:217], v[240:241], v[12:13], v[216:217]
v_cvt_pk_bf16_f32 v236, v216, v217
v_pk_mul_f32 v[218:219], v[218:219], v[2:3]
v_lshlrev_b32 v244, 16, v237
v_and_b32 v245, 0xffff0000, v237
v_pk_fma_f32 v[218:219], v[244:245], v[12:13], v[218:219]
v_cvt_pk_bf16_f32 v237, v218, v219
v_pk_mul_f32 v[220:221], v[220:221], v[2:3]
v_lshlrev_b32 v240, 16, v238
v_and_b32 v241, 0xffff0000, v238
v_pk_fma_f32 v[220:221], v[240:241], v[12:13], v[220:221]
v_cvt_pk_bf16_f32 v238, v220, v221
v_pk_mul_f32 v[222:223], v[222:223], v[2:3]
v_lshlrev_b32 v244, 16, v239
v_and_b32 v245, 0xffff0000, v239
v_pk_fma_f32 v[222:223], v[244:245], v[12:13], v[222:223]
v_cvt_pk_bf16_f32 v239, v222, v223
ds_write_b128 v9, v[236:239] offset:3072
s_waitcnt lgkmcnt(0)
s_barrier
ds_read_b128 a[0:3], v7 offset:0
ds_read_b128 a[32:35], v7 offset:8192
ds_read_b128 a[64:67], v7 offset:16384
ds_read_b128 v[128:131], v7 offset:24576
ds_read_b128 v[160:163], v10 offset:0
ds_read_b128 a[4:7], v7 offset:1024
ds_read_b128 a[36:39], v7 offset:9216
ds_read_b128 a[68:71], v7 offset:17408
ds_read_b128 v[132:135], v7 offset:25600
ds_read_b128 v[164:167], v10 offset:1024
s_waitcnt lgkmcnt(9)
v_mfma_f32_16x16x32_bf16 v[192:195], v[32:35], a[0:3], 0
ds_read_b128 a[8:11], v7 offset:2048
s_waitcnt lgkmcnt(9)
v_mfma_f32_16x16x32_bf16 v[196:199], v[32:35], a[32:35], 0
ds_read_b128 a[40:43], v7 offset:10240
s_add_u32 s47, s47, 128
s_waitcnt lgkmcnt(9)
v_mfma_f32_16x16x32_bf16 v[200:203], v[32:35], a[64:67], 0
ds_read_b128 a[72:75], v7 offset:18432
s_cmp_eq_u32 s47, s90
s_cselect_b32 s50, 896, 0
s_waitcnt lgkmcnt(9)
v_mfma_f32_16x16x32_bf16 v[204:207], v[32:35], v[128:131], 0
ds_read_b128 v[136:139], v7 offset:26624
s_sub_u32 s47, s47, s50
s_waitcnt lgkmcnt(9)
v_mfma_f32_16x16x32_bf16 v[208:211], v[32:35], v[160:163], 0
ds_read_b128 v[168:171], v10 offset:2048
s_add_u32 m0, s63, 32768
s_waitcnt lgkmcnt(9)
v_mfma_f32_16x16x32_bf16 v[192:195], v[36:39], a[4:7], v[192:195]
ds_read_b128 a[12:15], v7 offset:3072
s_add_u32 s50, s47, 0
s_waitcnt lgkmcnt(9)
v_mfma_f32_16x16x32_bf16 v[196:199], v[36:39], a[36:39], v[196:199]
ds_read_b128 a[44:47], v7 offset:11264
s_waitcnt lgkmcnt(7)
v_mfma_f32_16x16x32_bf16 v[200:203], v[36:39], a[68:71], v[200:203]
ds_read_b128 a[76:79], v7 offset:19456
v_mfma_f32_16x16x32_bf16 v[204:207], v[36:39], v[132:135], v[204:207]
ds_read_b128 v[140:143], v7 offset:27648
v_mfma_f32_16x16x32_bf16 v[208:211], v[36:39], v[164:167], v[208:211]
ds_read_b128 v[172:175], v10 offset:3072
s_waitcnt lgkmcnt(7)
v_mfma_f32_16x16x32_bf16 v[192:195], v[40:43], a[8:11], v[192:195]
ds_read_b128 a[16:19], v7 offset:4096
v_mfma_f32_16x16x32_bf16 v[196:199], v[40:43], a[40:43], v[196:199]
ds_read_b128 a[48:51], v7 offset:12288
v_mfma_f32_16x16x32_bf16 v[200:203], v[40:43], a[72:75], v[200:203]
ds_read_b128 a[80:83], v7 offset:20480
s_waitcnt lgkmcnt(7)
v_mfma_f32_16x16x32_bf16 v[204:207], v[40:43], v[136:139], v[204:207]
ds_read_b128 v[144:147], v7 offset:28672
v_mfma_f32_16x16x32_bf16 v[208:211], v[40:43], v[168:171], v[208:211]
ds_read_b128 v[176:179], v10 offset:4096
v_mfma_f32_16x16x32_bf16 v[192:195], v[44:47], a[12:15], v[192:195]
ds_read_b128 a[20:23], v7 offset:5120
s_waitcnt lgkmcnt(7)
v_mfma_f32_16x16x32_bf16 v[196:199], v[44:47], a[44:47], v[196:199]
ds_read_b128 a[52:55], v7 offset:13312
v_mfma_f32_16x16x32_bf16 v[200:203], v[44:47], a[76:79], v[200:203]
ds_read_b128 a[84:87], v7 offset:21504
v_mfma_f32_16x16x32_bf16 v[204:207], v[44:47], v[140:143], v[204:207]
ds_read_b128 v[148:151], v7 offset:29696
s_waitcnt lgkmcnt(7)
v_mfma_f32_16x16x32_bf16 v[208:211], v[44:47], v[172:175], v[208:211]
ds_read_b128 v[180:183], v10 offset:5120
v_mfma_f32_16x16x32_bf16 v[192:195], v[48:51], a[16:19], v[192:195]
ds_read_b128 a[24:27], v7 offset:6144
v_mfma_f32_16x16x32_bf16 v[196:199], v[48:51], a[48:51], v[196:199]
ds_read_b128 a[56:59], v7 offset:14336
s_waitcnt lgkmcnt(7)
v_mfma_f32_16x16x32_bf16 v[200:203], v[48:51], a[80:83], v[200:203]
ds_read_b128 a[88:91], v7 offset:22528
v_mfma_f32_16x16x32_bf16 v[204:207], v[48:51], v[144:147], v[204:207]
ds_read_b128 v[152:155], v7 offset:30720
v_mfma_f32_16x16x32_bf16 v[208:211], v[48:51], v[176:179], v[208:211]
ds_read_b128 v[184:187], v10 offset:6144
s_waitcnt lgkmcnt(7)
v_mfma_f32_16x16x32_bf16 v[192:195], v[52:55], a[20:23], v[192:195]
ds_read_b128 a[28:31], v7 offset:7168
v_mfma_f32_16x16x32_bf16 v[196:199], v[52:55], a[52:55], v[196:199]
ds_read_b128 a[60:63], v7 offset:15360
v_mfma_f32_16x16x32_bf16 v[200:203], v[52:55], a[84:87], v[200:203]
ds_read_b128 a[92:95], v7 offset:23552
s_waitcnt lgkmcnt(7)
v_mfma_f32_16x16x32_bf16 v[204:207], v[52:55], v[148:151], v[204:207]
ds_read_b128 v[156:159], v7 offset:31744
v_mfma_f32_16x16x32_bf16 v[208:211], v[52:55], v[180:183], v[208:211]
ds_read_b128 v[188:191], v10 offset:7168
v_mfma_f32_16x16x32_bf16 v[192:195], v[56:59], a[24:27], v[192:195]
ds_read_b64_tr_b16 a[160:161], v22 offset:32768
s_waitcnt lgkmcnt(7)
v_mfma_f32_16x16x32_bf16 v[196:199], v[56:59], a[56:59], v[196:199]
ds_read_b64_tr_b16 a[162:163], v22 offset:34816
v_mfma_f32_16x16x32_bf16 v[200:203], v[56:59], a[88:91], v[200:203]
ds_read_b64_tr_b16 a[164:165], v22 offset:36864
v_mfma_f32_16x16x32_bf16 v[204:207], v[56:59], v[152:155], v[204:207]
ds_read_b64_tr_b16 a[166:167], v22 offset:38912
s_waitcnt lgkmcnt(7)
v_mfma_f32_16x16x32_bf16 v[208:211], v[56:59], v[184:187], v[208:211]
ds_read_b64_tr_b16 a[168:169], v22 offset:40960
v_mfma_f32_16x16x32_bf16 v[192:195], v[60:63], a[28:31], v[192:195]
ds_read_b64_tr_b16 a[170:171], v22 offset:43008
v_mfma_f32_16x16x32_bf16 v[196:199], v[60:63], a[60:63], v[196:199]
ds_read_b64_tr_b16 a[172:173], v22 offset:45056
s_waitcnt lgkmcnt(7)
v_mfma_f32_16x16x32_bf16 v[200:203], v[60:63], a[92:95], v[200:203]
ds_read_b64_tr_b16 a[174:175], v22 offset:47104
v_mfma_f32_16x16x32_bf16 v[204:207], v[60:63], v[156:159], v[204:207]
ds_read_b64_tr_b16 a[176:177], v22 offset:49152
v_mfma_f32_16x16x32_bf16 v[208:211], v[60:63], v[188:191], v[208:211]
ds_read_b64_tr_b16 a[178:179], v22 offset:51200
v_mfma_f32_16x16x32_bf16 v[212:215], v[64:67], a[0:3], 0
ds_read_b64_tr_b16 a[180:181], v22 offset:53248
v_cvt_pk_bf16_f32 v232, v192, v193
v_mfma_f32_16x16x32_bf16 v[212:215], v[68:71], a[4:7], v[212:215]
ds_read_b64_tr_b16 a[182:183], v22 offset:55296
v_cvt_pk_bf16_f32 v233, v194, v195
v_mfma_f32_16x16x32_bf16 v[212:215], v[72:75], a[8:11], v[212:215]
ds_read_b64_tr_b16 a[184:185], v22 offset:57344
v_cvt_pk_bf16_f32 v234, v196, v197
v_mfma_f32_16x16x32_bf16 v[212:215], v[76:79], a[12:15], v[212:215]
ds_read_b64_tr_b16 a[186:187], v22 offset:59392
v_cvt_pk_bf16_f32 v235, v198, v199
v_mfma_f32_16x16x32_bf16 v[212:215], v[80:83], a[16:19], v[212:215]
ds_read_b64_tr_b16 a[188:189], v22 offset:61440
v_cvt_pk_bf16_f32 v236, v200, v201
v_mfma_f32_16x16x32_bf16 v[212:215], v[84:87], a[20:23], v[212:215]
ds_read_b64_tr_b16 a[190:191], v22 offset:63488
v_cvt_pk_bf16_f32 v237, v202, v203
v_mfma_f32_16x16x32_bf16 v[212:215], v[88:91], a[24:27], v[212:215]
buffer_load_dwordx4 v5, s[24:27], s50 offen offset:0 lds
v_cvt_pk_bf16_f32 v238, v204, v205
v_mfma_f32_16x16x32_bf16 v[212:215], v[92:95], a[28:31], v[212:215]
buffer_store_dwordx4 v[232:235], v7, s[28:31], s57 offen offset:0 sc1
v_cvt_pk_bf16_f32 v239, v206, v207
v_mfma_f32_16x16x32_bf16 v[216:219], v[64:67], a[32:35], 0
buffer_store_dwordx4 v[236:239], v7, s[28:31], s57 offen offset:1024 sc1
v_cvt_pk_bf16_f32 v248, v208, v209
v_mfma_f32_16x16x32_bf16 v[216:219], v[68:71], a[36:39], v[216:219]
s_add_u32 s50, s47, 6144
v_cvt_pk_bf16_f32 v249, v210, v211
v_mfma_f32_16x16x32_bf16 v[216:219], v[72:75], a[40:43], v[216:219]
buffer_load_dwordx4 v5, s[24:27], s50 offen offset:1024 lds
s_add_u32 s50, s47, 12288
v_mfma_f32_16x16x32_bf16 v[216:219], v[76:79], a[44:47], v[216:219]
s_and_b32 s45, s3, 0xf0
s_mul_i32 s59, s45, 73728
s_add_u32 s59, s59, 16777216
v_mfma_f32_16x16x32_bf16 v[216:219], v[80:83], a[48:51], v[216:219]
s_add_u32 s60, s59, 589824
v_cvt_pk_bf16_f32 v240, v212, v213
v_cvt_pk_bf16_f32 v241, v214, v215
v_mfma_f32_16x16x32_bf16 v[216:219], v[84:87], a[52:55], v[216:219]
s_lshl_b32 s44, s32, 2
s_add_u32 s44, s44, s45
s_lshl_b32 s44, s44, 8
v_mfma_f32_16x16x32_bf16 v[216:219], v[88:91], a[56:59], v[216:219]
buffer_load_dwordx4 v5, s[24:27], s50 offen offset:2048 lds
s_add_u32 s50, s47, 18432
v_mfma_f32_16x16x32_bf16 v[216:219], v[92:95], a[60:63], v[216:219]
s_lshl_b32 s53, s36, 2
s_add_u32 s44, s44, s53
s_add_u32 s44, s44, 58720256
v_mfma_f32_16x16x32_bf16 v[220:223], v[64:67], a[64:67], 0
v_and_b32 v2, 3, v1
v_lshlrev_b32 v2, 8, v2
v_mfma_f32_16x16x32_bf16 v[220:223], v[68:71], a[68:71], v[220:223]
v_and_b32 v3, 15, v1
v_lshlrev_b32 v3, 2, v3
v_mfma_f32_16x16x32_bf16 v[220:223], v[72:75], a[72:75], v[220:223]
buffer_load_dwordx4 v5, s[24:27], s50 offen offset:3072 lds
s_add_u32 m0, s63, 36864
v_mfma_f32_16x16x32_bf16 v[220:223], v[76:79], a[76:79], v[220:223]
s_add_u32 s50, s47, 28672
v_mov_b32 v29, 1
s_mov_b32 s52, 0
v_mfma_f32_16x16x32_bf16 v[220:223], v[80:83], a[80:83], v[220:223]
v_cvt_pk_bf16_f32 v242, v216, v217
v_cvt_pk_bf16_f32 v243, v218, v219
v_mfma_f32_16x16x32_bf16 v[220:223], v[84:87], a[84:87], v[220:223]
buffer_store_dwordx4 v[240:243], v7, s[28:31], s57 offen offset:2048 sc1
v_mfma_f32_16x16x32_bf16 v[220:223], v[88:91], a[88:91], v[220:223]
buffer_load_dwordx4 v5, s[24:27], s50 offen offset:0 lds
s_add_u32 s50, s47, 34816
v_mfma_f32_16x16x32_bf16 v[220:223], v[92:95], a[92:95], v[220:223]
v_mfma_f32_16x16x32_bf16 v[224:227], v[64:67], v[128:131], 0
v_mfma_f32_16x16x32_bf16 v[224:227], v[68:71], v[132:135], v[224:227]
v_mfma_f32_16x16x32_bf16 v[224:227], v[72:75], v[136:139], v[224:227]
buffer_load_dwordx4 v5, s[24:27], s50 offen offset:1024 lds
s_add_u32 s50, s47, 40960
v_mfma_f32_16x16x32_bf16 v[224:227], v[76:79], v[140:143], v[224:227]
v_mfma_f32_16x16x32_bf16 v[224:227], v[80:83], v[144:147], v[224:227]
s_nop 0
v_cvt_pk_bf16_f32 v244, v220, v221
v_cvt_pk_bf16_f32 v245, v222, v223
v_mfma_f32_16x16x32_bf16 v[224:227], v[84:87], v[148:151], v[224:227]
v_mfma_f32_16x16x32_bf16 v[224:227], v[88:91], v[152:155], v[224:227]
buffer_load_dwordx4 v5, s[24:27], s50 offen offset:2048 lds
s_add_u32 s50, s47, 47104
v_mfma_f32_16x16x32_bf16 v[224:227], v[92:95], v[156:159], v[224:227]
v_mfma_f32_16x16x32_bf16 v[228:231], v[64:67], v[160:163], 0
v_mfma_f32_16x16x32_bf16 v[228:231], v[68:71], v[164:167], v[228:231]
v_mfma_f32_16x16x32_bf16 v[228:231], v[72:75], v[168:171], v[228:231]
buffer_load_dwordx4 v5, s[24:27], s50 offen offset:3072 lds
s_add_u32 s47, s47, 128
v_mfma_f32_16x16x32_bf16 v[228:231], v[76:79], v[172:175], v[228:231]
s_cmp_eq_u32 s47, s90
s_cselect_b32 s50, 896, 0
s_sub_u32 s47, s47, s50
s_add_u32 m0, s63, 131072
v_mfma_f32_16x16x32_bf16 v[228:231], v[80:83], v[176:179], v[228:231]
s_add_u32 s50, s47, 0
v_cvt_pk_bf16_f32 v246, v224, v225
v_cvt_pk_bf16_f32 v247, v226, v227
v_mfma_f32_16x16x32_bf16 v[228:231], v[84:87], v[180:183], v[228:231]
buffer_load_dwordx4 v5, s[24:27], s50 offen offset:0 lds
s_add_u32 s50, s47, 6144
v_mfma_f32_16x16x32_bf16 v[228:231], v[88:91], v[184:187], v[228:231]
buffer_store_dwordx4 v[244:247], v7, s[28:31], s57 offen offset:3072 sc1
s_add_u32 s57, s57, 4096
v_mfma_f32_16x16x32_bf16 v[228:231], v[92:95], v[188:191], v[228:231]
v_mfma_f32_16x16x32_bf16 v[192:195], a[96:99], a[0:3], 0
v_mfma_f32_16x16x32_bf16 v[192:195], a[100:103], a[4:7], v[192:195]
buffer_load_dwordx4 v5, s[24:27], s50 offen offset:1024 lds
s_add_u32 s50, s47, 12288
v_mfma_f32_16x16x32_bf16 v[192:195], a[104:107], a[8:11], v[192:195]
v_mfma_f32_16x16x32_bf16 v[192:195], a[108:111], a[12:15], v[192:195]
v_mfma_f32_16x16x32_bf16 v[192:195], a[112:115], a[16:19], v[192:195]
s_nop 0
v_cvt_pk_bf16_f32 v250, v228, v229
v_cvt_pk_bf16_f32 v251, v230, v231
v_mfma_f32_16x16x32_bf16 v[192:195], a[116:119], a[20:23], v[192:195]
buffer_store_dwordx4 v[248:251], v7, s[28:31], s58 offen offset:0 sc1
v_mfma_f32_16x16x32_bf16 v[192:195], a[120:123], a[24:27], v[192:195]
buffer_load_dwordx4 v5, s[24:27], s50 offen offset:2048 lds
s_add_u32 s50, s47, 18432
v_mfma_f32_16x16x32_bf16 v[192:195], a[124:127], a[28:31], v[192:195]
v_mfma_f32_16x16x32_bf16 v[196:199], a[96:99], a[32:35], 0
v_mfma_f32_16x16x32_bf16 v[196:199], a[100:103], a[36:39], v[196:199]
v_mfma_f32_16x16x32_bf16 v[196:199], a[104:107], a[40:43], v[196:199]
buffer_load_dwordx4 v5, s[24:27], s50 offen offset:3072 lds
s_add_u32 m0, s63, 135168
v_mfma_f32_16x16x32_bf16 v[196:199], a[108:111], a[44:47], v[196:199]
s_add_u32 s50, s47, 28672
v_mfma_f32_16x16x32_bf16 v[196:199], a[112:115], a[48:51], v[196:199]
v_cvt_pk_bf16_f32 v232, v192, v193
v_cvt_pk_bf16_f32 v233, v194, v195
v_mfma_f32_16x16x32_bf16 v[196:199], a[116:119], a[52:55], v[196:199]
v_mfma_f32_16x16x32_bf16 v[196:199], a[120:123], a[56:59], v[196:199]
buffer_load_dwordx4 v5, s[24:27], s50 offen offset:0 lds
s_add_u32 s50, s47, 34816
v_mfma_f32_16x16x32_bf16 v[196:199], a[124:127], a[60:63], v[196:199]
v_mfma_f32_16x16x32_bf16 v[200:203], a[96:99], a[64:67], 0
v_mfma_f32_16x16x32_bf16 v[200:203], a[100:103], a[68:71], v[200:203]
v_mfma_f32_16x16x32_bf16 v[200:203], a[104:107], a[72:75], v[200:203]
buffer_load_dwordx4 v5, s[24:27], s50 offen offset:1024 lds
s_add_u32 s50, s47, 40960
v_mfma_f32_16x16x32_bf16 v[200:203], a[108:111], a[76:79], v[200:203]
v_mfma_f32_16x16x32_bf16 v[200:203], a[112:115], a[80:83], v[200:203]
s_nop 0
v_cvt_pk_bf16_f32 v234, v196, v197
v_cvt_pk_bf16_f32 v235, v198, v199
v_mfma_f32_16x16x32_bf16 v[200:203], a[116:119], a[84:87], v[200:203]
buffer_store_dwordx4 v[232:235], v7, s[28:31], s57 offen offset:0 sc1
v_mfma_f32_16x16x32_bf16 v[200:203], a[120:123], a[88:91], v[200:203]
buffer_load_dwordx4 v5, s[24:27], s50 offen offset:2048 lds
s_add_u32 s50, s47, 47104
v_mfma_f32_16x16x32_bf16 v[200:203], a[124:127], a[92:95], v[200:203]
v_mfma_f32_16x16x32_bf16 v[204:207], a[96:99], v[128:131], 0
v_mfma_f32_16x16x32_bf16 v[204:207], a[100:103], v[132:135], v[204:207]
v_mfma_f32_16x16x32_bf16 v[204:207], a[104:107], v[136:139], v[204:207]
buffer_load_dwordx4 v5, s[24:27], s50 offen offset:3072 lds
v_mfma_f32_16x16x32_bf16 v[204:207], a[108:111], v[140:143], v[204:207]
v_mfma_f32_16x16x32_bf16 v[204:207], a[112:115], v[144:147], v[204:207]
s_nop 1
v_cvt_pk_bf16_f32 v236, v200, v201
v_cvt_pk_bf16_f32 v237, v202, v203
v_mfma_f32_16x16x32_bf16 v[204:207], a[116:119], v[148:151], v[204:207]
v_mfma_f32_16x16x32_bf16 v[204:207], a[120:123], v[152:155], v[204:207]
v_mfma_f32_16x16x32_bf16 v[204:207], a[124:127], v[156:159], v[204:207]
v_mfma_f32_16x16x32_bf16 v[208:211], a[96:99], v[160:163], 0
v_mfma_f32_16x16x32_bf16 v[208:211], a[100:103], v[164:167], v[208:211]
v_mfma_f32_16x16x32_bf16 v[208:211], a[104:107], v[168:171], v[208:211]
v_mfma_f32_16x16x32_bf16 v[208:211], a[108:111], v[172:175], v[208:211]
v_mfma_f32_16x16x32_bf16 v[208:211], a[112:115], v[176:179], v[208:211]
s_nop 2
v_cvt_pk_bf16_f32 v238, v204, v205
v_cvt_pk_bf16_f32 v239, v206, v207
v_mfma_f32_16x16x32_bf16 v[208:211], a[116:119], v[180:183], v[208:211]
buffer_store_dwordx4 v[236:239], v7, s[28:31], s57 offen offset:1024 sc1
v_mfma_f32_16x16x32_bf16 v[208:211], a[120:123], v[184:187], v[208:211]
v_mfma_f32_16x16x32_bf16 v[208:211], a[124:127], v[188:191], v[208:211]
v_mfma_f32_16x16x32_bf16 v[212:215], a[128:131], a[0:3], 0
v_mfma_f32_16x16x32_bf16 v[212:215], a[132:135], a[4:7], v[212:215]
v_mfma_f32_16x16x32_bf16 v[212:215], a[136:139], a[8:11], v[212:215]
v_mfma_f32_16x16x32_bf16 v[212:215], a[140:143], a[12:15], v[212:215]
v_mfma_f32_16x16x32_bf16 v[212:215], a[144:147], a[16:19], v[212:215]
s_nop 2
v_cvt_pk_bf16_f32 v248, v208, v209
v_cvt_pk_bf16_f32 v249, v210, v211
v_mfma_f32_16x16x32_bf16 v[212:215], a[148:151], a[20:23], v[212:215]
v_mfma_f32_16x16x32_bf16 v[212:215], a[152:155], a[24:27], v[212:215]
v_mfma_f32_16x16x32_bf16 v[212:215], a[156:159], a[28:31], v[212:215]
v_mfma_f32_16x16x32_bf16 v[216:219], a[128:131], a[32:35], 0
v_mfma_f32_16x16x32_bf16 v[216:219], a[132:135], a[36:39], v[216:219]
v_mfma_f32_16x16x32_bf16 v[216:219], a[136:139], a[40:43], v[216:219]
v_mfma_f32_16x16x32_bf16 v[216:219], a[140:143], a[44:47], v[216:219]
v_mfma_f32_16x16x32_bf16 v[216:219], a[144:147], a[48:51], v[216:219]
s_nop 2
v_cvt_pk_bf16_f32 v240, v212, v213
v_cvt_pk_bf16_f32 v241, v214, v215
v_mfma_f32_16x16x32_bf16 v[216:219], a[148:151], a[52:55], v[216:219]
v_mfma_f32_16x16x32_bf16 v[216:219], a[152:155], a[56:59], v[216:219]
v_mfma_f32_16x16x32_bf16 v[216:219], a[156:159], a[60:63], v[216:219]
v_mfma_f32_16x16x32_bf16 v[220:223], a[128:131], a[64:67], 0
v_mfma_f32_16x16x32_bf16 v[220:223], a[132:135], a[68:71], v[220:223]
v_mfma_f32_16x16x32_bf16 v[220:223], a[136:139], a[72:75], v[220:223]
v_mfma_f32_16x16x32_bf16 v[220:223], a[140:143], a[76:79], v[220:223]
v_mfma_f32_16x16x32_bf16 v[220:223], a[144:147], a[80:83], v[220:223]
s_nop 2
v_cvt_pk_bf16_f32 v242, v216, v217
v_cvt_pk_bf16_f32 v243, v218, v219
v_mfma_f32_16x16x32_bf16 v[220:223], a[148:151], a[84:87], v[220:223]
buffer_store_dwordx4 v[240:243], v7, s[28:31], s57 offen offset:2048 sc1
v_mfma_f32_16x16x32_bf16 v[220:223], a[152:155], a[88:91], v[220:223]
v_mfma_f32_16x16x32_bf16 v[220:223], a[156:159], a[92:95], v[220:223]
v_mfma_f32_16x16x32_bf16 v[224:227], a[128:131], v[128:131], 0
v_mfma_f32_16x16x32_bf16 v[224:227], a[132:135], v[132:135], v[224:227]
v_mfma_f32_16x16x32_bf16 v[224:227], a[136:139], v[136:139], v[224:227]
v_mfma_f32_16x16x32_bf16 v[224:227], a[140:143], v[140:143], v[224:227]
v_mfma_f32_16x16x32_bf16 v[224:227], a[144:147], v[144:147], v[224:227]
s_nop 2
v_cvt_pk_bf16_f32 v244, v220, v221
v_cvt_pk_bf16_f32 v245, v222, v223
v_mfma_f32_16x16x32_bf16 v[224:227], a[148:151], v[148:151], v[224:227]
v_mfma_f32_16x16x32_bf16 v[224:227], a[152:155], v[152:155], v[224:227]
v_mfma_f32_16x16x32_bf16 v[224:227], a[156:159], v[156:159], v[224:227]
v_mfma_f32_16x16x32_bf16 v[228:231], a[128:131], v[160:163], 0
v_mfma_f32_16x16x32_bf16 v[228:231], a[132:135], v[164:167], v[228:231]
v_mfma_f32_16x16x32_bf16 v[228:231], a[136:139], v[168:171], v[228:231]
v_mfma_f32_16x16x32_bf16 v[228:231], a[140:143], v[172:175], v[228:231]
v_mfma_f32_16x16x32_bf16 v[228:231], a[144:147], v[176:179], v[228:231]
s_nop 2
v_cvt_pk_bf16_f32 v246, v224, v225
v_cvt_pk_bf16_f32 v247, v226, v227
v_mfma_f32_16x16x32_bf16 v[228:231], a[148:151], v[180:183], v[228:231]
buffer_store_dwordx4 v[244:247], v7, s[28:31], s57 offen offset:3072 sc1
s_add_u32 s57, s57, 4096
v_mfma_f32_16x16x32_bf16 v[228:231], a[152:155], v[184:187], v[228:231]
v_mfma_f32_16x16x32_bf16 v[228:231], a[156:159], v[188:191], v[228:231]
s_waitcnt lgkmcnt(0)
v_mfma_f32_16x16x32_bf16 v[192:195], a[160:163], a[0:3], 0
v_mfma_f32_16x16x32_bf16 v[192:195], a[164:167], a[4:7], v[192:195]
v_mfma_f32_16x16x32_bf16 v[192:195], a[168:171], a[8:11], v[192:195]
v_mfma_f32_16x16x32_bf16 v[192:195], a[172:175], a[12:15], v[192:195]
v_mfma_f32_16x16x32_bf16 v[192:195], a[176:179], a[16:19], v[192:195]
s_nop 1
v_cvt_pk_bf16_f32 v250, v228, v229
v_cvt_pk_bf16_f32 v251, v230, v231
v_mfma_f32_16x16x32_bf16 v[192:195], a[180:183], a[20:23], v[192:195]
buffer_store_dwordx4 v[248:251], v7, s[28:31], s58 offen offset:1024 sc1
v_mfma_f32_16x16x32_bf16 v[192:195], a[184:187], a[24:27], v[192:195]
s_waitcnt vmcnt(15)
s_barrier
v_mfma_f32_16x16x32_bf16 v[192:195], a[188:191], a[28:31], v[192:195]
ds_read_b64_tr_b16 a[192:193], v21 offset:32768
v_mfma_f32_16x16x32_bf16 v[196:199], a[160:163], a[32:35], 0
ds_read_b64_tr_b16 a[194:195], v21 offset:34816
v_mfma_f32_16x16x32_bf16 v[196:199], a[164:167], a[36:39], v[196:199]
ds_read_b64_tr_b16 a[196:197], v21 offset:36864
v_mfma_f32_16x16x32_bf16 v[196:199], a[168:171], a[40:43], v[196:199]
ds_read_b64_tr_b16 a[198:199], v21 offset:38912
v_mfma_f32_16x16x32_bf16 v[196:199], a[172:175], a[44:47], v[196:199]
ds_read_b64_tr_b16 a[200:201], v21 offset:40960
v_mfma_f32_16x16x32_bf16 v[196:199], a[176:179], a[48:51], v[196:199]
ds_read_b64_tr_b16 a[202:203], v21 offset:43008
v_cvt_pk_bf16_f32 v232, v192, v193
v_mfma_f32_16x16x32_bf16 v[196:199], a[180:183], a[52:55], v[196:199]
ds_read_b64_tr_b16 a[204:205], v21 offset:45056
v_cvt_pk_bf16_f32 v233, v194, v195
v_mfma_f32_16x16x32_bf16 v[196:199], a[184:187], a[56:59], v[196:199]
ds_read_b64_tr_b16 a[206:207], v21 offset:47104
v_mfma_f32_16x16x32_bf16 v[196:199], a[188:191], a[60:63], v[196:199]
ds_read_b64_tr_b16 a[208:209], v21 offset:49152
v_mfma_f32_16x16x32_bf16 v[200:203], a[160:163], a[64:67], 0
ds_read_b64_tr_b16 a[210:211], v21 offset:51200
v_mfma_f32_16x16x32_bf16 v[200:203], a[164:167], a[68:71], v[200:203]
ds_read_b64_tr_b16 a[212:213], v21 offset:53248
v_mfma_f32_16x16x32_bf16 v[200:203], a[168:171], a[72:75], v[200:203]
ds_read_b64_tr_b16 a[214:215], v21 offset:55296
v_mfma_f32_16x16x32_bf16 v[200:203], a[172:175], a[76:79], v[200:203]
ds_read_b64_tr_b16 a[216:217], v21 offset:57344
v_mfma_f32_16x16x32_bf16 v[200:203], a[176:179], a[80:83], v[200:203]
ds_read_b64_tr_b16 a[218:219], v21 offset:59392
v_cvt_pk_bf16_f32 v234, v196, v197
v_mfma_f32_16x16x32_bf16 v[200:203], a[180:183], a[84:87], v[200:203]
ds_read_b64_tr_b16 a[220:221], v21 offset:61440
v_cvt_pk_bf16_f32 v235, v198, v199
v_mfma_f32_16x16x32_bf16 v[200:203], a[184:187], a[88:91], v[200:203]
ds_read_b64_tr_b16 a[222:223], v21 offset:63488
v_mfma_f32_16x16x32_bf16 v[200:203], a[188:191], a[92:95], v[200:203]
buffer_store_dwordx4 v[232:235], v7, s[28:31], s57 offen offset:0 sc1
v_mfma_f32_16x16x32_bf16 v[204:207], a[160:163], v[128:131], 0
v_mfma_f32_16x16x32_bf16 v[204:207], a[164:167], v[132:135], v[204:207]
v_mfma_f32_16x16x32_bf16 v[204:207], a[168:171], v[136:139], v[204:207]
v_mfma_f32_16x16x32_bf16 v[204:207], a[172:175], v[140:143], v[204:207]
v_mfma_f32_16x16x32_bf16 v[204:207], a[176:179], v[144:147], v[204:207]
s_nop 1
v_cvt_pk_bf16_f32 v236, v200, v201
v_cvt_pk_bf16_f32 v237, v202, v203
v_mfma_f32_16x16x32_bf16 v[204:207], a[180:183], v[148:151], v[204:207]
v_mfma_f32_16x16x32_bf16 v[204:207], a[184:187], v[152:155], v[204:207]
v_mfma_f32_16x16x32_bf16 v[204:207], a[188:191], v[156:159], v[204:207]
v_mfma_f32_16x16x32_bf16 v[208:211], a[160:163], v[160:163], 0
v_mfma_f32_16x16x32_bf16 v[208:211], a[164:167], v[164:167], v[208:211]
v_mfma_f32_16x16x32_bf16 v[208:211], a[168:171], v[168:171], v[208:211]
v_mfma_f32_16x16x32_bf16 v[208:211], a[172:175], v[172:175], v[208:211]
v_mfma_f32_16x16x32_bf16 v[208:211], a[176:179], v[176:179], v[208:211]
s_nop 2
v_cvt_pk_bf16_f32 v238, v204, v205
v_cvt_pk_bf16_f32 v239, v206, v207
v_mfma_f32_16x16x32_bf16 v[208:211], a[180:183], v[180:183], v[208:211]
buffer_store_dwordx4 v[236:239], v7, s[28:31], s57 offen offset:1024 sc1
v_mfma_f32_16x16x32_bf16 v[208:211], a[184:187], v[184:187], v[208:211]
v_mfma_f32_16x16x32_bf16 v[208:211], a[188:191], v[188:191], v[208:211]
s_waitcnt lgkmcnt(0)
v_mfma_f32_16x16x32_bf16 v[212:215], a[192:195], a[0:3], 0
v_mfma_f32_16x16x32_bf16 v[212:215], a[196:199], a[4:7], v[212:215]
v_mfma_f32_16x16x32_bf16 v[212:215], a[200:203], a[8:11], v[212:215]
v_mfma_f32_16x16x32_bf16 v[212:215], a[204:207], a[12:15], v[212:215]
v_mfma_f32_16x16x32_bf16 v[212:215], a[208:211], a[16:19], v[212:215]
s_nop 1
v_cvt_pk_bf16_f32 v248, v208, v209
v_cvt_pk_bf16_f32 v249, v210, v211
v_mfma_f32_16x16x32_bf16 v[212:215], a[212:215], a[20:23], v[212:215]
v_mfma_f32_16x16x32_bf16 v[212:215], a[216:219], a[24:27], v[212:215]
s_waitcnt vmcnt(6)
s_barrier
v_mfma_f32_16x16x32_bf16 v[212:215], a[220:223], a[28:31], v[212:215]
ds_read_b64_tr_b16 a[224:225], v23 offset:0
v_mfma_f32_16x16x32_bf16 v[216:219], a[192:195], a[32:35], 0
ds_read_b64_tr_b16 a[226:227], v23 offset:2048
v_mfma_f32_16x16x32_bf16 v[216:219], a[196:199], a[36:39], v[216:219]
ds_read_b64_tr_b16 a[228:229], v23 offset:4096
v_mfma_f32_16x16x32_bf16 v[216:219], a[200:203], a[40:43], v[216:219]
ds_read_b64_tr_b16 a[230:231], v23 offset:6144
v_mfma_f32_16x16x32_bf16 v[216:219], a[204:207], a[44:47], v[216:219]
ds_read_b64_tr_b16 a[232:233], v23 offset:8192
v_mfma_f32_16x16x32_bf16 v[216:219], a[208:211], a[48:51], v[216:219]
ds_read_b64_tr_b16 a[234:235], v23 offset:10240
v_cvt_pk_bf16_f32 v240, v212, v213
v_mfma_f32_16x16x32_bf16 v[216:219], a[212:215], a[52:55], v[216:219]
ds_read_b64_tr_b16 a[236:237], v23 offset:12288
v_cvt_pk_bf16_f32 v241, v214, v215
v_mfma_f32_16x16x32_bf16 v[216:219], a[216:219], a[56:59], v[216:219]
ds_read_b64_tr_b16 a[238:239], v23 offset:14336
v_mfma_f32_16x16x32_bf16 v[216:219], a[220:223], a[60:63], v[216:219]
ds_read_b64_tr_b16 a[240:241], v23 offset:16384
v_mfma_f32_16x16x32_bf16 v[220:223], a[192:195], a[64:67], 0
ds_read_b64_tr_b16 a[242:243], v23 offset:18432
v_mfma_f32_16x16x32_bf16 v[220:223], a[196:199], a[68:71], v[220:223]
ds_read_b64_tr_b16 a[244:245], v23 offset:20480
v_mfma_f32_16x16x32_bf16 v[220:223], a[200:203], a[72:75], v[220:223]
ds_read_b64_tr_b16 a[246:247], v23 offset:22528
v_mfma_f32_16x16x32_bf16 v[220:223], a[204:207], a[76:79], v[220:223]
ds_read_b64_tr_b16 a[248:249], v23 offset:24576
v_mfma_f32_16x16x32_bf16 v[220:223], a[208:211], a[80:83], v[220:223]
ds_read_b64_tr_b16 a[250:251], v23 offset:26624
v_cvt_pk_bf16_f32 v242, v216, v217
v_mfma_f32_16x16x32_bf16 v[220:223], a[212:215], a[84:87], v[220:223]
ds_read_b64_tr_b16 a[252:253], v23 offset:28672
v_cvt_pk_bf16_f32 v243, v218, v219
v_mfma_f32_16x16x32_bf16 v[220:223], a[216:219], a[88:91], v[220:223]
ds_read_b64_tr_b16 a[254:255], v23 offset:30720
v_mfma_f32_16x16x32_bf16 v[220:223], a[220:223], a[92:95], v[220:223]
buffer_store_dwordx4 v[240:243], v7, s[28:31], s57 offen offset:2048 sc1
v_mfma_f32_16x16x32_bf16 v[224:227], a[192:195], v[128:131], 0
v_mfma_f32_16x16x32_bf16 v[224:227], a[196:199], v[132:135], v[224:227]
v_mfma_f32_16x16x32_bf16 v[224:227], a[200:203], v[136:139], v[224:227]
v_mfma_f32_16x16x32_bf16 v[224:227], a[204:207], v[140:143], v[224:227]
v_mfma_f32_16x16x32_bf16 v[224:227], a[208:211], v[144:147], v[224:227]
s_nop 1
v_cvt_pk_bf16_f32 v244, v220, v221
v_cvt_pk_bf16_f32 v245, v222, v223
v_mfma_f32_16x16x32_bf16 v[224:227], a[212:215], v[148:151], v[224:227]
v_mfma_f32_16x16x32_bf16 v[224:227], a[216:219], v[152:155], v[224:227]
v_mfma_f32_16x16x32_bf16 v[224:227], a[220:223], v[156:159], v[224:227]
v_mfma_f32_16x16x32_bf16 v[228:231], a[192:195], v[160:163], 0
v_mfma_f32_16x16x32_bf16 v[228:231], a[196:199], v[164:167], v[228:231]
v_mfma_f32_16x16x32_bf16 v[228:231], a[200:203], v[168:171], v[228:231]
v_mfma_f32_16x16x32_bf16 v[228:231], a[204:207], v[172:175], v[228:231]
v_mfma_f32_16x16x32_bf16 v[228:231], a[208:211], v[176:179], v[228:231]
s_nop 2
v_cvt_pk_bf16_f32 v246, v224, v225
v_cvt_pk_bf16_f32 v247, v226, v227
v_mfma_f32_16x16x32_bf16 v[228:231], a[212:215], v[180:183], v[228:231]
buffer_store_dwordx4 v[244:247], v7, s[28:31], s57 offen offset:3072 sc1
s_add_u32 s57, s57, 4096
v_mfma_f32_16x16x32_bf16 v[228:231], a[216:219], v[184:187], v[228:231]
v_mfma_f32_16x16x32_bf16 v[228:231], a[220:223], v[188:191], v[228:231]
s_waitcnt lgkmcnt(0)
v_mfma_f32_16x16x32_bf16 v[192:195], a[224:227], a[0:3], 0
v_mfma_f32_16x16x32_bf16 v[192:195], a[228:231], a[4:7], v[192:195]
v_mfma_f32_16x16x32_bf16 v[192:195], a[232:235], a[8:11], v[192:195]
v_mfma_f32_16x16x32_bf16 v[192:195], a[236:239], a[12:15], v[192:195]
v_mfma_f32_16x16x32_bf16 v[192:195], a[240:243], a[16:19], v[192:195]
s_nop 1
v_cvt_pk_bf16_f32 v250, v228, v229
v_cvt_pk_bf16_f32 v251, v230, v231
v_mfma_f32_16x16x32_bf16 v[192:195], a[244:247], a[20:23], v[192:195]
buffer_store_dwordx4 v[248:251], v7, s[28:31], s58 offen offset:2048 sc1
v_mfma_f32_16x16x32_bf16 v[192:195], a[248:251], a[24:27], v[192:195]
v_mfma_f32_16x16x32_bf16 v[192:195], a[252:255], a[28:31], v[192:195]
v_mfma_f32_16x16x32_bf16 v[196:199], a[224:227], a[32:35], 0
v_mfma_f32_16x16x32_bf16 v[196:199], a[228:231], a[36:39], v[196:199]
v_mfma_f32_16x16x32_bf16 v[196:199], a[232:235], a[40:43], v[196:199]
v_mfma_f32_16x16x32_bf16 v[196:199], a[236:239], a[44:47], v[196:199]
v_mfma_f32_16x16x32_bf16 v[196:199], a[240:243], a[48:51], v[196:199]
s_nop 2
v_cvt_pk_bf16_f32 v232, v192, v193
v_cvt_pk_bf16_f32 v233, v194, v195
v_mfma_f32_16x16x32_bf16 v[196:199], a[244:247], a[52:55], v[196:199]
v_mfma_f32_16x16x32_bf16 v[196:199], a[248:251], a[56:59], v[196:199]
v_mfma_f32_16x16x32_bf16 v[196:199], a[252:255], a[60:63], v[196:199]
v_mfma_f32_16x16x32_bf16 v[200:203], a[224:227], a[64:67], 0
v_mfma_f32_16x16x32_bf16 v[200:203], a[228:231], a[68:71], v[200:203]
v_mfma_f32_16x16x32_bf16 v[200:203], a[232:235], a[72:75], v[200:203]
v_mfma_f32_16x16x32_bf16 v[200:203], a[236:239], a[76:79], v[200:203]
v_mfma_f32_16x16x32_bf16 v[200:203], a[240:243], a[80:83], v[200:203]
s_nop 2
v_cvt_pk_bf16_f32 v234, v196, v197
v_cvt_pk_bf16_f32 v235, v198, v199
v_mfma_f32_16x16x32_bf16 v[200:203], a[244:247], a[84:87], v[200:203]
buffer_store_dwordx4 v[232:235], v7, s[28:31], s57 offen offset:0 sc1
v_mfma_f32_16x16x32_bf16 v[200:203], a[248:251], a[88:91], v[200:203]
v_mfma_f32_16x16x32_bf16 v[200:203], a[252:255], a[92:95], v[200:203]
v_mfma_f32_16x16x32_bf16 v[204:207], a[224:227], v[128:131], 0
v_mfma_f32_16x16x32_bf16 v[204:207], a[228:231], v[132:135], v[204:207]
v_mfma_f32_16x16x32_bf16 v[204:207], a[232:235], v[136:139], v[204:207]
v_mfma_f32_16x16x32_bf16 v[204:207], a[236:239], v[140:143], v[204:207]
v_mfma_f32_16x16x32_bf16 v[204:207], a[240:243], v[144:147], v[204:207]
s_nop 2
v_cvt_pk_bf16_f32 v236, v200, v201
v_cvt_pk_bf16_f32 v237, v202, v203
v_mfma_f32_16x16x32_bf16 v[204:207], a[244:247], v[148:151], v[204:207]
v_mfma_f32_16x16x32_bf16 v[204:207], a[248:251], v[152:155], v[204:207]
v_mfma_f32_16x16x32_bf16 v[204:207], a[252:255], v[156:159], v[204:207]
v_mfma_f32_16x16x32_bf16 v[208:211], a[224:227], v[160:163], 0
v_mfma_f32_16x16x32_bf16 v[208:211], a[228:231], v[164:167], v[208:211]
v_mfma_f32_16x16x32_bf16 v[208:211], a[232:235], v[168:171], v[208:211]
v_mfma_f32_16x16x32_bf16 v[208:211], a[236:239], v[172:175], v[208:211]
v_mfma_f32_16x16x32_bf16 v[208:211], a[240:243], v[176:179], v[208:211]
s_nop 2
v_cvt_pk_bf16_f32 v238, v204, v205
v_cvt_pk_bf16_f32 v239, v206, v207
v_mfma_f32_16x16x32_bf16 v[208:211], a[244:247], v[180:183], v[208:211]
buffer_store_dwordx4 v[236:239], v7, s[28:31], s57 offen offset:1024 sc1
s_add_u32 s57, s57, 4096
v_mfma_f32_16x16x32_bf16 v[208:211], a[248:251], v[184:187], v[208:211]
v_mfma_f32_16x16x32_bf16 v[208:211], a[252:255], v[188:191], v[208:211]
s_nop 7
v_cvt_pk_bf16_f32 v248, v208, v209
v_cvt_pk_bf16_f32 v249, v210, v211
buffer_store_dwordx4 v[248:251], v7, s[28:31], s58 offen offset:3072 sc1
buffer_load_dword v4, v3, s[28:31], s82 offen sc1
s_waitcnt vmcnt(0)
buffer_store_dword v29, v2, s[28:31], s44 offen offset:0 sc1
s_mov_b32 s55, 0
s_mov_b32 s61, 0
L_p2:
v_cmp_ne_u32 vcc, 0, v4
s_add_u32 s55, s55, 1
s_and_b32 s53, vcc_lo, 0xffff
s_cmp_gt_u32 s55, 300000
s_cselect_b32 s53, 0xffff, s53
s_andn2_b32 s51, s53, s52
s_cbranch_scc0 L_p2n
s_bitcmp1_b32 s51, 0
s_cbranch_scc0 L_gb0
s_add_u32 s46, s59, 0
buffer_load_dwordx4 v[32:35], v16, s[28:31], s46 offen offset:0 sc1
L_gb0:
s_bitcmp1_b32 s51, 1
s_cbranch_scc0 L_gb1
s_add_u32 s46, s59, 73728
buffer_load_dwordx4 v[36:39], v16, s[28:31], s46 offen offset:0 sc1
L_gb1:
s_bitcmp1_b32 s51, 2
s_cbranch_scc0 L_gb2
s_add_u32 s46, s59, 147456
buffer_load_dwordx4 v[40:43], v16, s[28:31], s46 offen offset:0 sc1
L_gb2:
s_bitcmp1_b32 s51, 3
s_cbranch_scc0 L_gb3
s_add_u32 s46, s59, 221184
buffer_load_dwordx4 v[44:47], v16, s[28:31], s46 offen offset:0 sc1
L_gb3:
s_bitcmp1_b32 s51, 4
s_cbranch_scc0 L_gb4
s_add_u32 s46, s59, 294912
buffer_load_dwordx4 v[48:51], v16, s[28:31], s46 offen offset:0 sc1
L_gb4:
s_bitcmp1_b32 s51, 5
s_cbranch_scc0 L_gb5
s_add_u32 s46, s59, 368640
buffer_load_dwordx4 v[52:55], v16, s[28:31], s46 offen offset:0 sc1
L_gb5:
s_bitcmp1_b32 s51, 6
s_cbranch_scc0 L_gb6
s_add_u32 s46, s59, 442368
buffer_load_dwordx4 v[56:59], v16, s[28:31], s46 offen offset:0 sc1
L_gb6:
s_bitcmp1_b32 s51, 7
s_cbranch_scc0 L_gb7
s_add_u32 s46, s59, 516096
buffer_load_dwordx4 v[60:63], v16, s[28:31], s46 offen offset:0 sc1
L_gb7:
s_bitcmp1_b32 s51, 8
s_cbranch_scc0 L_gb8
s_add_u32 s46, s59, 589824
buffer_load_dwordx4 v[64:67], v16, s[28:31], s46 offen offset:0 sc1
L_gb8:
s_bitcmp1_b32 s51, 9
s_cbranch_scc0 L_gb9
s_add_u32 s46, s59, 663552
buffer_load_dwordx4 v[68:71], v16, s[28:31], s46 offen offset:0 sc1
L_gb9:
s_bitcmp1_b32 s51, 10
s_cbranch_scc0 L_gb10
s_add_u32 s46, s59, 737280
buffer_load_dwordx4 v[72:75], v16, s[28:31], s46 offen offset:0 sc1
L_gb10:
s_bitcmp1_b32 s51, 11
s_cbranch_scc0 L_gb11
s_add_u32 s46, s59, 811008
buffer_load_dwordx4 v[76:79], v16, s[28:31], s46 offen offset:0 sc1
L_gb11:
s_bitcmp1_b32 s51, 12
s_cbranch_scc0 L_gb12
s_add_u32 s46, s59, 884736
buffer_load_dwordx4 v[80:83], v16, s[28:31], s46 offen offset:0 sc1
L_gb12:
s_bitcmp1_b32 s51, 13
s_cbranch_scc0 L_gb13
s_add_u32 s46, s59, 958464
buffer_load_dwordx4 v[84:87], v16, s[28:31], s46 offen offset:0 sc1
L_gb13:
s_bitcmp1_b32 s51, 14
s_cbranch_scc0 L_gb14
s_add_u32 s46, s59, 1032192
buffer_load_dwordx4 v[88:91], v16, s[28:31], s46 offen offset:0 sc1
L_gb14:
s_bitcmp1_b32 s51, 15
s_cbranch_scc0 L_gb15
s_add_u32 s46, s59, 1105920
buffer_load_dwordx4 v[92:95], v16, s[28:31], s46 offen offset:0 sc1
L_gb15:
s_cmp_eq_u32 s53, 0xffff
s_cbranch_scc1 L_p2d
L_p2n:
buffer_load_dword v4, v3, s[28:31], s82 offen sc1
s_bfe_u32 s46, s52, 0x80000
s_cmp_lg_u32 s46, 0xff
s_cbranch_scc1 L_hsa0
s_bitcmp1_b32 s61, 0
s_cbranch_scc1 L_hsa0
s_bitset1_b32 s61, 0
v_lshlrev_b32 v192, 16, v32
v_and_b32 v193, 0xffff0000, v32
v_lshlrev_b32 v194, 16, v33
v_and_b32 v195, 0xffff0000, v33
v_lshlrev_b32 v196, 16, v34
v_and_b32 v197, 0xffff0000, v34
v_lshlrev_b32 v198, 16, v35
v_and_b32 v199, 0xffff0000, v35
v_lshlrev_b32 v208, 16, v36
v_and_b32 v209, 0xffff0000, v36
v_pk_add_f32 v[192:193], v[192:193], v[208:209]
v_lshlrev_b32 v210, 16, v37
v_and_b32 v211, 0xffff0000, v37
v_pk_add_f32 v[194:195], v[194:195], v[210:211]
v_lshlrev_b32 v208, 16, v38
v_and_b32 v209, 0xffff0000, v38
v_pk_add_f32 v[196:197], v[196:197], v[208:209]
v_lshlrev_b32 v210, 16, v39
v_and_b32 v211, 0xffff0000, v39
v_pk_add_f32 v[198:199], v[198:199], v[210:211]
v_lshlrev_b32 v208, 16, v40
v_and_b32 v209, 0xffff0000, v40
v_pk_add_f32 v[192:193], v[192:193], v[208:209]
v_lshlrev_b32 v210, 16, v41
v_and_b32 v211, 0xffff0000, v41
v_pk_add_f32 v[194:195], v[194:195], v[210:211]
v_lshlrev_b32 v208, 16, v42
v_and_b32 v209, 0xffff0000, v42
v_pk_add_f32 v[196:197], v[196:197], v[208:209]
v_lshlrev_b32 v210, 16, v43
v_and_b32 v211, 0xffff0000, v43
v_pk_add_f32 v[198:199], v[198:199], v[210:211]
v_lshlrev_b32 v208, 16, v44
v_and_b32 v209, 0xffff0000, v44
v_pk_add_f32 v[192:193], v[192:193], v[208:209]
v_lshlrev_b32 v210, 16, v45
v_and_b32 v211, 0xffff0000, v45
v_pk_add_f32 v[194:195], v[194:195], v[210:211]
v_lshlrev_b32 v208, 16, v46
v_and_b32 v209, 0xffff0000, v46
v_pk_add_f32 v[196:197], v[196:197], v[208:209]
v_lshlrev_b32 v210, 16, v47
v_and_b32 v211, 0xffff0000, v47
v_pk_add_f32 v[198:199], v[198:199], v[210:211]
v_lshlrev_b32 v208, 16, v48
v_and_b32 v209, 0xffff0000, v48
v_pk_add_f32 v[192:193], v[192:193], v[208:209]
v_lshlrev_b32 v210, 16, v49
v_and_b32 v211, 0xffff0000, v49
v_pk_add_f32 v[194:195], v[194:195], v[210:211]
v_lshlrev_b32 v208, 16, v50
v_and_b32 v209, 0xffff0000, v50
v_pk_add_f32 v[196:197], v[196:197], v[208:209]
v_lshlrev_b32 v210, 16, v51
v_and_b32 v211, 0xffff0000, v51
v_pk_add_f32 v[198:199], v[198:199], v[210:211]
v_lshlrev_b32 v208, 16, v52
v_and_b32 v209, 0xffff0000, v52
v_pk_add_f32 v[192:193], v[192:193], v[208:209]
v_lshlrev_b32 v210, 16, v53
v_and_b32 v211, 0xffff0000, v53
v_pk_add_f32 v[194:195], v[194:195], v[210:211]
v_lshlrev_b32 v208, 16, v54
v_and_b32 v209, 0xffff0000, v54
v_pk_add_f32 v[196:197], v[196:197], v[208:209]
v_lshlrev_b32 v210, 16, v55
v_and_b32 v211, 0xffff0000, v55
v_pk_add_f32 v[198:199], v[198:199], v[210:211]
v_lshlrev_b32 v208, 16, v56
v_and_b32 v209, 0xffff0000, v56
v_pk_add_f32 v[192:193], v[192:193], v[208:209]
v_lshlrev_b32 v210, 16, v57
v_and_b32 v211, 0xffff0000, v57
v_pk_add_f32 v[194:195], v[194:195], v[210:211]
v_lshlrev_b32 v208, 16, v58
v_and_b32 v209, 0xffff0000, v58
v_pk_add_f32 v[196:197], v[196:197], v[208:209]
v_lshlrev_b32 v210, 16, v59
v_and_b32 v211, 0xffff0000, v59
v_pk_add_f32 v[198:199], v[198:199], v[210:211]
v_lshlrev_b32 v208, 16, v60
v_and_b32 v209, 0xffff0000, v60
v_pk_add_f32 v[192:193], v[192:193], v[208:209]
v_lshlrev_b32 v210, 16, v61
v_and_b32 v211, 0xffff0000, v61
v_pk_add_f32 v[194:195], v[194:195], v[210:211]
v_lshlrev_b32 v208, 16, v62
v_and_b32 v209, 0xffff0000, v62
v_pk_add_f32 v[196:197], v[196:197], v[208:209]
v_lshlrev_b32 v210, 16, v63
v_and_b32 v211, 0xffff0000, v63
v_pk_add_f32 v[198:199], v[198:199], v[210:211]
L_hsa0:
s_bfe_u32 s46, s52, 0x80008
s_cmp_lg_u32 s46, 0xff
s_cbranch_scc1 L_hsa1
s_bitcmp1_b32 s61, 1
s_cbranch_scc1 L_hsa1
s_bitset1_b32 s61, 1
v_lshlrev_b32 v228, 16, v64
v_and_b32 v229, 0xffff0000, v64
v_lshlrev_b32 v230, 16, v65
v_and_b32 v231, 0xffff0000, v65
v_lshlrev_b32 v232, 16, v66
v_and_b32 v233, 0xffff0000, v66
v_lshlrev_b32 v234, 16, v67
v_and_b32 v235, 0xffff0000, v67
v_lshlrev_b32 v208, 16, v68
v_and_b32 v209, 0xffff0000, v68
v_pk_add_f32 v[228:229], v[228:229], v[208:209]
v_lshlrev_b32 v210, 16, v69
v_and_b32 v211, 0xffff0000, v69
v_pk_add_f32 v[230:231], v[230:231], v[210:211]
v_lshlrev_b32 v208, 16, v70
v_and_b32 v209, 0xffff0000, v70
v_pk_add_f32 v[232:233], v[232:233], v[208:209]
v_lshlrev_b32 v210, 16, v71
v_and_b32 v211, 0xffff0000, v71
v_pk_add_f32 v[234:235], v[234:235], v[210:211]
v_lshlrev_b32 v208, 16, v72
v_and_b32 v209, 0xffff0000, v72
v_pk_add_f32 v[228:229], v[228:229], v[208:209]
v_lshlrev_b32 v210, 16, v73
v_and_b32 v211, 0xffff0000, v73
v_pk_add_f32 v[230:231], v[230:231], v[210:211]
v_lshlrev_b32 v208, 16, v74
v_and_b32 v209, 0xffff0000, v74
v_pk_add_f32 v[232:233], v[232:233], v[208:209]
v_lshlrev_b32 v210, 16, v75
v_and_b32 v211, 0xffff0000, v75
v_pk_add_f32 v[234:235], v[234:235], v[210:211]
v_lshlrev_b32 v208, 16, v76
v_and_b32 v209, 0xffff0000, v76
v_pk_add_f32 v[228:229], v[228:229], v[208:209]
v_lshlrev_b32 v210, 16, v77
v_and_b32 v211, 0xffff0000, v77
v_pk_add_f32 v[230:231], v[230:231], v[210:211]
v_lshlrev_b32 v208, 16, v78
v_and_b32 v209, 0xffff0000, v78
v_pk_add_f32 v[232:233], v[232:233], v[208:209]
v_lshlrev_b32 v210, 16, v79
v_and_b32 v211, 0xffff0000, v79
v_pk_add_f32 v[234:235], v[234:235], v[210:211]
v_lshlrev_b32 v208, 16, v80
v_and_b32 v209, 0xffff0000, v80
v_pk_add_f32 v[228:229], v[228:229], v[208:209]
v_lshlrev_b32 v210, 16, v81
v_and_b32 v211, 0xffff0000, v81
v_pk_add_f32 v[230:231], v[230:231], v[210:211]
v_lshlrev_b32 v208, 16, v82
v_and_b32 v209, 0xffff0000, v82
v_pk_add_f32 v[232:233], v[232:233], v[208:209]
v_lshlrev_b32 v210, 16, v83
v_and_b32 v211, 0xffff0000, v83
v_pk_add_f32 v[234:235], v[234:235], v[210:211]
v_lshlrev_b32 v208, 16, v84
v_and_b32 v209, 0xffff0000, v84
v_pk_add_f32 v[228:229], v[228:229], v[208:209]
v_lshlrev_b32 v210, 16, v85
v_and_b32 v211, 0xffff0000, v85
v_pk_add_f32 v[230:231], v[230:231], v[210:211]
v_lshlrev_b32 v208, 16, v86
v_and_b32 v209, 0xffff0000, v86
v_pk_add_f32 v[232:233], v[232:233], v[208:209]
v_lshlrev_b32 v210, 16, v87
v_and_b32 v211, 0xffff0000, v87
v_pk_add_f32 v[234:235], v[234:235], v[210:211]
v_lshlrev_b32 v208, 16, v88
v_and_b32 v209, 0xffff0000, v88
v_pk_add_f32 v[228:229], v[228:229], v[208:209]
v_lshlrev_b32 v210, 16, v89
v_and_b32 v211, 0xffff0000, v89
v_pk_add_f32 v[230:231], v[230:231], v[210:211]
v_lshlrev_b32 v208, 16, v90
v_and_b32 v209, 0xffff0000, v90
v_pk_add_f32 v[232:233], v[232:233], v[208:209]
v_lshlrev_b32 v210, 16, v91
v_and_b32 v211, 0xffff0000, v91
v_pk_add_f32 v[234:235], v[234:235], v[210:211]
v_lshlrev_b32 v208, 16, v92
v_and_b32 v209, 0xffff0000, v92
v_pk_add_f32 v[228:229], v[228:229], v[208:209]
v_lshlrev_b32 v210, 16, v93
v_and_b32 v211, 0xffff0000, v93
v_pk_add_f32 v[230:231], v[230:231], v[210:211]
v_lshlrev_b32 v208, 16, v94
v_and_b32 v209, 0xffff0000, v94
v_pk_add_f32 v[232:233], v[232:233], v[208:209]
v_lshlrev_b32 v210, 16, v95
v_and_b32 v211, 0xffff0000, v95
v_pk_add_f32 v[234:235], v[234:235], v[210:211]
L_hsa1:
s_mov_b32 s52, s53
s_waitcnt vmcnt(0)
s_branch L_p2
L_p2d:
buffer_load_dwordx4 v[96:99], v17, s[28:31], s59 offen offset:0 sc1
buffer_load_dwordx4 v[100:103], v17, s[28:31], s60 offen offset:0 sc1
s_bfe_u32 s46, s52, 0x80000
s_cmp_lg_u32 s46, 0xff
s_cbranch_scc1 L_hsb0
s_bitcmp1_b32 s61, 0
s_cbranch_scc1 L_hsb0
s_bitset1_b32 s61, 0
v_lshlrev_b32 v192, 16, v32
v_and_b32 v193, 0xffff0000, v32
v_lshlrev_b32 v194, 16, v33
v_and_b32 v195, 0xffff0000, v33
v_lshlrev_b32 v196, 16, v34
v_and_b32 v197, 0xffff0000, v34
v_lshlrev_b32 v198, 16, v35
v_and_b32 v199, 0xffff0000, v35
v_lshlrev_b32 v208, 16, v36
v_and_b32 v209, 0xffff0000, v36
v_pk_add_f32 v[192:193], v[192:193], v[208:209]
v_lshlrev_b32 v210, 16, v37
v_and_b32 v211, 0xffff0000, v37
v_pk_add_f32 v[194:195], v[194:195], v[210:211]
v_lshlrev_b32 v208, 16, v38
v_and_b32 v209, 0xffff0000, v38
v_pk_add_f32 v[196:197], v[196:197], v[208:209]
v_lshlrev_b32 v210, 16, v39
v_and_b32 v211, 0xffff0000, v39
v_pk_add_f32 v[198:199], v[198:199], v[210:211]
v_lshlrev_b32 v208, 16, v40
v_and_b32 v209, 0xffff0000, v40
v_pk_add_f32 v[192:193], v[192:193], v[208:209]
v_lshlrev_b32 v210, 16, v41
v_and_b32 v211, 0xffff0000, v41
v_pk_add_f32 v[194:195], v[194:195], v[210:211]
v_lshlrev_b32 v208, 16, v42
v_and_b32 v209, 0xffff0000, v42
v_pk_add_f32 v[196:197], v[196:197], v[208:209]
v_lshlrev_b32 v210, 16, v43
v_and_b32 v211, 0xffff0000, v43
v_pk_add_f32 v[198:199], v[198:199], v[210:211]
v_lshlrev_b32 v208, 16, v44
v_and_b32 v209, 0xffff0000, v44
v_pk_add_f32 v[192:193], v[192:193], v[208:209]
v_lshlrev_b32 v210, 16, v45
v_and_b32 v211, 0xffff0000, v45
v_pk_add_f32 v[194:195], v[194:195], v[210:211]
v_lshlrev_b32 v208, 16, v46
v_and_b32 v209, 0xffff0000, v46
v_pk_add_f32 v[196:197], v[196:197], v[208:209]
v_lshlrev_b32 v210, 16, v47
v_and_b32 v211, 0xffff0000, v47
v_pk_add_f32 v[198:199], v[198:199], v[210:211]
v_lshlrev_b32 v208, 16, v48
v_and_b32 v209, 0xffff0000, v48
v_pk_add_f32 v[192:193], v[192:193], v[208:209]
v_lshlrev_b32 v210, 16, v49
v_and_b32 v211, 0xffff0000, v49
v_pk_add_f32 v[194:195], v[194:195], v[210:211]
v_lshlrev_b32 v208, 16, v50
v_and_b32 v209, 0xffff0000, v50
v_pk_add_f32 v[196:197], v[196:197], v[208:209]
v_lshlrev_b32 v210, 16, v51
v_and_b32 v211, 0xffff0000, v51
v_pk_add_f32 v[198:199], v[198:199], v[210:211]
v_lshlrev_b32 v208, 16, v52
v_and_b32 v209, 0xffff0000, v52
v_pk_add_f32 v[192:193], v[192:193], v[208:209]
v_lshlrev_b32 v210, 16, v53
v_and_b32 v211, 0xffff0000, v53
v_pk_add_f32 v[194:195], v[194:195], v[210:211]
v_lshlrev_b32 v208, 16, v54
v_and_b32 v209, 0xffff0000, v54
v_pk_add_f32 v[196:197], v[196:197], v[208:209]
v_lshlrev_b32 v210, 16, v55
v_and_b32 v211, 0xffff0000, v55
v_pk_add_f32 v[198:199], v[198:199], v[210:211]
v_lshlrev_b32 v208, 16, v56
v_and_b32 v209, 0xffff0000, v56
v_pk_add_f32 v[192:193], v[192:193], v[208:209]
v_lshlrev_b32 v210, 16, v57
v_and_b32 v211, 0xffff0000, v57
v_pk_add_f32 v[194:195], v[194:195], v[210:211]
v_lshlrev_b32 v208, 16, v58
v_and_b32 v209, 0xffff0000, v58
v_pk_add_f32 v[196:197], v[196:197], v[208:209]
v_lshlrev_b32 v210, 16, v59
v_and_b32 v211, 0xffff0000, v59
v_pk_add_f32 v[198:199], v[198:199], v[210:211]
v_lshlrev_b32 v208, 16, v60
v_and_b32 v209, 0xffff0000, v60
v_pk_add_f32 v[192:193], v[192:193], v[208:209]
v_lshlrev_b32 v210, 16, v61
v_and_b32 v211, 0xffff0000, v61
v_pk_add_f32 v[194:195], v[194:195], v[210:211]
v_lshlrev_b32 v208, 16, v62
v_and_b32 v209, 0xffff0000, v62
v_pk_add_f32 v[196:197], v[196:197], v[208:209]
v_lshlrev_b32 v210, 16, v63
v_and_b32 v211, 0xffff0000, v63
v_pk_add_f32 v[198:199], v[198:199], v[210:211]
L_hsb0:
s_bfe_u32 s46, s52, 0x80008
s_cmp_lg_u32 s46, 0xff
s_cbranch_scc1 L_hsb1
s_bitcmp1_b32 s61, 1
s_cbranch_scc1 L_hsb1
s_bitset1_b32 s61, 1
v_lshlrev_b32 v228, 16, v64
v_and_b32 v229, 0xffff0000, v64
v_lshlrev_b32 v230, 16, v65
v_and_b32 v231, 0xffff0000, v65
v_lshlrev_b32 v232, 16, v66
v_and_b32 v233, 0xffff0000, v66
v_lshlrev_b32 v234, 16, v67
v_and_b32 v235, 0xffff0000, v67
v_lshlrev_b32 v208, 16, v68
v_and_b32 v209, 0xffff0000, v68
v_pk_add_f32 v[228:229], v[228:229], v[208:209]
v_lshlrev_b32 v210, 16, v69
v_and_b32 v211, 0xffff0000, v69
v_pk_add_f32 v[230:231], v[230:231], v[210:211]
v_lshlrev_b32 v208, 16, v70
v_and_b32 v209, 0xffff0000, v70
v_pk_add_f32 v[232:233], v[232:233], v[208:209]
v_lshlrev_b32 v210, 16, v71
v_and_b32 v211, 0xffff0000, v71
v_pk_add_f32 v[234:235], v[234:235], v[210:211]
v_lshlrev_b32 v208, 16, v72
v_and_b32 v209, 0xffff0000, v72
v_pk_add_f32 v[228:229], v[228:229], v[208:209]
v_lshlrev_b32 v210, 16, v73
v_and_b32 v211, 0xffff0000, v73
v_pk_add_f32 v[230:231], v[230:231], v[210:211]
v_lshlrev_b32 v208, 16, v74
v_and_b32 v209, 0xffff0000, v74
v_pk_add_f32 v[232:233], v[232:233], v[208:209]
v_lshlrev_b32 v210, 16, v75
v_and_b32 v211, 0xffff0000, v75
v_pk_add_f32 v[234:235], v[234:235], v[210:211]
v_lshlrev_b32 v208, 16, v76
v_and_b32 v209, 0xffff0000, v76
v_pk_add_f32 v[228:229], v[228:229], v[208:209]
v_lshlrev_b32 v210, 16, v77
v_and_b32 v211, 0xffff0000, v77
v_pk_add_f32 v[230:231], v[230:231], v[210:211]
v_lshlrev_b32 v208, 16, v78
v_and_b32 v209, 0xffff0000, v78
v_pk_add_f32 v[232:233], v[232:233], v[208:209]
v_lshlrev_b32 v210, 16, v79
v_and_b32 v211, 0xffff0000, v79
v_pk_add_f32 v[234:235], v[234:235], v[210:211]
v_lshlrev_b32 v208, 16, v80
v_and_b32 v209, 0xffff0000, v80
v_pk_add_f32 v[228:229], v[228:229], v[208:209]
v_lshlrev_b32 v210, 16, v81
v_and_b32 v211, 0xffff0000, v81
v_pk_add_f32 v[230:231], v[230:231], v[210:211]
v_lshlrev_b32 v208, 16, v82
v_and_b32 v209, 0xffff0000, v82
v_pk_add_f32 v[232:233], v[232:233], v[208:209]
v_lshlrev_b32 v210, 16, v83
v_and_b32 v211, 0xffff0000, v83
v_pk_add_f32 v[234:235], v[234:235], v[210:211]
v_lshlrev_b32 v208, 16, v84
v_and_b32 v209, 0xffff0000, v84
v_pk_add_f32 v[228:229], v[228:229], v[208:209]
v_lshlrev_b32 v210, 16, v85
v_and_b32 v211, 0xffff0000, v85
v_pk_add_f32 v[230:231], v[230:231], v[210:211]
v_lshlrev_b32 v208, 16, v86
v_and_b32 v209, 0xffff0000, v86
v_pk_add_f32 v[232:233], v[232:233], v[208:209]
v_lshlrev_b32 v210, 16, v87
v_and_b32 v211, 0xffff0000, v87
v_pk_add_f32 v[234:235], v[234:235], v[210:211]
v_lshlrev_b32 v208, 16, v88
v_and_b32 v209, 0xffff0000, v88
v_pk_add_f32 v[228:229], v[228:229], v[208:209]
v_lshlrev_b32 v210, 16, v89
v_and_b32 v211, 0xffff0000, v89
v_pk_add_f32 v[230:231], v[230:231], v[210:211]
v_lshlrev_b32 v208, 16, v90
v_and_b32 v209, 0xffff0000, v90
v_pk_add_f32 v[232:233], v[232:233], v[208:209]
v_lshlrev_b32 v210, 16, v91
v_and_b32 v211, 0xffff0000, v91
v_pk_add_f32 v[234:235], v[234:235], v[210:211]
v_lshlrev_b32 v208, 16, v92
v_and_b32 v209, 0xffff0000, v92
v_pk_add_f32 v[228:229], v[228:229], v[208:209]
v_lshlrev_b32 v210, 16, v93
v_and_b32 v211, 0xffff0000, v93
v_pk_add_f32 v[230:231], v[230:231], v[210:211]
v_lshlrev_b32 v208, 16, v94
v_and_b32 v209, 0xffff0000, v94
v_pk_add_f32 v[232:233], v[232:233], v[208:209]
v_lshlrev_b32 v210, 16, v95
v_and_b32 v211, 0xffff0000, v95
v_pk_add_f32 v[234:235], v[234:235], v[210:211]
L_hsb1:
s_mov_b32 s52, 0xffff
s_waitcnt vmcnt(2)
s_bfe_u32 s46, s52, 0x80000
s_cmp_lg_u32 s46, 0xff
s_cbranch_scc1 L_hsc0
s_bitcmp1_b32 s61, 0
s_cbranch_scc1 L_hsc0
s_bitset1_b32 s61, 0
v_lshlrev_b32 v192, 16, v32
v_and_b32 v193, 0xffff0000, v32
v_lshlrev_b32 v194, 16, v33
v_and_b32 v195, 0xffff0000, v33
v_lshlrev_b32 v196, 16, v34
v_and_b32 v197, 0xffff0000, v34
v_lshlrev_b32 v198, 16, v35
v_and_b32 v199, 0xffff0000, v35
v_lshlrev_b32 v208, 16, v36
v_and_b32 v209, 0xffff0000, v36
v_pk_add_f32 v[192:193], v[192:193], v[208:209]
v_lshlrev_b32 v210, 16, v37
v_and_b32 v211, 0xffff0000, v37
v_pk_add_f32 v[194:195], v[194:195], v[210:211]
v_lshlrev_b32 v208, 16, v38
v_and_b32 v209, 0xffff0000, v38
v_pk_add_f32 v[196:197], v[196:197], v[208:209]
v_lshlrev_b32 v210, 16, v39
v_and_b32 v211, 0xffff0000, v39
v_pk_add_f32 v[198:199], v[198:199], v[210:211]
v_lshlrev_b32 v208, 16, v40
v_and_b32 v209, 0xffff0000, v40
v_pk_add_f32 v[192:193], v[192:193], v[208:209]
v_lshlrev_b32 v210, 16, v41
v_and_b32 v211, 0xffff0000, v41
v_pk_add_f32 v[194:195], v[194:195], v[210:211]
v_lshlrev_b32 v208, 16, v42
v_and_b32 v209, 0xffff0000, v42
v_pk_add_f32 v[196:197], v[196:197], v[208:209]
v_lshlrev_b32 v210, 16, v43
v_and_b32 v211, 0xffff0000, v43
v_pk_add_f32 v[198:199], v[198:199], v[210:211]
v_lshlrev_b32 v208, 16, v44
v_and_b32 v209, 0xffff0000, v44
v_pk_add_f32 v[192:193], v[192:193], v[208:209]
v_lshlrev_b32 v210, 16, v45
v_and_b32 v211, 0xffff0000, v45
v_pk_add_f32 v[194:195], v[194:195], v[210:211]
v_lshlrev_b32 v208, 16, v46
v_and_b32 v209, 0xffff0000, v46
v_pk_add_f32 v[196:197], v[196:197], v[208:209]
v_lshlrev_b32 v210, 16, v47
v_and_b32 v211, 0xffff0000, v47
v_pk_add_f32 v[198:199], v[198:199], v[210:211]
v_lshlrev_b32 v208, 16, v48
v_and_b32 v209, 0xffff0000, v48
v_pk_add_f32 v[192:193], v[192:193], v[208:209]
v_lshlrev_b32 v210, 16, v49
v_and_b32 v211, 0xffff0000, v49
v_pk_add_f32 v[194:195], v[194:195], v[210:211]
v_lshlrev_b32 v208, 16, v50
v_and_b32 v209, 0xffff0000, v50
v_pk_add_f32 v[196:197], v[196:197], v[208:209]
v_lshlrev_b32 v210, 16, v51
v_and_b32 v211, 0xffff0000, v51
v_pk_add_f32 v[198:199], v[198:199], v[210:211]
v_lshlrev_b32 v208, 16, v52
v_and_b32 v209, 0xffff0000, v52
v_pk_add_f32 v[192:193], v[192:193], v[208:209]
v_lshlrev_b32 v210, 16, v53
v_and_b32 v211, 0xffff0000, v53
v_pk_add_f32 v[194:195], v[194:195], v[210:211]
v_lshlrev_b32 v208, 16, v54
v_and_b32 v209, 0xffff0000, v54
v_pk_add_f32 v[196:197], v[196:197], v[208:209]
v_lshlrev_b32 v210, 16, v55
v_and_b32 v211, 0xffff0000, v55
v_pk_add_f32 v[198:199], v[198:199], v[210:211]
v_lshlrev_b32 v208, 16, v56
v_and_b32 v209, 0xffff0000, v56
v_pk_add_f32 v[192:193], v[192:193], v[208:209]
v_lshlrev_b32 v210, 16, v57
v_and_b32 v211, 0xffff0000, v57
v_pk_add_f32 v[194:195], v[194:195], v[210:211]
v_lshlrev_b32 v208, 16, v58
v_and_b32 v209, 0xffff0000, v58
v_pk_add_f32 v[196:197], v[196:197], v[208:209]
v_lshlrev_b32 v210, 16, v59
v_and_b32 v211, 0xffff0000, v59
v_pk_add_f32 v[198:199], v[198:199], v[210:211]
v_lshlrev_b32 v208, 16, v60
v_and_b32 v209, 0xffff0000, v60
v_pk_add_f32 v[192:193], v[192:193], v[208:209]
v_lshlrev_b32 v210, 16, v61
v_and_b32 v211, 0xffff0000, v61
v_pk_add_f32 v[194:195], v[194:195], v[210:211]
v_lshlrev_b32 v208, 16, v62
v_and_b32 v209, 0xffff0000, v62
v_pk_add_f32 v[196:197], v[196:197], v[208:209]
v_lshlrev_b32 v210, 16, v63
v_and_b32 v211, 0xffff0000, v63
v_pk_add_f32 v[198:199], v[198:199], v[210:211]
L_hsc0:
s_bfe_u32 s46, s52, 0x80008
s_cmp_lg_u32 s46, 0xff
s_cbranch_scc1 L_hsc1
s_bitcmp1_b32 s61, 1
s_cbranch_scc1 L_hsc1
s_bitset1_b32 s61, 1
v_lshlrev_b32 v228, 16, v64
v_and_b32 v229, 0xffff0000, v64
v_lshlrev_b32 v230, 16, v65
v_and_b32 v231, 0xffff0000, v65
v_lshlrev_b32 v232, 16, v66
v_and_b32 v233, 0xffff0000, v66
v_lshlrev_b32 v234, 16, v67
v_and_b32 v235, 0xffff0000, v67
v_lshlrev_b32 v208, 16, v68
v_and_b32 v209, 0xffff0000, v68
v_pk_add_f32 v[228:229], v[228:229], v[208:209]
v_lshlrev_b32 v210, 16, v69
v_and_b32 v211, 0xffff0000, v69
v_pk_add_f32 v[230:231], v[230:231], v[210:211]
v_lshlrev_b32 v208, 16, v70
v_and_b32 v209, 0xffff0000, v70
v_pk_add_f32 v[232:233], v[232:233], v[208:209]
v_lshlrev_b32 v210, 16, v71
v_and_b32 v211, 0xffff0000, v71
v_pk_add_f32 v[234:235], v[234:235], v[210:211]
v_lshlrev_b32 v208, 16, v72
v_and_b32 v209, 0xffff0000, v72
v_pk_add_f32 v[228:229], v[228:229], v[208:209]
v_lshlrev_b32 v210, 16, v73
v_and_b32 v211, 0xffff0000, v73
v_pk_add_f32 v[230:231], v[230:231], v[210:211]
v_lshlrev_b32 v208, 16, v74
v_and_b32 v209, 0xffff0000, v74
v_pk_add_f32 v[232:233], v[232:233], v[208:209]
v_lshlrev_b32 v210, 16, v75
v_and_b32 v211, 0xffff0000, v75
v_pk_add_f32 v[234:235], v[234:235], v[210:211]
v_lshlrev_b32 v208, 16, v76
v_and_b32 v209, 0xffff0000, v76
v_pk_add_f32 v[228:229], v[228:229], v[208:209]
v_lshlrev_b32 v210, 16, v77
v_and_b32 v211, 0xffff0000, v77
v_pk_add_f32 v[230:231], v[230:231], v[210:211]
v_lshlrev_b32 v208, 16, v78
v_and_b32 v209, 0xffff0000, v78
v_pk_add_f32 v[232:233], v[232:233], v[208:209]
v_lshlrev_b32 v210, 16, v79
v_and_b32 v211, 0xffff0000, v79
v_pk_add_f32 v[234:235], v[234:235], v[210:211]
v_lshlrev_b32 v208, 16, v80
v_and_b32 v209, 0xffff0000, v80
v_pk_add_f32 v[228:229], v[228:229], v[208:209]
v_lshlrev_b32 v210, 16, v81
v_and_b32 v211, 0xffff0000, v81
v_pk_add_f32 v[230:231], v[230:231], v[210:211]
v_lshlrev_b32 v208, 16, v82
v_and_b32 v209, 0xffff0000, v82
v_pk_add_f32 v[232:233], v[232:233], v[208:209]
v_lshlrev_b32 v210, 16, v83
v_and_b32 v211, 0xffff0000, v83
v_pk_add_f32 v[234:235], v[234:235], v[210:211]
v_lshlrev_b32 v208, 16, v84
v_and_b32 v209, 0xffff0000, v84
v_pk_add_f32 v[228:229], v[228:229], v[208:209]
v_lshlrev_b32 v210, 16, v85
v_and_b32 v211, 0xffff0000, v85
v_pk_add_f32 v[230:231], v[230:231], v[210:211]
v_lshlrev_b32 v208, 16, v86
v_and_b32 v209, 0xffff0000, v86
v_pk_add_f32 v[232:233], v[232:233], v[208:209]
v_lshlrev_b32 v210, 16, v87
v_and_b32 v211, 0xffff0000, v87
v_pk_add_f32 v[234:235], v[234:235], v[210:211]
v_lshlrev_b32 v208, 16, v88
v_and_b32 v209, 0xffff0000, v88
v_pk_add_f32 v[228:229], v[228:229], v[208:209]
v_lshlrev_b32 v210, 16, v89
v_and_b32 v211, 0xffff0000, v89
v_pk_add_f32 v[230:231], v[230:231], v[210:211]
v_lshlrev_b32 v208, 16, v90
v_and_b32 v209, 0xffff0000, v90
v_pk_add_f32 v[232:233], v[232:233], v[208:209]
v_lshlrev_b32 v210, 16, v91
v_and_b32 v211, 0xffff0000, v91
v_pk_add_f32 v[234:235], v[234:235], v[210:211]
v_lshlrev_b32 v208, 16, v92
v_and_b32 v209, 0xffff0000, v92
v_pk_add_f32 v[228:229], v[228:229], v[208:209]
v_lshlrev_b32 v210, 16, v93
v_and_b32 v211, 0xffff0000, v93
v_pk_add_f32 v[230:231], v[230:231], v[210:211]
v_lshlrev_b32 v208, 16, v94
v_and_b32 v209, 0xffff0000, v94
v_pk_add_f32 v[232:233], v[232:233], v[208:209]
v_lshlrev_b32 v210, 16, v95
v_and_b32 v211, 0xffff0000, v95
v_pk_add_f32 v[234:235], v[234:235], v[210:211]
L_hsc1:
v_pk_add_f32 v[192:193], v[192:193], v[228:229]
v_pk_add_f32 v[194:195], v[194:195], v[230:231]
v_pk_add_f32 v[196:197], v[196:197], v[232:233]
v_pk_add_f32 v[198:199], v[198:199], v[234:235]
s_waitcnt vmcnt(0)
v_lshlrev_b32 v200, 16, v96
v_and_b32 v201, 0xffff0000, v96
v_lshlrev_b32 v202, 16, v97
v_and_b32 v203, 0xffff0000, v97
v_lshlrev_b32 v204, 16, v98
v_and_b32 v205, 0xffff0000, v98
v_lshlrev_b32 v206, 16, v99
v_and_b32 v207, 0xffff0000, v99
v_lshlrev_b32 v208, 16, v100
v_and_b32 v209, 0xffff0000, v100
v_pk_add_f32 v[200:201], v[200:201], v[208:209]
v_lshlrev_b32 v210, 16, v101
v_and_b32 v211, 0xffff0000, v101
v_pk_add_f32 v[202:203], v[202:203], v[210:211]
v_lshlrev_b32 v208, 16, v102
v_and_b32 v209, 0xffff0000, v102
v_pk_add_f32 v[204:205], v[204:205], v[208:209]
v_lshlrev_b32 v210, 16, v103
v_and_b32 v211, 0xffff0000, v103
v_pk_add_f32 v[206:207], v[206:207], v[210:211]
v_mov_b32 v212, v200
v_mov_b32 v213, v201
v_mov_b32 v214, v202
v_mov_b32 v215, v203
v_mov_b32 v216, v204
v_mov_b32 v217, v205
v_mov_b32 v218, v206
v_mov_b32 v219, v207
v_permlane32_swap_b32 v200, v212
v_permlane32_swap_b32 v201, v213
v_permlane32_swap_b32 v202, v214
v_permlane32_swap_b32 v203, v215
v_permlane32_swap_b32 v204, v216
v_permlane32_swap_b32 v205, v217
v_permlane32_swap_b32 v206, v218
v_permlane32_swap_b32 v207, v219
v_pk_add_f32 v[200:201], v[200:201], v[212:213]
v_pk_add_f32 v[202:203], v[202:203], v[214:215]
v_pk_add_f32 v[204:205], v[204:205], v[216:217]
v_pk_add_f32 v[206:207], v[206:207], v[218:219]
v_mov_b32 v212, v200
v_mov_b32 v213, v201
v_mov_b32 v214, v202
v_mov_b32 v215, v203
v_mov_b32 v216, v204
v_mov_b32 v217, v205
v_mov_b32 v218, v206
v_mov_b32 v219, v207
v_permlane16_swap_b32 v200, v212
v_permlane16_swap_b32 v201, v213
v_permlane16_swap_b32 v202, v214
v_permlane16_swap_b32 v203, v215
v_permlane16_swap_b32 v204, v216
v_permlane16_swap_b32 v205, v217
v_permlane16_swap_b32 v206, v218
v_permlane16_swap_b32 v207, v219
v_pk_add_f32 v[200:201], v[200:201], v[212:213]
v_pk_add_f32 v[202:203], v[202:203], v[214:215]
v_pk_add_f32 v[204:205], v[204:205], v[216:217]
v_pk_add_f32 v[206:207], v[206:207], v[218:219]
s_nop 1
v_add_f32_dpp v200, v200, v200 row_ror:8 row_mask:0xf bank_mask:0xf
v_add_f32_dpp v201, v201, v201 row_ror:8 row_mask:0xf bank_mask:0xf
v_add_f32_dpp v202, v202, v202 row_ror:8 row_mask:0xf bank_mask:0xf
v_add_f32_dpp v203, v203, v203 row_ror:8 row_mask:0xf bank_mask:0xf
v_add_f32_dpp v204, v204, v204 row_ror:8 row_mask:0xf bank_mask:0xf
v_add_f32_dpp v205, v205, v205 row_ror:8 row_mask:0xf bank_mask:0xf
v_add_f32_dpp v206, v206, v206 row_ror:8 row_mask:0xf bank_mask:0xf
v_add_f32_dpp v207, v207, v207 row_ror:8 row_mask:0xf bank_mask:0xf
v_cvt_pk_bf16_f32 v220, v192, v193
v_cvt_pk_bf16_f32 v221, v194, v195
v_cvt_pk_bf16_f32 v222, v196, v197
v_cvt_pk_bf16_f32 v223, v198, v199
buffer_store_dwordx2 v[220:221], v18, s[20:23], 0 offen offset:0
buffer_store_dwordx2 v[222:223], v20, s[20:23], 0 offen offset:0
v_cvt_pk_bf16_f32 v224, v200, v201
v_cvt_pk_bf16_f32 v225, v202, v203
v_cvt_pk_bf16_f32 v226, v204, v205
v_cvt_pk_bf16_f32 v227, v206, v207
buffer_store_dwordx2 v[224:225], v19, s[20:23], 0 offen offset:0
buffer_store_dwordx2 v[226:227], v6, s[20:23], 0 offen offset:0
L_end:
s_endpgm
L_slow_0:
s_nop 15
v_max3_f32 v236, v128, v129, v130
v_max3_f32 v236, v236, v131, v140
v_max3_f32 v236, v236, v141, v142
v_max_f32 v236, v236, v143
v_mov_b32 v237, v236
s_nop 1
v_permlane32_swap_b32 v236, v237
v_max_f32 v236, v236, v237
v_mov_b32 v237, v236
s_nop 1
v_permlane16_swap_b32 v236, v237
v_max_f32 v236, v236, v237
v_ceil_f32 v236, v236
v_max_f32 v236, 0, v236
v_exp_f32 v253, -v236
v_sub_f32 v224, v224, v236
v_sub_f32 v225, v225, v236
v_sub_f32 v226, v226, v236
v_sub_f32 v227, v227, v236
v_sub_f32 v128, v128, v236
v_sub_f32 v129, v129, v236
v_sub_f32 v130, v130, v236
v_sub_f32 v131, v131, v236
v_sub_f32 v140, v140, v236
v_sub_f32 v141, v141, v236
v_sub_f32 v142, v142, v236
v_sub_f32 v143, v143, v236
v_sub_f32 v152, v152, v236
v_sub_f32 v153, v153, v236
v_sub_f32 v154, v154, v236
v_sub_f32 v155, v155, v236
v_sub_f32 v164, v164, v236
v_sub_f32 v165, v165, v236
v_sub_f32 v166, v166, v236
v_sub_f32 v167, v167, v236
v_mov_b32 v244, 0
v_exp_f32 v238, v128
v_exp_f32 v239, v129
s_nop 0
v_cvt_pk_bf16_f32 v176, v238, v239
v_add_f32 v244, v238, v244
v_add_f32 v244, v239, v244
v_exp_f32 v238, v130
v_exp_f32 v239, v131
s_nop 0
v_cvt_pk_bf16_f32 v177, v238, v239
v_add_f32 v244, v238, v244
v_add_f32 v244, v239, v244
v_exp_f32 v238, v140
v_exp_f32 v239, v141
s_nop 0
v_cvt_pk_bf16_f32 v178, v238, v239
v_add_f32 v244, v238, v244
v_add_f32 v244, v239, v244
v_exp_f32 v238, v142
v_exp_f32 v239, v143
s_nop 0
v_cvt_pk_bf16_f32 v179, v238, v239
v_add_f32 v244, v238, v244
v_add_f32 v244, v239, v244
v_max3_f32 v236, v132, v133, v134
v_max3_f32 v236, v236, v135, v144
v_max3_f32 v236, v236, v145, v146
v_max_f32 v236, v236, v147
v_mov_b32 v237, v236
s_nop 1
v_permlane32_swap_b32 v236, v237
v_max_f32 v236, v236, v237
v_mov_b32 v237, v236
s_nop 1
v_permlane16_swap_b32 v236, v237
v_max_f32 v236, v236, v237
v_ceil_f32 v236, v236
v_max_f32 v236, 0, v236
v_exp_f32 v254, -v236
v_sub_f32 v228, v228, v236
v_sub_f32 v229, v229, v236
v_sub_f32 v230, v230, v236
v_sub_f32 v231, v231, v236
v_sub_f32 v132, v132, v236
v_sub_f32 v133, v133, v236
v_sub_f32 v134, v134, v236
v_sub_f32 v135, v135, v236
v_sub_f32 v144, v144, v236
v_sub_f32 v145, v145, v236
v_sub_f32 v146, v146, v236
v_sub_f32 v147, v147, v236
v_sub_f32 v156, v156, v236
v_sub_f32 v157, v157, v236
v_sub_f32 v158, v158, v236
v_sub_f32 v159, v159, v236
v_sub_f32 v168, v168, v236
v_sub_f32 v169, v169, v236
v_sub_f32 v170, v170, v236
v_sub_f32 v171, v171, v236
v_mov_b32 v245, 0
v_exp_f32 v238, v132
v_exp_f32 v239, v133
s_nop 0
v_cvt_pk_bf16_f32 v180, v238, v239
v_add_f32 v245, v238, v245
v_add_f32 v245, v239, v245
v_exp_f32 v238, v134
v_exp_f32 v239, v135
s_nop 0
v_cvt_pk_bf16_f32 v181, v238, v239
v_add_f32 v245, v238, v245
v_add_f32 v245, v239, v245
v_exp_f32 v238, v144
v_exp_f32 v239, v145
s_nop 0
v_cvt_pk_bf16_f32 v182, v238, v239
v_add_f32 v245, v238, v245
v_add_f32 v245, v239, v245
v_exp_f32 v238, v146
v_exp_f32 v239, v147
s_nop 0
v_cvt_pk_bf16_f32 v183, v238, v239
v_add_f32 v245, v238, v245
v_add_f32 v245, v239, v245
v_mov_b32 v255, 1.0
s_mov_b32 s56, 0
s_branch L_slow_tail
L_slow_1:
s_nop 15
v_max3_f32 v236, v152, v153, v154
v_max3_f32 v236, v236, v155, v164
v_max3_f32 v236, v236, v165, v166
v_max_f32 v236, v236, v167
v_mov_b32 v237, v236
s_nop 1
v_permlane32_swap_b32 v236, v237
v_max_f32 v236, v236, v237
v_mov_b32 v237, v236
s_nop 1
v_permlane16_swap_b32 v236, v237
v_max_f32 v236, v236, v237
v_ceil_f32 v236, v236
v_max_f32 v236, 0, v236
v_exp_f32 v253, -v236
v_sub_f32 v224, v224, v236
v_sub_f32 v225, v225, v236
v_sub_f32 v226, v226, v236
v_sub_f32 v227, v227, v236
v_sub_f32 v152, v152, v236
v_sub_f32 v153, v153, v236
v_sub_f32 v154, v154, v236
v_sub_f32 v155, v155, v236
v_sub_f32 v164, v164, v236
v_sub_f32 v165, v165, v236
v_sub_f32 v166, v166, v236
v_sub_f32 v167, v167, v236
v_sub_f32 v128, v128, v236
v_sub_f32 v129, v129, v236
v_sub_f32 v130, v130, v236
v_sub_f32 v131, v131, v236
v_sub_f32 v140, v140, v236
v_sub_f32 v141, v141, v236
v_sub_f32 v142, v142, v236
v_sub_f32 v143, v143, v236
v_lshlrev_b32 v238, 16, v176
v_and_b32 v239, 0xffff0000, v176
v_mul_f32 v238, v238, v253
v_mul_f32 v239, v239, v253
v_cvt_pk_bf16_f32 v176, v238, v239
v_lshlrev_b32 v238, 16, v177
v_and_b32 v239, 0xffff0000, v177
v_mul_f32 v238, v238, v253
v_mul_f32 v239, v239, v253
v_cvt_pk_bf16_f32 v177, v238, v239
v_lshlrev_b32 v238, 16, v178
v_and_b32 v239, 0xffff0000, v178
v_mul_f32 v238, v238, v253
v_mul_f32 v239, v239, v253
v_cvt_pk_bf16_f32 v178, v238, v239
v_lshlrev_b32 v238, 16, v179
v_and_b32 v239, 0xffff0000, v179
v_mul_f32 v238, v238, v253
v_mul_f32 v239, v239, v253
v_cvt_pk_bf16_f32 v179, v238, v239
v_mov_b32 v247, 0
v_exp_f32 v238, v152
v_exp_f32 v239, v153
s_nop 0
v_cvt_pk_bf16_f32 v188, v238, v239
v_add_f32 v247, v238, v247
v_add_f32 v247, v239, v247
v_exp_f32 v238, v154
v_exp_f32 v239, v155
s_nop 0
v_cvt_pk_bf16_f32 v189, v238, v239
v_add_f32 v247, v238, v247
v_add_f32 v247, v239, v247
v_exp_f32 v238, v164
v_exp_f32 v239, v165
s_nop 0
v_cvt_pk_bf16_f32 v190, v238, v239
v_add_f32 v247, v238, v247
v_add_f32 v247, v239, v247
v_exp_f32 v238, v166
v_exp_f32 v239, v167
s_nop 0
v_cvt_pk_bf16_f32 v191, v238, v239
v_add_f32 v247, v238, v247
v_add_f32 v247, v239, v247
v_max3_f32 v236, v156, v157, v158
v_max3_f32 v236, v236, v159, v168
v_max3_f32 v236, v236, v169, v170
v_max_f32 v236, v236, v171
v_mov_b32 v237, v236
s_nop 1
v_permlane32_swap_b32 v236, v237
v_max_f32 v236, v236, v237
v_mov_b32 v237, v236
s_nop 1
v_permlane16_swap_b32 v236, v237
v_max_f32 v236, v236, v237
v_ceil_f32 v236, v236
v_max_f32 v236, 0, v236
v_exp_f32 v254, -v236
v_sub_f32 v228, v228, v236
v_sub_f32 v229, v229, v236
v_sub_f32 v230, v230, v236
v_sub_f32 v231, v231, v236
v_sub_f32 v156, v156, v236
v_sub_f32 v157, v157, v236
v_sub_f32 v158, v158, v236
v_sub_f32 v159, v159, v236
v_sub_f32 v168, v168, v236
v_sub_f32 v169, v169, v236
v_sub_f32 v170, v170, v236
v_sub_f32 v171, v171, v236
v_sub_f32 v132, v132, v236
v_sub_f32 v133, v133, v236
v_sub_f32 v134, v134, v236
v_sub_f32 v135, v135, v236
v_sub_f32 v144, v144, v236
v_sub_f32 v145, v145, v236
v_sub_f32 v146, v146, v236
v_sub_f32 v147, v147, v236
v_lshlrev_b32 v238, 16, v180
v_and_b32 v239, 0xffff0000, v180
v_mul_f32 v238, v238, v254
v_mul_f32 v239, v239, v254
v_cvt_pk_bf16_f32 v180, v238, v239
v_lshlrev_b32 v238, 16, v181
v_and_b32 v239, 0xffff0000, v181
v_mul_f32 v238, v238, v254
v_mul_f32 v239, v239, v254
v_cvt_pk_bf16_f32 v181, v238, v239
v_lshlrev_b32 v238, 16, v182
v_and_b32 v239, 0xffff0000, v182
v_mul_f32 v238, v238, v254
v_mul_f32 v239, v239, v254
v_cvt_pk_bf16_f32 v182, v238, v239
v_lshlrev_b32 v238, 16, v183
v_and_b32 v239, 0xffff0000, v183
v_mul_f32 v238, v238, v254
v_mul_f32 v239, v239, v254
v_cvt_pk_bf16_f32 v183, v238, v239
v_mov_b32 v248, 0
v_exp_f32 v238, v156
v_exp_f32 v239, v157
s_nop 0
v_cvt_pk_bf16_f32 v192, v238, v239
v_add_f32 v248, v238, v248
v_add_f32 v248, v239, v248
v_exp_f32 v238, v158
v_exp_f32 v239, v159
s_nop 0
v_cvt_pk_bf16_f32 v193, v238, v239
v_add_f32 v248, v238, v248
v_add_f32 v248, v239, v248
v_exp_f32 v238, v168
v_exp_f32 v239, v169
s_nop 0
v_cvt_pk_bf16_f32 v194, v238, v239
v_add_f32 v248, v238, v248
v_add_f32 v248, v239, v248
v_exp_f32 v238, v170
v_exp_f32 v239, v171
s_nop 0
v_cvt_pk_bf16_f32 v195, v238, v239
v_add_f32 v248, v238, v248
v_add_f32 v248, v239, v248
v_max3_f32 v236, v160, v161, v162
v_max3_f32 v236, v236, v163, v172
v_max3_f32 v236, v236, v173, v174
v_max_f32 v236, v236, v175
v_mov_b32 v237, v236
s_nop 1
v_permlane32_swap_b32 v236, v237
v_max_f32 v236, v236, v237
v_mov_b32 v237, v236
s_nop 1
v_permlane16_swap_b32 v236, v237
v_max_f32 v236, v236, v237
v_ceil_f32 v236, v236
v_max_f32 v236, 0, v236
v_exp_f32 v255, -v236
v_sub_f32 v232, v232, v236
v_sub_f32 v233, v233, v236
v_sub_f32 v234, v234, v236
v_sub_f32 v235, v235, v236
v_sub_f32 v160, v160, v236
v_sub_f32 v161, v161, v236
v_sub_f32 v162, v162, v236
v_sub_f32 v163, v163, v236
v_sub_f32 v172, v172, v236
v_sub_f32 v173, v173, v236
v_sub_f32 v174, v174, v236
v_sub_f32 v175, v175, v236
v_mov_b32 v249, 0
v_exp_f32 v238, v160
v_exp_f32 v239, v161
s_nop 0
v_cvt_pk_bf16_f32 v196, v238, v239
v_add_f32 v249, v238, v249
v_add_f32 v249, v239, v249
v_exp_f32 v238, v162
v_exp_f32 v239, v163
s_nop 0
v_cvt_pk_bf16_f32 v197, v238, v239
v_add_f32 v249, v238, v249
v_add_f32 v249, v239, v249
v_exp_f32 v238, v172
v_exp_f32 v239, v173
s_nop 0
v_cvt_pk_bf16_f32 v198, v238, v239
v_add_f32 v249, v238, v249
v_add_f32 v249, v239, v249
v_exp_f32 v238, v174
v_exp_f32 v239, v175
s_nop 0
v_cvt_pk_bf16_f32 v199, v238, v239
v_add_f32 v249, v238, v249
v_add_f32 v249, v239, v249
s_mov_b32 s56, 1
s_branch L_slow_tail
L_slow_2:
s_nop 15
v_max3_f32 v236, v128, v129, v130
v_max3_f32 v236, v236, v131, v140
v_max3_f32 v236, v236, v141, v142
v_max_f32 v236, v236, v143
v_mov_b32 v237, v236
s_nop 1
v_permlane32_swap_b32 v236, v237
v_max_f32 v236, v236, v237
v_mov_b32 v237, v236
s_nop 1
v_permlane16_swap_b32 v236, v237
v_max_f32 v236, v236, v237
v_ceil_f32 v236, v236
v_max_f32 v236, 0, v236
v_exp_f32 v253, -v236
v_sub_f32 v224, v224, v236
v_sub_f32 v225, v225, v236
v_sub_f32 v226, v226, v236
v_sub_f32 v227, v227, v236
v_sub_f32 v128, v128, v236
v_sub_f32 v129, v129, v236
v_sub_f32 v130, v130, v236
v_sub_f32 v131, v131, v236
v_sub_f32 v140, v140, v236
v_sub_f32 v141, v141, v236
v_sub_f32 v142, v142, v236
v_sub_f32 v143, v143, v236
v_sub_f32 v152, v152, v236
v_sub_f32 v153, v153, v236
v_sub_f32 v154, v154, v236
v_sub_f32 v155, v155, v236
v_sub_f32 v164, v164, v236
v_sub_f32 v165, v165, v236
v_sub_f32 v166, v166, v236
v_sub_f32 v167, v167, v236
v_lshlrev_b32 v238, 16, v188
v_and_b32 v239, 0xffff0000, v188
v_mul_f32 v238, v238, v253
v_mul_f32 v239, v239, v253
v_cvt_pk_bf16_f32 v188, v238, v239
v_lshlrev_b32 v238, 16, v189
v_and_b32 v239, 0xffff0000, v189
v_mul_f32 v238, v238, v253
v_mul_f32 v239, v239, v253
v_cvt_pk_bf16_f32 v189, v238, v239
v_lshlrev_b32 v238, 16, v190
v_and_b32 v239, 0xffff0000, v190
v_mul_f32 v238, v238, v253
v_mul_f32 v239, v239, v253
v_cvt_pk_bf16_f32 v190, v238, v239
v_lshlrev_b32 v238, 16, v191
v_and_b32 v239, 0xffff0000, v191
v_mul_f32 v238, v238, v253
v_mul_f32 v239, v239, v253
v_cvt_pk_bf16_f32 v191, v238, v239
v_mov_b32 v244, 0
v_exp_f32 v238, v128
v_exp_f32 v239, v129
s_nop 0
v_cvt_pk_bf16_f32 v200, v238, v239
v_add_f32 v244, v238, v244
v_add_f32 v244, v239, v244
v_exp_f32 v238, v130
v_exp_f32 v239, v131
s_nop 0
v_cvt_pk_bf16_f32 v201, v238, v239
v_add_f32 v244, v238, v244
v_add_f32 v244, v239, v244
v_exp_f32 v238, v140
v_exp_f32 v239, v141
s_nop 0
v_cvt_pk_bf16_f32 v202, v238, v239
v_add_f32 v244, v238, v244
v_add_f32 v244, v239, v244
v_exp_f32 v238, v142
v_exp_f32 v239, v143
s_nop 0
v_cvt_pk_bf16_f32 v203, v238, v239
v_add_f32 v244, v238, v244
v_add_f32 v244, v239, v244
v_max3_f32 v236, v132, v133, v134
v_max3_f32 v236, v236, v135, v144
v_max3_f32 v236, v236, v145, v146
v_max_f32 v236, v236, v147
v_mov_b32 v237, v236
s_nop 1
v_permlane32_swap_b32 v236, v237
v_max_f32 v236, v236, v237
v_mov_b32 v237, v236
s_nop 1
v_permlane16_swap_b32 v236, v237
v_max_f32 v236, v236, v237
v_ceil_f32 v236, v236
v_max_f32 v236, 0, v236
v_exp_f32 v254, -v236
v_sub_f32 v228, v228, v236
v_sub_f32 v229, v229, v236
v_sub_f32 v230, v230, v236
v_sub_f32 v231, v231, v236
v_sub_f32 v132, v132, v236
v_sub_f32 v133, v133, v236
v_sub_f32 v134, v134, v236
v_sub_f32 v135, v135, v236
v_sub_f32 v144, v144, v236
v_sub_f32 v145, v145, v236
v_sub_f32 v146, v146, v236
v_sub_f32 v147, v147, v236
v_sub_f32 v156, v156, v236
v_sub_f32 v157, v157, v236
v_sub_f32 v158, v158, v236
v_sub_f32 v159, v159, v236
v_sub_f32 v168, v168, v236
v_sub_f32 v169, v169, v236
v_sub_f32 v170, v170, v236
v_sub_f32 v171, v171, v236
v_lshlrev_b32 v238, 16, v192
v_and_b32 v239, 0xffff0000, v192
v_mul_f32 v238, v238, v254
v_mul_f32 v239, v239, v254
v_cvt_pk_bf16_f32 v192, v238, v239
v_lshlrev_b32 v238, 16, v193
v_and_b32 v239, 0xffff0000, v193
v_mul_f32 v238, v238, v254
v_mul_f32 v239, v239, v254
v_cvt_pk_bf16_f32 v193, v238, v239
v_lshlrev_b32 v238, 16, v194
v_and_b32 v239, 0xffff0000, v194
v_mul_f32 v238, v238, v254
v_mul_f32 v239, v239, v254
v_cvt_pk_bf16_f32 v194, v238, v239
v_lshlrev_b32 v238, 16, v195
v_and_b32 v239, 0xffff0000, v195
v_mul_f32 v238, v238, v254
v_mul_f32 v239, v239, v254
v_cvt_pk_bf16_f32 v195, v238, v239
v_mov_b32 v245, 0
v_exp_f32 v238, v132
v_exp_f32 v239, v133
s_nop 0
v_cvt_pk_bf16_f32 v204, v238, v239
v_add_f32 v245, v238, v245
v_add_f32 v245, v239, v245
v_exp_f32 v238, v134
v_exp_f32 v239, v135
s_nop 0
v_cvt_pk_bf16_f32 v205, v238, v239
v_add_f32 v245, v238, v245
v_add_f32 v245, v239, v245
v_exp_f32 v238, v144
v_exp_f32 v239, v145
s_nop 0
v_cvt_pk_bf16_f32 v206, v238, v239
v_add_f32 v245, v238, v245
v_add_f32 v245, v239, v245
v_exp_f32 v238, v146
v_exp_f32 v239, v147
s_nop 0
v_cvt_pk_bf16_f32 v207, v238, v239
v_add_f32 v245, v238, v245
v_add_f32 v245, v239, v245
v_mov_b32 v255, 1.0
s_mov_b32 s56, 2
s_branch L_slow_tail
L_slow_3:
s_nop 15
v_max3_f32 v236, v152, v153, v154
v_max3_f32 v236, v236, v155, v164
v_max3_f32 v236, v236, v165, v166
v_max_f32 v236, v236, v167
v_mov_b32 v237, v236
s_nop 1
v_permlane32_swap_b32 v236, v237
v_max_f32 v236, v236, v237
v_mov_b32 v237, v236
s_nop 1
v_permlane16_swap_b32 v236, v237
v_max_f32 v236, v236, v237
v_ceil_f32 v236, v236
v_max_f32 v236, 0, v236
v_exp_f32 v253, -v236
v_sub_f32 v224, v224, v236
v_sub_f32 v225, v225, v236
v_sub_f32 v226, v226, v236
v_sub_f32 v227, v227, v236
v_sub_f32 v152, v152, v236
v_sub_f32 v153, v153, v236
v_sub_f32 v154, v154, v236
v_sub_f32 v155, v155, v236
v_sub_f32 v164, v164, v236
v_sub_f32 v165, v165, v236
v_sub_f32 v166, v166, v236
v_sub_f32 v167, v167, v236
v_sub_f32 v128, v128, v236
v_sub_f32 v129, v129, v236
v_sub_f32 v130, v130, v236
v_sub_f32 v131, v131, v236
v_sub_f32 v140, v140, v236
v_sub_f32 v141, v141, v236
v_sub_f32 v142, v142, v236
v_sub_f32 v143, v143, v236
v_lshlrev_b32 v238, 16, v200
v_and_b32 v239, 0xffff0000, v200
v_mul_f32 v238, v238, v253
v_mul_f32 v239, v239, v253
v_cvt_pk_bf16_f32 v200, v238, v239
v_lshlrev_b32 v238, 16, v201
v_and_b32 v239, 0xffff0000, v201
v_mul_f32 v238, v238, v253
v_mul_f32 v239, v239, v253
v_cvt_pk_bf16_f32 v201, v238, v239
v_lshlrev_b32 v238, 16, v202
v_and_b32 v239, 0xffff0000, v202
v_mul_f32 v238, v238, v253
v_mul_f32 v239, v239, v253
v_cvt_pk_bf16_f32 v202, v238, v239
v_lshlrev_b32 v238, 16, v203
v_and_b32 v239, 0xffff0000, v203
v_mul_f32 v238, v238, v253
v_mul_f32 v239, v239, v253
v_cvt_pk_bf16_f32 v203, v238, v239
v_mov_b32 v247, 0
v_exp_f32 v238, v152
v_exp_f32 v239, v153
s_nop 0
v_cvt_pk_bf16_f32 v212, v238, v239
v_add_f32 v247, v238, v247
v_add_f32 v247, v239, v247
v_exp_f32 v238, v154
v_exp_f32 v239, v155
s_nop 0
v_cvt_pk_bf16_f32 v213, v238, v239
v_add_f32 v247, v238, v247
v_add_f32 v247, v239, v247
v_exp_f32 v238, v164
v_exp_f32 v239, v165
s_nop 0
v_cvt_pk_bf16_f32 v214, v238, v239
v_add_f32 v247, v238, v247
v_add_f32 v247, v239, v247
v_exp_f32 v238, v166
v_exp_f32 v239, v167
s_nop 0
v_cvt_pk_bf16_f32 v215, v238, v239
v_add_f32 v247, v238, v247
v_add_f32 v247, v239, v247
v_max3_f32 v236, v156, v157, v158
v_max3_f32 v236, v236, v159, v168
v_max3_f32 v236, v236, v169, v170
v_max_f32 v236, v236, v171
v_mov_b32 v237, v236
s_nop 1
v_permlane32_swap_b32 v236, v237
v_max_f32 v236, v236, v237
v_mov_b32 v237, v236
s_nop 1
v_permlane16_swap_b32 v236, v237
v_max_f32 v236, v236, v237
v_ceil_f32 v236, v236
v_max_f32 v236, 0, v236
v_exp_f32 v254, -v236
v_sub_f32 v228, v228, v236
v_sub_f32 v229, v229, v236
v_sub_f32 v230, v230, v236
v_sub_f32 v231, v231, v236
v_sub_f32 v156, v156, v236
v_sub_f32 v157, v157, v236
v_sub_f32 v158, v158, v236
v_sub_f32 v159, v159, v236
v_sub_f32 v168, v168, v236
v_sub_f32 v169, v169, v236
v_sub_f32 v170, v170, v236
v_sub_f32 v171, v171, v236
v_sub_f32 v132, v132, v236
v_sub_f32 v133, v133, v236
v_sub_f32 v134, v134, v236
v_sub_f32 v135, v135, v236
v_sub_f32 v144, v144, v236
v_sub_f32 v145, v145, v236
v_sub_f32 v146, v146, v236
v_sub_f32 v147, v147, v236
v_lshlrev_b32 v238, 16, v204
v_and_b32 v239, 0xffff0000, v204
v_mul_f32 v238, v238, v254
v_mul_f32 v239, v239, v254
v_cvt_pk_bf16_f32 v204, v238, v239
v_lshlrev_b32 v238, 16, v205
v_and_b32 v239, 0xffff0000, v205
v_mul_f32 v238, v238, v254
v_mul_f32 v239, v239, v254
v_cvt_pk_bf16_f32 v205, v238, v239
v_lshlrev_b32 v238, 16, v206
v_and_b32 v239, 0xffff0000, v206
v_mul_f32 v238, v238, v254
v_mul_f32 v239, v239, v254
v_cvt_pk_bf16_f32 v206, v238, v239
v_lshlrev_b32 v238, 16, v207
v_and_b32 v239, 0xffff0000, v207
v_mul_f32 v238, v238, v254
v_mul_f32 v239, v239, v254
v_cvt_pk_bf16_f32 v207, v238, v239
v_mov_b32 v248, 0
v_exp_f32 v238, v156
v_exp_f32 v239, v157
s_nop 0
v_cvt_pk_bf16_f32 v216, v238, v239
v_add_f32 v248, v238, v248
v_add_f32 v248, v239, v248
v_exp_f32 v238, v158
v_exp_f32 v239, v159
s_nop 0
v_cvt_pk_bf16_f32 v217, v238, v239
v_add_f32 v248, v238, v248
v_add_f32 v248, v239, v248
v_exp_f32 v238, v168
v_exp_f32 v239, v169
s_nop 0
v_cvt_pk_bf16_f32 v218, v238, v239
v_add_f32 v248, v238, v248
v_add_f32 v248, v239, v248
v_exp_f32 v238, v170
v_exp_f32 v239, v171
s_nop 0
v_cvt_pk_bf16_f32 v219, v238, v239
v_add_f32 v248, v238, v248
v_add_f32 v248, v239, v248
v_max3_f32 v236, v160, v161, v162
v_max3_f32 v236, v236, v163, v172
v_max3_f32 v236, v236, v173, v174
v_max_f32 v236, v236, v175
v_mov_b32 v237, v236
s_nop 1
v_permlane32_swap_b32 v236, v237
v_max_f32 v236, v236, v237
v_mov_b32 v237, v236
s_nop 1
v_permlane16_swap_b32 v236, v237
v_max_f32 v236, v236, v237
v_ceil_f32 v236, v236
v_max_f32 v236, 0, v236
v_exp_f32 v255, -v236
v_sub_f32 v232, v232, v236
v_sub_f32 v233, v233, v236
v_sub_f32 v234, v234, v236
v_sub_f32 v235, v235, v236
v_sub_f32 v160, v160, v236
v_sub_f32 v161, v161, v236
v_sub_f32 v162, v162, v236
v_sub_f32 v163, v163, v236
v_sub_f32 v172, v172, v236
v_sub_f32 v173, v173, v236
v_sub_f32 v174, v174, v236
v_sub_f32 v175, v175, v236
v_mov_b32 v249, 0
v_exp_f32 v238, v160
v_exp_f32 v239, v161
s_nop 0
v_cvt_pk_bf16_f32 v220, v238, v239
v_add_f32 v249, v238, v249
v_add_f32 v249, v239, v249
v_exp_f32 v238, v162
v_exp_f32 v239, v163
s_nop 0
v_cvt_pk_bf16_f32 v221, v238, v239
v_add_f32 v249, v238, v249
v_add_f32 v249, v239, v249
v_exp_f32 v238, v172
v_exp_f32 v239, v173
s_nop 0
v_cvt_pk_bf16_f32 v222, v238, v239
v_add_f32 v249, v238, v249
v_add_f32 v249, v239, v249
v_exp_f32 v238, v174
v_exp_f32 v239, v175
s_nop 0
v_cvt_pk_bf16_f32 v223, v238, v239
v_add_f32 v249, v238, v249
v_add_f32 v249, v239, v249
s_mov_b32 s56, 3
s_branch L_slow_tail
L_slow_4:
s_nop 15
v_max3_f32 v236, v128, v129, v130
v_max3_f32 v236, v236, v131, v140
v_max3_f32 v236, v236, v141, v142
v_max_f32 v236, v236, v143
v_mov_b32 v237, v236
s_nop 1
v_permlane32_swap_b32 v236, v237
v_max_f32 v236, v236, v237
v_mov_b32 v237, v236
s_nop 1
v_permlane16_swap_b32 v236, v237
v_max_f32 v236, v236, v237
v_ceil_f32 v236, v236
v_max_f32 v236, 0, v236
v_exp_f32 v253, -v236
v_sub_f32 v224, v224, v236
v_sub_f32 v225, v225, v236
v_sub_f32 v226, v226, v236
v_sub_f32 v227, v227, v236
v_sub_f32 v128, v128, v236
v_sub_f32 v129, v129, v236
v_sub_f32 v130, v130, v236
v_sub_f32 v131, v131, v236
v_sub_f32 v140, v140, v236
v_sub_f32 v141, v141, v236
v_sub_f32 v142, v142, v236
v_sub_f32 v143, v143, v236
v_sub_f32 v152, v152, v236
v_sub_f32 v153, v153, v236
v_sub_f32 v154, v154, v236
v_sub_f32 v155, v155, v236
v_sub_f32 v164, v164, v236
v_sub_f32 v165, v165, v236
v_sub_f32 v166, v166, v236
v_sub_f32 v167, v167, v236
v_lshlrev_b32 v238, 16, v200
v_and_b32 v239, 0xffff0000, v200
v_mul_f32 v238, v238, v253
v_mul_f32 v239, v239, v253
v_cvt_pk_bf16_f32 v200, v238, v239
v_lshlrev_b32 v238, 16, v201
v_and_b32 v239, 0xffff0000, v201
v_mul_f32 v238, v238, v253
v_mul_f32 v239, v239, v253
v_cvt_pk_bf16_f32 v201, v238, v239
v_lshlrev_b32 v238, 16, v202
v_and_b32 v239, 0xffff0000, v202
v_mul_f32 v238, v238, v253
v_mul_f32 v239, v239, v253
v_cvt_pk_bf16_f32 v202, v238, v239
v_lshlrev_b32 v238, 16, v203
v_and_b32 v239, 0xffff0000, v203
v_mul_f32 v238, v238, v253
v_mul_f32 v239, v239, v253
v_cvt_pk_bf16_f32 v203, v238, v239
v_lshlrev_b32 v238, 16, v212
v_and_b32 v239, 0xffff0000, v212
v_mul_f32 v238, v238, v253
v_mul_f32 v239, v239, v253
v_cvt_pk_bf16_f32 v212, v238, v239
v_lshlrev_b32 v238, 16, v213
v_and_b32 v239, 0xffff0000, v213
v_mul_f32 v238, v238, v253
v_mul_f32 v239, v239, v253
v_cvt_pk_bf16_f32 v213, v238, v239
v_lshlrev_b32 v238, 16, v214
v_and_b32 v239, 0xffff0000, v214
v_mul_f32 v238, v238, v253
v_mul_f32 v239, v239, v253
v_cvt_pk_bf16_f32 v214, v238, v239
v_lshlrev_b32 v238, 16, v215
v_and_b32 v239, 0xffff0000, v215
v_mul_f32 v238, v238, v253
v_mul_f32 v239, v239, v253
v_cvt_pk_bf16_f32 v215, v238, v239
v_mov_b32 v244, 0
v_exp_f32 v238, v128
v_exp_f32 v239, v129
s_nop 0
v_cvt_pk_bf16_f32 v176, v238, v239
v_add_f32 v244, v238, v244
v_add_f32 v244, v239, v244
v_exp_f32 v238, v130
v_exp_f32 v239, v131
s_nop 0
v_cvt_pk_bf16_f32 v177, v238, v239
v_add_f32 v244, v238, v244
v_add_f32 v244, v239, v244
v_exp_f32 v238, v140
v_exp_f32 v239, v141
s_nop 0
v_cvt_pk_bf16_f32 v178, v238, v239
v_add_f32 v244, v238, v244
v_add_f32 v244, v239, v244
v_exp_f32 v238, v142
v_exp_f32 v239, v143
s_nop 0
v_cvt_pk_bf16_f32 v179, v238, v239
v_add_f32 v244, v238, v244
v_add_f32 v244, v239, v244
v_max3_f32 v236, v132, v133, v134
v_max3_f32 v236, v236, v135, v144
v_max3_f32 v236, v236, v145, v146
v_max_f32 v236, v236, v147
v_mov_b32 v237, v236
s_nop 1
v_permlane32_swap_b32 v236, v237
v_max_f32 v236, v236, v237
v_mov_b32 v237, v236
s_nop 1
v_permlane16_swap_b32 v236, v237
v_max_f32 v236, v236, v237
v_ceil_f32 v236, v236
v_max_f32 v236, 0, v236
v_exp_f32 v254, -v236
v_sub_f32 v228, v228, v236
v_sub_f32 v229, v229, v236
v_sub_f32 v230, v230, v236
v_sub_f32 v231, v231, v236
v_sub_f32 v132, v132, v236
v_sub_f32 v133, v133, v236
v_sub_f32 v134, v134, v236
v_sub_f32 v135, v135, v236
v_sub_f32 v144, v144, v236
v_sub_f32 v145, v145, v236
v_sub_f32 v146, v146, v236
v_sub_f32 v147, v147, v236
v_sub_f32 v156, v156, v236
v_sub_f32 v157, v157, v236
v_sub_f32 v158, v158, v236
v_sub_f32 v159, v159, v236
v_sub_f32 v168, v168, v236
v_sub_f32 v169, v169, v236
v_sub_f32 v170, v170, v236
v_sub_f32 v171, v171, v236
v_lshlrev_b32 v238, 16, v204
v_and_b32 v239, 0xffff0000, v204
v_mul_f32 v238, v238, v254
v_mul_f32 v239, v239, v254
v_cvt_pk_bf16_f32 v204, v238, v239
v_lshlrev_b32 v238, 16, v205
v_and_b32 v239, 0xffff0000, v205
v_mul_f32 v238, v238, v254
v_mul_f32 v239, v239, v254
v_cvt_pk_bf16_f32 v205, v238, v239
v_lshlrev_b32 v238, 16, v206
v_and_b32 v239, 0xffff0000, v206
v_mul_f32 v238, v238, v254
v_mul_f32 v239, v239, v254
v_cvt_pk_bf16_f32 v206, v238, v239
v_lshlrev_b32 v238, 16, v207
v_and_b32 v239, 0xffff0000, v207
v_mul_f32 v238, v238, v254
v_mul_f32 v239, v239, v254
v_cvt_pk_bf16_f32 v207, v238, v239
v_lshlrev_b32 v238, 16, v216
v_and_b32 v239, 0xffff0000, v216
v_mul_f32 v238, v238, v254
v_mul_f32 v239, v239, v254
v_cvt_pk_bf16_f32 v216, v238, v239
v_lshlrev_b32 v238, 16, v217
v_and_b32 v239, 0xffff0000, v217
v_mul_f32 v238, v238, v254
v_mul_f32 v239, v239, v254
v_cvt_pk_bf16_f32 v217, v238, v239
v_lshlrev_b32 v238, 16, v218
v_and_b32 v239, 0xffff0000, v218
v_mul_f32 v238, v238, v254
v_mul_f32 v239, v239, v254
v_cvt_pk_bf16_f32 v218, v238, v239
v_lshlrev_b32 v238, 16, v219
v_and_b32 v239, 0xffff0000, v219
v_mul_f32 v238, v238, v254
v_mul_f32 v239, v239, v254
v_cvt_pk_bf16_f32 v219, v238, v239
v_mov_b32 v245, 0
v_exp_f32 v238, v132
v_exp_f32 v239, v133
s_nop 0
v_cvt_pk_bf16_f32 v180, v238, v239
v_add_f32 v245, v238, v245
v_add_f32 v245, v239, v245
v_exp_f32 v238, v134
v_exp_f32 v239, v135
s_nop 0
v_cvt_pk_bf16_f32 v181, v238, v239
v_add_f32 v245, v238, v245
v_add_f32 v245, v239, v245
v_exp_f32 v238, v144
v_exp_f32 v239, v145
s_nop 0
v_cvt_pk_bf16_f32 v182, v238, v239
v_add_f32 v245, v238, v245
v_add_f32 v245, v239, v245
v_exp_f32 v238, v146
v_exp_f32 v239, v147
s_nop 0
v_cvt_pk_bf16_f32 v183, v238, v239
v_add_f32 v245, v238, v245
v_add_f32 v245, v239, v245
v_mov_b32 v255, 1.0
s_mov_b32 s56, 4
s_branch L_slow_tail
L_slow_5:
s_nop 15
v_max3_f32 v236, v152, v153, v154
v_max3_f32 v236, v236, v155, v164
v_max3_f32 v236, v236, v165, v166
v_max_f32 v236, v236, v167
v_mov_b32 v237, v236
s_nop 1
v_permlane32_swap_b32 v236, v237
v_max_f32 v236, v236, v237
v_mov_b32 v237, v236
s_nop 1
v_permlane16_swap_b32 v236, v237
v_max_f32 v236, v236, v237
v_ceil_f32 v236, v236
v_max_f32 v236, 0, v236
v_exp_f32 v253, -v236
v_sub_f32 v224, v224, v236
v_sub_f32 v225, v225, v236
v_sub_f32 v226, v226, v236
v_sub_f32 v227, v227, v236
v_sub_f32 v152, v152, v236
v_sub_f32 v153, v153, v236
v_sub_f32 v154, v154, v236
v_sub_f32 v155, v155, v236
v_sub_f32 v164, v164, v236
v_sub_f32 v165, v165, v236
v_sub_f32 v166, v166, v236
v_sub_f32 v167, v167, v236
v_sub_f32 v128, v128, v236
v_sub_f32 v129, v129, v236
v_sub_f32 v130, v130, v236
v_sub_f32 v131, v131, v236
v_sub_f32 v140, v140, v236
v_sub_f32 v141, v141, v236
v_sub_f32 v142, v142, v236
v_sub_f32 v143, v143, v236
v_lshlrev_b32 v238, 16, v176
v_and_b32 v239, 0xffff0000, v176
v_mul_f32 v238, v238, v253
v_mul_f32 v239, v239, v253
v_cvt_pk_bf16_f32 v176, v238, v239
v_lshlrev_b32 v238, 16, v177
v_and_b32 v239, 0xffff0000, v177
v_mul_f32 v238, v238, v253
v_mul_f32 v239, v239, v253
v_cvt_pk_bf16_f32 v177, v238, v239
v_lshlrev_b32 v238, 16, v178
v_and_b32 v239, 0xffff0000, v178
v_mul_f32 v238, v238, v253
v_mul_f32 v239, v239, v253
v_cvt_pk_bf16_f32 v178, v238, v239
v_lshlrev_b32 v238, 16, v179
v_and_b32 v239, 0xffff0000, v179
v_mul_f32 v238, v238, v253
v_mul_f32 v239, v239, v253
v_cvt_pk_bf16_f32 v179, v238, v239
v_mov_b32 v247, 0
v_exp_f32 v238, v152
v_exp_f32 v239, v153
s_nop 0
v_cvt_pk_bf16_f32 v188, v238, v239
v_add_f32 v247, v238, v247
v_add_f32 v247, v239, v247
v_exp_f32 v238, v154
v_exp_f32 v239, v155
s_nop 0
v_cvt_pk_bf16_f32 v189, v238, v239
v_add_f32 v247, v238, v247
v_add_f32 v247, v239, v247
v_exp_f32 v238, v164
v_exp_f32 v239, v165
s_nop 0
v_cvt_pk_bf16_f32 v190, v238, v239
v_add_f32 v247, v238, v247
v_add_f32 v247, v239, v247
v_exp_f32 v238, v166
v_exp_f32 v239, v167
s_nop 0
v_cvt_pk_bf16_f32 v191, v238, v239
v_add_f32 v247, v238, v247
v_add_f32 v247, v239, v247
v_max3_f32 v236, v156, v157, v158
v_max3_f32 v236, v236, v159, v168
v_max3_f32 v236, v236, v169, v170
v_max_f32 v236, v236, v171
v_mov_b32 v237, v236
s_nop 1
v_permlane32_swap_b32 v236, v237
v_max_f32 v236, v236, v237
v_mov_b32 v237, v236
s_nop 1
v_permlane16_swap_b32 v236, v237
v_max_f32 v236, v236, v237
v_ceil_f32 v236, v236
v_max_f32 v236, 0, v236
v_exp_f32 v254, -v236
v_sub_f32 v228, v228, v236
v_sub_f32 v229, v229, v236
v_sub_f32 v230, v230, v236
v_sub_f32 v231, v231, v236
v_sub_f32 v156, v156, v236
v_sub_f32 v157, v157, v236
v_sub_f32 v158, v158, v236
v_sub_f32 v159, v159, v236
v_sub_f32 v168, v168, v236
v_sub_f32 v169, v169, v236
v_sub_f32 v170, v170, v236
v_sub_f32 v171, v171, v236
v_sub_f32 v132, v132, v236
v_sub_f32 v133, v133, v236
v_sub_f32 v134, v134, v236
v_sub_f32 v135, v135, v236
v_sub_f32 v144, v144, v236
v_sub_f32 v145, v145, v236
v_sub_f32 v146, v146, v236
v_sub_f32 v147, v147, v236
v_lshlrev_b32 v238, 16, v180
v_and_b32 v239, 0xffff0000, v180
v_mul_f32 v238, v238, v254
v_mul_f32 v239, v239, v254
v_cvt_pk_bf16_f32 v180, v238, v239
v_lshlrev_b32 v238, 16, v181
v_and_b32 v239, 0xffff0000, v181
v_mul_f32 v238, v238, v254
v_mul_f32 v239, v239, v254
v_cvt_pk_bf16_f32 v181, v238, v239
v_lshlrev_b32 v238, 16, v182
v_and_b32 v239, 0xffff0000, v182
v_mul_f32 v238, v238, v254
v_mul_f32 v239, v239, v254
v_cvt_pk_bf16_f32 v182, v238, v239
v_lshlrev_b32 v238, 16, v183
v_and_b32 v239, 0xffff0000, v183
v_mul_f32 v238, v238, v254
v_mul_f32 v239, v239, v254
v_cvt_pk_bf16_f32 v183, v238, v239
v_mov_b32 v248, 0
v_exp_f32 v238, v156
v_exp_f32 v239, v157
s_nop 0
v_cvt_pk_bf16_f32 v192, v238, v239
v_add_f32 v248, v238, v248
v_add_f32 v248, v239, v248
v_exp_f32 v238, v158
v_exp_f32 v239, v159
s_nop 0
v_cvt_pk_bf16_f32 v193, v238, v239
v_add_f32 v248, v238, v248
v_add_f32 v248, v239, v248
v_exp_f32 v238, v168
v_exp_f32 v239, v169
s_nop 0
v_cvt_pk_bf16_f32 v194, v238, v239
v_add_f32 v248, v238, v248
v_add_f32 v248, v239, v248
v_exp_f32 v238, v170
v_exp_f32 v239, v171
s_nop 0
v_cvt_pk_bf16_f32 v195, v238, v239
v_add_f32 v248, v238, v248
v_add_f32 v248, v239, v248
v_max3_f32 v236, v160, v161, v162
v_max3_f32 v236, v236, v163, v172
v_max3_f32 v236, v236, v173, v174
v_max_f32 v236, v236, v175
v_mov_b32 v237, v236
s_nop 1
v_permlane32_swap_b32 v236, v237
v_max_f32 v236, v236, v237
v_mov_b32 v237, v236
s_nop 1
v_permlane16_swap_b32 v236, v237
v_max_f32 v236, v236, v237
v_ceil_f32 v236, v236
v_max_f32 v236, 0, v236
v_exp_f32 v255, -v236
v_sub_f32 v232, v232, v236
v_sub_f32 v233, v233, v236
v_sub_f32 v234, v234, v236
v_sub_f32 v235, v235, v236
v_sub_f32 v160, v160, v236
v_sub_f32 v161, v161, v236
v_sub_f32 v162, v162, v236
v_sub_f32 v163, v163, v236
v_sub_f32 v172, v172, v236
v_sub_f32 v173, v173, v236
v_sub_f32 v174, v174, v236
v_sub_f32 v175, v175, v236
v_mov_b32 v249, 0
v_exp_f32 v238, v160
v_exp_f32 v239, v161
s_nop 0
v_cvt_pk_bf16_f32 v196, v238, v239
v_add_f32 v249, v238, v249
v_add_f32 v249, v239, v249
v_exp_f32 v238, v162
v_exp_f32 v239, v163
s_nop 0
v_cvt_pk_bf16_f32 v197, v238, v239
v_add_f32 v249, v238, v249
v_add_f32 v249, v239, v249
v_exp_f32 v238, v172
v_exp_f32 v239, v173
s_nop 0
v_cvt_pk_bf16_f32 v198, v238, v239
v_add_f32 v249, v238, v249
v_add_f32 v249, v239, v249
v_exp_f32 v238, v174
v_exp_f32 v239, v175
s_nop 0
v_cvt_pk_bf16_f32 v199, v238, v239
v_add_f32 v249, v238, v249
v_add_f32 v249, v239, v249
s_mov_b32 s56, 5
s_branch L_slow_tail
L_slow_6:
s_nop 15
v_max3_f32 v236, v128, v129, v130
v_max3_f32 v236, v236, v131, v140
v_max3_f32 v236, v236, v141, v142
v_max_f32 v236, v236, v143
v_mov_b32 v237, v236
s_nop 1
v_permlane32_swap_b32 v236, v237
v_max_f32 v236, v236, v237
v_mov_b32 v237, v236
s_nop 1
v_permlane16_swap_b32 v236, v237
v_max_f32 v236, v236, v237
v_ceil_f32 v236, v236
v_max_f32 v236, 0, v236
v_exp_f32 v253, -v236
v_sub_f32 v224, v224, v236
v_sub_f32 v225, v225, v236
v_sub_f32 v226, v226, v236
v_sub_f32 v227, v227, v236
v_sub_f32 v128, v128, v236
v_sub_f32 v129, v129, v236
v_sub_f32 v130, v130, v236
v_sub_f32 v131, v131, v236
v_sub_f32 v140, v140, v236
v_sub_f32 v141, v141, v236
v_sub_f32 v142, v142, v236
v_sub_f32 v143, v143, v236
v_sub_f32 v152, v152, v236
v_sub_f32 v153, v153, v236
v_sub_f32 v154, v154, v236
v_sub_f32 v155, v155, v236
v_sub_f32 v164, v164, v236
v_sub_f32 v165, v165, v236
v_sub_f32 v166, v166, v236
v_sub_f32 v167, v167, v236
v_lshlrev_b32 v238, 16, v176
v_and_b32 v239, 0xffff0000, v176
v_mul_f32 v238, v238, v253
v_mul_f32 v239, v239, v253
v_cvt_pk_bf16_f32 v176, v238, v239
v_lshlrev_b32 v238, 16, v177
v_and_b32 v239, 0xffff0000, v177
v_mul_f32 v238, v238, v253
v_mul_f32 v239, v239, v253
v_cvt_pk_bf16_f32 v177, v238, v239
v_lshlrev_b32 v238, 16, v178
v_and_b32 v239, 0xffff0000, v178
v_mul_f32 v238, v238, v253
v_mul_f32 v239, v239, v253
v_cvt_pk_bf16_f32 v178, v238, v239
v_lshlrev_b32 v238, 16, v179
v_and_b32 v239, 0xffff0000, v179
v_mul_f32 v238, v238, v253
v_mul_f32 v239, v239, v253
v_cvt_pk_bf16_f32 v179, v238, v239
v_lshlrev_b32 v238, 16, v188
v_and_b32 v239, 0xffff0000, v188
v_mul_f32 v238, v238, v253
v_mul_f32 v239, v239, v253
v_cvt_pk_bf16_f32 v188, v238, v239
v_lshlrev_b32 v238, 16, v189
v_and_b32 v239, 0xffff0000, v189
v_mul_f32 v238, v238, v253
v_mul_f32 v239, v239, v253
v_cvt_pk_bf16_f32 v189, v238, v239
v_lshlrev_b32 v238, 16, v190
v_and_b32 v239, 0xffff0000, v190
v_mul_f32 v238, v238, v253
v_mul_f32 v239, v239, v253
v_cvt_pk_bf16_f32 v190, v238, v239
v_lshlrev_b32 v238, 16, v191
v_and_b32 v239, 0xffff0000, v191
v_mul_f32 v238, v238, v253
v_mul_f32 v239, v239, v253
v_cvt_pk_bf16_f32 v191, v238, v239
v_mov_b32 v244, 0
v_exp_f32 v238, v128
v_exp_f32 v239, v129
s_nop 0
v_cvt_pk_bf16_f32 v200, v238, v239
v_add_f32 v244, v238, v244
v_add_f32 v244, v239, v244
v_exp_f32 v238, v130
v_exp_f32 v239, v131
s_nop 0
v_cvt_pk_bf16_f32 v201, v238, v239
v_add_f32 v244, v238, v244
v_add_f32 v244, v239, v244
v_exp_f32 v238, v140
v_exp_f32 v239, v141
s_nop 0
v_cvt_pk_bf16_f32 v202, v238, v239
v_add_f32 v244, v238, v244
v_add_f32 v244, v239, v244
v_exp_f32 v238, v142
v_exp_f32 v239, v143
s_nop 0
v_cvt_pk_bf16_f32 v203, v238, v239
v_add_f32 v244, v238, v244
v_add_f32 v244, v239, v244
v_max3_f32 v236, v132, v133, v134
v_max3_f32 v236, v236, v135, v144
v_max3_f32 v236, v236, v145, v146
v_max_f32 v236, v236, v147
v_mov_b32 v237, v236
s_nop 1
v_permlane32_swap_b32 v236, v237
v_max_f32 v236, v236, v237
v_mov_b32 v237, v236
s_nop 1
v_permlane16_swap_b32 v236, v237
v_max_f32 v236, v236, v237
v_ceil_f32 v236, v236
v_max_f32 v236, 0, v236
v_exp_f32 v254, -v236
v_sub_f32 v228, v228, v236
v_sub_f32 v229, v229, v236
v_sub_f32 v230, v230, v236
v_sub_f32 v231, v231, v236
v_sub_f32 v132, v132, v236
v_sub_f32 v133, v133, v236
v_sub_f32 v134, v134, v236
v_sub_f32 v135, v135, v236
v_sub_f32 v144, v144, v236
v_sub_f32 v145, v145, v236
v_sub_f32 v146, v146, v236
v_sub_f32 v147, v147, v236
v_sub_f32 v156, v156, v236
v_sub_f32 v157, v157, v236
v_sub_f32 v158, v158, v236
v_sub_f32 v159, v159, v236
v_sub_f32 v168, v168, v236
v_sub_f32 v169, v169, v236
v_sub_f32 v170, v170, v236
v_sub_f32 v171, v171, v236
v_lshlrev_b32 v238, 16, v180
v_and_b32 v239, 0xffff0000, v180
v_mul_f32 v238, v238, v254
v_mul_f32 v239, v239, v254
v_cvt_pk_bf16_f32 v180, v238, v239
v_lshlrev_b32 v238, 16, v181
v_and_b32 v239, 0xffff0000, v181
v_mul_f32 v238, v238, v254
v_mul_f32 v239, v239, v254
v_cvt_pk_bf16_f32 v181, v238, v239
v_lshlrev_b32 v238, 16, v182
v_and_b32 v239, 0xffff0000, v182
v_mul_f32 v238, v238, v254
v_mul_f32 v239, v239, v254
v_cvt_pk_bf16_f32 v182, v238, v239
v_lshlrev_b32 v238, 16, v183
v_and_b32 v239, 0xffff0000, v183
v_mul_f32 v238, v238, v254
v_mul_f32 v239, v239, v254
v_cvt_pk_bf16_f32 v183, v238, v239
v_lshlrev_b32 v238, 16, v192
v_and_b32 v239, 0xffff0000, v192
v_mul_f32 v238, v238, v254
v_mul_f32 v239, v239, v254
v_cvt_pk_bf16_f32 v192, v238, v239
v_lshlrev_b32 v238, 16, v193
v_and_b32 v239, 0xffff0000, v193
v_mul_f32 v238, v238, v254
v_mul_f32 v239, v239, v254
v_cvt_pk_bf16_f32 v193, v238, v239
v_lshlrev_b32 v238, 16, v194
v_and_b32 v239, 0xffff0000, v194
v_mul_f32 v238, v238, v254
v_mul_f32 v239, v239, v254
v_cvt_pk_bf16_f32 v194, v238, v239
v_lshlrev_b32 v238, 16, v195
v_and_b32 v239, 0xffff0000, v195
v_mul_f32 v238, v238, v254
v_mul_f32 v239, v239, v254
v_cvt_pk_bf16_f32 v195, v238, v239
v_mov_b32 v245, 0
v_exp_f32 v238, v132
v_exp_f32 v239, v133
s_nop 0
v_cvt_pk_bf16_f32 v204, v238, v239
v_add_f32 v245, v238, v245
v_add_f32 v245, v239, v245
v_exp_f32 v238, v134
v_exp_f32 v239, v135
s_nop 0
v_cvt_pk_bf16_f32 v205, v238, v239
v_add_f32 v245, v238, v245
v_add_f32 v245, v239, v245
v_exp_f32 v238, v144
v_exp_f32 v239, v145
s_nop 0
v_cvt_pk_bf16_f32 v206, v238, v239
v_add_f32 v245, v238, v245
v_add_f32 v245, v239, v245
v_exp_f32 v238, v146
v_exp_f32 v239, v147
s_nop 0
v_cvt_pk_bf16_f32 v207, v238, v239
v_add_f32 v245, v238, v245
v_add_f32 v245, v239, v245
v_mov_b32 v255, 1.0
s_mov_b32 s56, 6
s_branch L_slow_tail
L_slow_7:
s_nop 15
v_max3_f32 v236, v152, v153, v154
v_max3_f32 v236, v236, v155, v164
v_max3_f32 v236, v236, v165, v166
v_max_f32 v236, v236, v167
v_mov_b32 v237, v236
s_nop 1
v_permlane32_swap_b32 v236, v237
v_max_f32 v236, v236, v237
v_mov_b32 v237, v236
s_nop 1
v_permlane16_swap_b32 v236, v237
v_max_f32 v236, v236, v237
v_ceil_f32 v236, v236
v_max_f32 v236, 0, v236
v_exp_f32 v253, -v236
v_sub_f32 v224, v224, v236
v_sub_f32 v225, v225, v236
v_sub_f32 v226, v226, v236
v_sub_f32 v227, v227, v236
v_sub_f32 v152, v152, v236
v_sub_f32 v153, v153, v236
v_sub_f32 v154, v154, v236
v_sub_f32 v155, v155, v236
v_sub_f32 v164, v164, v236
v_sub_f32 v165, v165, v236
v_sub_f32 v166, v166, v236
v_sub_f32 v167, v167, v236
v_sub_f32 v128, v128, v236
v_sub_f32 v129, v129, v236
v_sub_f32 v130, v130, v236
v_sub_f32 v131, v131, v236
v_sub_f32 v140, v140, v236
v_sub_f32 v141, v141, v236
v_sub_f32 v142, v142, v236
v_sub_f32 v143, v143, v236
v_lshlrev_b32 v238, 16, v200
v_and_b32 v239, 0xffff0000, v200
v_mul_f32 v238, v238, v253
v_mul_f32 v239, v239, v253
v_cvt_pk_bf16_f32 v200, v238, v239
v_lshlrev_b32 v238, 16, v201
v_and_b32 v239, 0xffff0000, v201
v_mul_f32 v238, v238, v253
v_mul_f32 v239, v239, v253
v_cvt_pk_bf16_f32 v201, v238, v239
v_lshlrev_b32 v238, 16, v202
v_and_b32 v239, 0xffff0000, v202
v_mul_f32 v238, v238, v253
v_mul_f32 v239, v239, v253
v_cvt_pk_bf16_f32 v202, v238, v239
v_lshlrev_b32 v238, 16, v203
v_and_b32 v239, 0xffff0000, v203
v_mul_f32 v238, v238, v253
v_mul_f32 v239, v239, v253
v_cvt_pk_bf16_f32 v203, v238, v239
v_mov_b32 v247, 0
v_exp_f32 v238, v152
v_exp_f32 v239, v153
s_nop 0
v_cvt_pk_bf16_f32 v212, v238, v239
v_add_f32 v247, v238, v247
v_add_f32 v247, v239, v247
v_exp_f32 v238, v154
v_exp_f32 v239, v155
s_nop 0
v_cvt_pk_bf16_f32 v213, v238, v239
v_add_f32 v247, v238, v247
v_add_f32 v247, v239, v247
v_exp_f32 v238, v164
v_exp_f32 v239, v165
s_nop 0
v_cvt_pk_bf16_f32 v214, v238, v239
v_add_f32 v247, v238, v247
v_add_f32 v247, v239, v247
v_exp_f32 v238, v166
v_exp_f32 v239, v167
s_nop 0
v_cvt_pk_bf16_f32 v215, v238, v239
v_add_f32 v247, v238, v247
v_add_f32 v247, v239, v247
v_max3_f32 v236, v156, v157, v158
v_max3_f32 v236, v236, v159, v168
v_max3_f32 v236, v236, v169, v170
v_max_f32 v236, v236, v171
v_mov_b32 v237, v236
s_nop 1
v_permlane32_swap_b32 v236, v237
v_max_f32 v236, v236, v237
v_mov_b32 v237, v236
s_nop 1
v_permlane16_swap_b32 v236, v237
v_max_f32 v236, v236, v237
v_ceil_f32 v236, v236
v_max_f32 v236, 0, v236
v_exp_f32 v254, -v236
v_sub_f32 v228, v228, v236
v_sub_f32 v229, v229, v236
v_sub_f32 v230, v230, v236
v_sub_f32 v231, v231, v236
v_sub_f32 v156, v156, v236
v_sub_f32 v157, v157, v236
v_sub_f32 v158, v158, v236
v_sub_f32 v159, v159, v236
v_sub_f32 v168, v168, v236
v_sub_f32 v169, v169, v236
v_sub_f32 v170, v170, v236
v_sub_f32 v171, v171, v236
v_sub_f32 v132, v132, v236
v_sub_f32 v133, v133, v236
v_sub_f32 v134, v134, v236
v_sub_f32 v135, v135, v236
v_sub_f32 v144, v144, v236
v_sub_f32 v145, v145, v236
v_sub_f32 v146, v146, v236
v_sub_f32 v147, v147, v236
v_lshlrev_b32 v238, 16, v204
v_and_b32 v239, 0xffff0000, v204
v_mul_f32 v238, v238, v254
v_mul_f32 v239, v239, v254
v_cvt_pk_bf16_f32 v204, v238, v239
v_lshlrev_b32 v238, 16, v205
v_and_b32 v239, 0xffff0000, v205
v_mul_f32 v238, v238, v254
v_mul_f32 v239, v239, v254
v_cvt_pk_bf16_f32 v205, v238, v239
v_lshlrev_b32 v238, 16, v206
v_and_b32 v239, 0xffff0000, v206
v_mul_f32 v238, v238, v254
v_mul_f32 v239, v239, v254
v_cvt_pk_bf16_f32 v206, v238, v239
v_lshlrev_b32 v238, 16, v207
v_and_b32 v239, 0xffff0000, v207
v_mul_f32 v238, v238, v254
v_mul_f32 v239, v239, v254
v_cvt_pk_bf16_f32 v207, v238, v239
v_mov_b32 v248, 0
v_exp_f32 v238, v156
v_exp_f32 v239, v157
s_nop 0
v_cvt_pk_bf16_f32 v216, v238, v239
v_add_f32 v248, v238, v248
v_add_f32 v248, v239, v248
v_exp_f32 v238, v158
v_exp_f32 v239, v159
s_nop 0
v_cvt_pk_bf16_f32 v217, v238, v239
v_add_f32 v248, v238, v248
v_add_f32 v248, v239, v248
v_exp_f32 v238, v168
v_exp_f32 v239, v169
s_nop 0
v_cvt_pk_bf16_f32 v218, v238, v239
v_add_f32 v248, v238, v248
v_add_f32 v248, v239, v248
v_exp_f32 v238, v170
v_exp_f32 v239, v171
s_nop 0
v_cvt_pk_bf16_f32 v219, v238, v239
v_add_f32 v248, v238, v248
v_add_f32 v248, v239, v248
v_max3_f32 v236, v160, v161, v162
v_max3_f32 v236, v236, v163, v172
v_max3_f32 v236, v236, v173, v174
v_max_f32 v236, v236, v175
v_mov_b32 v237, v236
s_nop 1
v_permlane32_swap_b32 v236, v237
v_max_f32 v236, v236, v237
v_mov_b32 v237, v236
s_nop 1
v_permlane16_swap_b32 v236, v237
v_max_f32 v236, v236, v237
v_ceil_f32 v236, v236
v_max_f32 v236, 0, v236
v_exp_f32 v255, -v236
v_sub_f32 v232, v232, v236
v_sub_f32 v233, v233, v236
v_sub_f32 v234, v234, v236
v_sub_f32 v235, v235, v236
v_sub_f32 v160, v160, v236
v_sub_f32 v161, v161, v236
v_sub_f32 v162, v162, v236
v_sub_f32 v163, v163, v236
v_sub_f32 v172, v172, v236
v_sub_f32 v173, v173, v236
v_sub_f32 v174, v174, v236
v_sub_f32 v175, v175, v236
v_mov_b32 v249, 0
v_exp_f32 v238, v160
v_exp_f32 v239, v161
s_nop 0
v_cvt_pk_bf16_f32 v220, v238, v239
v_add_f32 v249, v238, v249
v_add_f32 v249, v239, v249
v_exp_f32 v238, v162
v_exp_f32 v239, v163
s_nop 0
v_cvt_pk_bf16_f32 v221, v238, v239
v_add_f32 v249, v238, v249
v_add_f32 v249, v239, v249
v_exp_f32 v238, v172
v_exp_f32 v239, v173
s_nop 0
v_cvt_pk_bf16_f32 v222, v238, v239
v_add_f32 v249, v238, v249
v_add_f32 v249, v239, v249
v_exp_f32 v238, v174
v_exp_f32 v239, v175
s_nop 0
v_cvt_pk_bf16_f32 v223, v238, v239
v_add_f32 v249, v238, v249
v_add_f32 v249, v239, v249
s_mov_b32 s56, 7
s_branch L_slow_tail
L_slow_8:
s_nop 15
v_max3_f32 v236, v128, v129, v130
v_max3_f32 v236, v236, v131, v140
v_max3_f32 v236, v236, v141, v142
v_max_f32 v236, v236, v143
v_mov_b32 v237, v236
s_nop 1
v_permlane32_swap_b32 v236, v237
v_max_f32 v236, v236, v237
v_mov_b32 v237, v236
s_nop 1
v_permlane16_swap_b32 v236, v237
v_max_f32 v236, v236, v237
v_ceil_f32 v236, v236
v_max_f32 v236, 0, v236
v_exp_f32 v253, -v236
v_sub_f32 v224, v224, v236
v_sub_f32 v225, v225, v236
v_sub_f32 v226, v226, v236
v_sub_f32 v227, v227, v236
v_sub_f32 v128, v128, v236
v_sub_f32 v129, v129, v236
v_sub_f32 v130, v130, v236
v_sub_f32 v131, v131, v236
v_sub_f32 v140, v140, v236
v_sub_f32 v141, v141, v236
v_sub_f32 v142, v142, v236
v_sub_f32 v143, v143, v236
v_sub_f32 v152, v152, v236
v_sub_f32 v153, v153, v236
v_sub_f32 v154, v154, v236
v_sub_f32 v155, v155, v236
v_sub_f32 v164, v164, v236
v_sub_f32 v165, v165, v236
v_sub_f32 v166, v166, v236
v_sub_f32 v167, v167, v236
v_lshlrev_b32 v238, 16, v200
v_and_b32 v239, 0xffff0000, v200
v_mul_f32 v238, v238, v253
v_mul_f32 v239, v239, v253
v_cvt_pk_bf16_f32 v200, v238, v239
v_lshlrev_b32 v238, 16, v201
v_and_b32 v239, 0xffff0000, v201
v_mul_f32 v238, v238, v253
v_mul_f32 v239, v239, v253
v_cvt_pk_bf16_f32 v201, v238, v239
v_lshlrev_b32 v238, 16, v202
v_and_b32 v239, 0xffff0000, v202
v_mul_f32 v238, v238, v253
v_mul_f32 v239, v239, v253
v_cvt_pk_bf16_f32 v202, v238, v239
v_lshlrev_b32 v238, 16, v203
v_and_b32 v239, 0xffff0000, v203
v_mul_f32 v238, v238, v253
v_mul_f32 v239, v239, v253
v_cvt_pk_bf16_f32 v203, v238, v239
v_lshlrev_b32 v238, 16, v212
v_and_b32 v239, 0xffff0000, v212
v_mul_f32 v238, v238, v253
v_mul_f32 v239, v239, v253
v_cvt_pk_bf16_f32 v212, v238, v239
v_lshlrev_b32 v238, 16, v213
v_and_b32 v239, 0xffff0000, v213
v_mul_f32 v238, v238, v253
v_mul_f32 v239, v239, v253
v_cvt_pk_bf16_f32 v213, v238, v239
v_lshlrev_b32 v238, 16, v214
v_and_b32 v239, 0xffff0000, v214
v_mul_f32 v238, v238, v253
v_mul_f32 v239, v239, v253
v_cvt_pk_bf16_f32 v214, v238, v239
v_lshlrev_b32 v238, 16, v215
v_and_b32 v239, 0xffff0000, v215
v_mul_f32 v238, v238, v253
v_mul_f32 v239, v239, v253
v_cvt_pk_bf16_f32 v215, v238, v239
v_mov_b32 v244, 0
v_exp_f32 v238, v128
v_exp_f32 v239, v129
s_nop 0
v_cvt_pk_bf16_f32 v176, v238, v239
v_add_f32 v244, v238, v244
v_add_f32 v244, v239, v244
v_exp_f32 v238, v130
v_exp_f32 v239, v131
s_nop 0
v_cvt_pk_bf16_f32 v177, v238, v239
v_add_f32 v244, v238, v244
v_add_f32 v244, v239, v244
v_exp_f32 v238, v140
v_exp_f32 v239, v141
s_nop 0
v_cvt_pk_bf16_f32 v178, v238, v239
v_add_f32 v244, v238, v244
v_add_f32 v244, v239, v244
v_exp_f32 v238, v142
v_exp_f32 v239, v143
s_nop 0
v_cvt_pk_bf16_f32 v179, v238, v239
v_add_f32 v244, v238, v244
v_add_f32 v244, v239, v244
v_max3_f32 v236, v132, v133, v134
v_max3_f32 v236, v236, v135, v144
v_max3_f32 v236, v236, v145, v146
v_max_f32 v236, v236, v147
v_mov_b32 v237, v236
s_nop 1
v_permlane32_swap_b32 v236, v237
v_max_f32 v236, v236, v237
v_mov_b32 v237, v236
s_nop 1
v_permlane16_swap_b32 v236, v237
v_max_f32 v236, v236, v237
v_ceil_f32 v236, v236
v_max_f32 v236, 0, v236
v_exp_f32 v254, -v236
v_sub_f32 v228, v228, v236
v_sub_f32 v229, v229, v236
v_sub_f32 v230, v230, v236
v_sub_f32 v231, v231, v236
v_sub_f32 v132, v132, v236
v_sub_f32 v133, v133, v236
v_sub_f32 v134, v134, v236
v_sub_f32 v135, v135, v236
v_sub_f32 v144, v144, v236
v_sub_f32 v145, v145, v236
v_sub_f32 v146, v146, v236
v_sub_f32 v147, v147, v236
v_sub_f32 v156, v156, v236
v_sub_f32 v157, v157, v236
v_sub_f32 v158, v158, v236
v_sub_f32 v159, v159, v236
v_sub_f32 v168, v168, v236
v_sub_f32 v169, v169, v236
v_sub_f32 v170, v170, v236
v_sub_f32 v171, v171, v236
v_lshlrev_b32 v238, 16, v204
v_and_b32 v239, 0xffff0000, v204
v_mul_f32 v238, v238, v254
v_mul_f32 v239, v239, v254
v_cvt_pk_bf16_f32 v204, v238, v239
v_lshlrev_b32 v238, 16, v205
v_and_b32 v239, 0xffff0000, v205
v_mul_f32 v238, v238, v254
v_mul_f32 v239, v239, v254
v_cvt_pk_bf16_f32 v205, v238, v239
v_lshlrev_b32 v238, 16, v206
v_and_b32 v239, 0xffff0000, v206
v_mul_f32 v238, v238, v254
v_mul_f32 v239, v239, v254
v_cvt_pk_bf16_f32 v206, v238, v239
v_lshlrev_b32 v238, 16, v207
v_and_b32 v239, 0xffff0000, v207
v_mul_f32 v238, v238, v254
v_mul_f32 v239, v239, v254
v_cvt_pk_bf16_f32 v207, v238, v239
v_lshlrev_b32 v238, 16, v216
v_and_b32 v239, 0xffff0000, v216
v_mul_f32 v238, v238, v254
v_mul_f32 v239, v239, v254
v_cvt_pk_bf16_f32 v216, v238, v239
v_lshlrev_b32 v238, 16, v217
v_and_b32 v239, 0xffff0000, v217
v_mul_f32 v238, v238, v254
v_mul_f32 v239, v239, v254
v_cvt_pk_bf16_f32 v217, v238, v239
v_lshlrev_b32 v238, 16, v218
v_and_b32 v239, 0xffff0000, v218
v_mul_f32 v238, v238, v254
v_mul_f32 v239, v239, v254
v_cvt_pk_bf16_f32 v218, v238, v239
v_lshlrev_b32 v238, 16, v219
v_and_b32 v239, 0xffff0000, v219
v_mul_f32 v238, v238, v254
v_mul_f32 v239, v239, v254
v_cvt_pk_bf16_f32 v219, v238, v239
v_mov_b32 v245, 0
v_exp_f32 v238, v132
v_exp_f32 v239, v133
s_nop 0
v_cvt_pk_bf16_f32 v180, v238, v239
v_add_f32 v245, v238, v245
v_add_f32 v245, v239, v245
v_exp_f32 v238, v134
v_exp_f32 v239, v135
s_nop 0
v_cvt_pk_bf16_f32 v181, v238, v239
v_add_f32 v245, v238, v245
v_add_f32 v245, v239, v245
v_exp_f32 v238, v144
v_exp_f32 v239, v145
s_nop 0
v_cvt_pk_bf16_f32 v182, v238, v239
v_add_f32 v245, v238, v245
v_add_f32 v245, v239, v245
v_exp_f32 v238, v146
v_exp_f32 v239, v147
s_nop 0
v_cvt_pk_bf16_f32 v183, v238, v239
v_add_f32 v245, v238, v245
v_add_f32 v245, v239, v245
v_mov_b32 v255, 1.0
s_mov_b32 s56, 8
s_branch L_slow_tail
L_slow_27:
s_nop 15
v_max3_f32 v236, v152, v153, v154
v_max3_f32 v236, v236, v155, v164
v_max3_f32 v236, v236, v165, v166
v_max_f32 v236, v236, v167
v_mov_b32 v237, v236
s_nop 1
v_permlane32_swap_b32 v236, v237
v_max_f32 v236, v236, v237
v_mov_b32 v237, v236
s_nop 1
v_permlane16_swap_b32 v236, v237
v_max_f32 v236, v236, v237
v_ceil_f32 v236, v236
v_max_f32 v236, 0, v236
v_exp_f32 v253, -v236
v_sub_f32 v224, v224, v236
v_sub_f32 v225, v225, v236
v_sub_f32 v226, v226, v236
v_sub_f32 v227, v227, v236
v_sub_f32 v152, v152, v236
v_sub_f32 v153, v153, v236
v_sub_f32 v154, v154, v236
v_sub_f32 v155, v155, v236
v_sub_f32 v164, v164, v236
v_sub_f32 v165, v165, v236
v_sub_f32 v166, v166, v236
v_sub_f32 v167, v167, v236
v_sub_f32 v128, v128, v236
v_sub_f32 v129, v129, v236
v_sub_f32 v130, v130, v236
v_sub_f32 v131, v131, v236
v_sub_f32 v140, v140, v236
v_sub_f32 v141, v141, v236
v_sub_f32 v142, v142, v236
v_sub_f32 v143, v143, v236
v_lshlrev_b32 v238, 16, v200
v_and_b32 v239, 0xffff0000, v200
v_mul_f32 v238, v238, v253
v_mul_f32 v239, v239, v253
v_cvt_pk_bf16_f32 v200, v238, v239
v_lshlrev_b32 v238, 16, v201
v_and_b32 v239, 0xffff0000, v201
v_mul_f32 v238, v238, v253
v_mul_f32 v239, v239, v253
v_cvt_pk_bf16_f32 v201, v238, v239
v_lshlrev_b32 v238, 16, v202
v_and_b32 v239, 0xffff0000, v202
v_mul_f32 v238, v238, v253
v_mul_f32 v239, v239, v253
v_cvt_pk_bf16_f32 v202, v238, v239
v_lshlrev_b32 v238, 16, v203
v_and_b32 v239, 0xffff0000, v203
v_mul_f32 v238, v238, v253
v_mul_f32 v239, v239, v253
v_cvt_pk_bf16_f32 v203, v238, v239
v_mov_b32 v247, 0
v_exp_f32 v238, v152
v_exp_f32 v239, v153
s_nop 0
v_cvt_pk_bf16_f32 v212, v238, v239
v_add_f32 v247, v238, v247
v_add_f32 v247, v239, v247
v_exp_f32 v238, v154
v_exp_f32 v239, v155
s_nop 0
v_cvt_pk_bf16_f32 v213, v238, v239
v_add_f32 v247, v238, v247
v_add_f32 v247, v239, v247
v_exp_f32 v238, v164
v_exp_f32 v239, v165
s_nop 0
v_cvt_pk_bf16_f32 v214, v238, v239
v_add_f32 v247, v238, v247
v_add_f32 v247, v239, v247
v_exp_f32 v238, v166
v_exp_f32 v239, v167
s_nop 0
v_cvt_pk_bf16_f32 v215, v238, v239
v_add_f32 v247, v238, v247
v_add_f32 v247, v239, v247
v_max3_f32 v236, v156, v157, v158
v_max3_f32 v236, v236, v159, v168
v_max3_f32 v236, v236, v169, v170
v_max_f32 v236, v236, v171
v_mov_b32 v237, v236
s_nop 1
v_permlane32_swap_b32 v236, v237
v_max_f32 v236, v236, v237
v_mov_b32 v237, v236
s_nop 1
v_permlane16_swap_b32 v236, v237
v_max_f32 v236, v236, v237
v_ceil_f32 v236, v236
v_max_f32 v236, 0, v236
v_exp_f32 v254, -v236
v_sub_f32 v228, v228, v236
v_sub_f32 v229, v229, v236
v_sub_f32 v230, v230, v236
v_sub_f32 v231, v231, v236
v_sub_f32 v156, v156, v236
v_sub_f32 v157, v157, v236
v_sub_f32 v158, v158, v236
v_sub_f32 v159, v159, v236
v_sub_f32 v168, v168, v236
v_sub_f32 v169, v169, v236
v_sub_f32 v170, v170, v236
v_sub_f32 v171, v171, v236
v_sub_f32 v132, v132, v236
v_sub_f32 v133, v133, v236
v_sub_f32 v134, v134, v236
v_sub_f32 v135, v135, v236
v_sub_f32 v144, v144, v236
v_sub_f32 v145, v145, v236
v_sub_f32 v146, v146, v236
v_sub_f32 v147, v147, v236
v_lshlrev_b32 v238, 16, v204
v_and_b32 v239, 0xffff0000, v204
v_mul_f32 v238, v238, v254
v_mul_f32 v239, v239, v254
v_cvt_pk_bf16_f32 v204, v238, v239
v_lshlrev_b32 v238, 16, v205
v_and_b32 v239, 0xffff0000, v205
v_mul_f32 v238, v238, v254
v_mul_f32 v239, v239, v254
v_cvt_pk_bf16_f32 v205, v238, v239
v_lshlrev_b32 v238, 16, v206
v_and_b32 v239, 0xffff0000, v206
v_mul_f32 v238, v238, v254
v_mul_f32 v239, v239, v254
v_cvt_pk_bf16_f32 v206, v238, v239
v_lshlrev_b32 v238, 16, v207
v_and_b32 v239, 0xffff0000, v207
v_mul_f32 v238, v238, v254
v_mul_f32 v239, v239, v254
v_cvt_pk_bf16_f32 v207, v238, v239
v_mov_b32 v248, 0
v_exp_f32 v238, v156
v_exp_f32 v239, v157
s_nop 0
v_cvt_pk_bf16_f32 v216, v238, v239
v_add_f32 v248, v238, v248
v_add_f32 v248, v239, v248
v_exp_f32 v238, v158
v_exp_f32 v239, v159
s_nop 0
v_cvt_pk_bf16_f32 v217, v238, v239
v_add_f32 v248, v238, v248
v_add_f32 v248, v239, v248
v_exp_f32 v238, v168
v_exp_f32 v239, v169
s_nop 0
v_cvt_pk_bf16_f32 v218, v238, v239
v_add_f32 v248, v238, v248
v_add_f32 v248, v239, v248
v_exp_f32 v238, v170
v_exp_f32 v239, v171
s_nop 0
v_cvt_pk_bf16_f32 v219, v238, v239
v_add_f32 v248, v238, v248
v_add_f32 v248, v239, v248
v_max3_f32 v236, v160, v161, v162
v_max3_f32 v236, v236, v163, v172
v_max3_f32 v236, v236, v173, v174
v_max_f32 v236, v236, v175
v_mov_b32 v237, v236
s_nop 1
v_permlane32_swap_b32 v236, v237
v_max_f32 v236, v236, v237
v_mov_b32 v237, v236
s_nop 1
v_permlane16_swap_b32 v236, v237
v_max_f32 v236, v236, v237
v_ceil_f32 v236, v236
v_max_f32 v236, 0, v236
v_exp_f32 v255, -v236
v_sub_f32 v232, v232, v236
v_sub_f32 v233, v233, v236
v_sub_f32 v234, v234, v236
v_sub_f32 v235, v235, v236
v_sub_f32 v160, v160, v236
v_sub_f32 v161, v161, v236
v_sub_f32 v162, v162, v236
v_sub_f32 v163, v163, v236
v_sub_f32 v172, v172, v236
v_sub_f32 v173, v173, v236
v_sub_f32 v174, v174, v236
v_sub_f32 v175, v175, v236
v_mov_b32 v249, 0
v_exp_f32 v238, v160
v_exp_f32 v239, v161
s_nop 0
v_cvt_pk_bf16_f32 v220, v238, v239
v_add_f32 v249, v238, v249
v_add_f32 v249, v239, v249
v_exp_f32 v238, v162
v_exp_f32 v239, v163
s_nop 0
v_cvt_pk_bf16_f32 v221, v238, v239
v_add_f32 v249, v238, v249
v_add_f32 v249, v239, v249
v_exp_f32 v238, v172
v_exp_f32 v239, v173
s_nop 0
v_cvt_pk_bf16_f32 v222, v238, v239
v_add_f32 v249, v238, v249
v_add_f32 v249, v239, v249
v_exp_f32 v238, v174
v_exp_f32 v239, v175
s_nop 0
v_cvt_pk_bf16_f32 v223, v238, v239
v_add_f32 v249, v238, v249
v_add_f32 v249, v239, v249
s_mov_b32 s56, 9
s_branch L_slow_tail
L_slow_28:
s_nop 15
v_max3_f32 v236, v128, v129, v130
v_max3_f32 v236, v236, v131, v140
v_max3_f32 v236, v236, v141, v142
v_max_f32 v236, v236, v143
v_mov_b32 v237, v236
s_nop 1
v_permlane32_swap_b32 v236, v237
v_max_f32 v236, v236, v237
v_mov_b32 v237, v236
s_nop 1
v_permlane16_swap_b32 v236, v237
v_max_f32 v236, v236, v237
v_ceil_f32 v236, v236
v_max_f32 v236, 0, v236
v_exp_f32 v253, -v236
v_sub_f32 v224, v224, v236
v_sub_f32 v225, v225, v236
v_sub_f32 v226, v226, v236
v_sub_f32 v227, v227, v236
v_sub_f32 v128, v128, v236
v_sub_f32 v129, v129, v236
v_sub_f32 v130, v130, v236
v_sub_f32 v131, v131, v236
v_sub_f32 v140, v140, v236
v_sub_f32 v141, v141, v236
v_sub_f32 v142, v142, v236
v_sub_f32 v143, v143, v236
v_sub_f32 v152, v152, v236
v_sub_f32 v153, v153, v236
v_sub_f32 v154, v154, v236
v_sub_f32 v155, v155, v236
v_sub_f32 v164, v164, v236
v_sub_f32 v165, v165, v236
v_sub_f32 v166, v166, v236
v_sub_f32 v167, v167, v236
v_lshlrev_b32 v238, 16, v212
v_and_b32 v239, 0xffff0000, v212
v_mul_f32 v238, v238, v253
v_mul_f32 v239, v239, v253
v_cvt_pk_bf16_f32 v212, v238, v239
v_lshlrev_b32 v238, 16, v213
v_and_b32 v239, 0xffff0000, v213
v_mul_f32 v238, v238, v253
v_mul_f32 v239, v239, v253
v_cvt_pk_bf16_f32 v213, v238, v239
v_lshlrev_b32 v238, 16, v214
v_and_b32 v239, 0xffff0000, v214
v_mul_f32 v238, v238, v253
v_mul_f32 v239, v239, v253
v_cvt_pk_bf16_f32 v214, v238, v239
v_lshlrev_b32 v238, 16, v215
v_and_b32 v239, 0xffff0000, v215
v_mul_f32 v238, v238, v253
v_mul_f32 v239, v239, v253
v_cvt_pk_bf16_f32 v215, v238, v239
v_mov_b32 v244, 0
v_exp_f32 v238, v128
v_exp_f32 v239, v129
s_nop 0
v_cvt_pk_bf16_f32 v176, v238, v239
v_add_f32 v244, v238, v244
v_add_f32 v244, v239, v244
v_exp_f32 v238, v130
v_exp_f32 v239, v131
s_nop 0
v_cvt_pk_bf16_f32 v177, v238, v239
v_add_f32 v244, v238, v244
v_add_f32 v244, v239, v244
v_exp_f32 v238, v140
v_exp_f32 v239, v141
s_nop 0
v_cvt_pk_bf16_f32 v178, v238, v239
v_add_f32 v244, v238, v244
v_add_f32 v244, v239, v244
v_exp_f32 v238, v142
v_exp_f32 v239, v143
s_nop 0
v_cvt_pk_bf16_f32 v179, v238, v239
v_add_f32 v244, v238, v244
v_add_f32 v244, v239, v244
v_max3_f32 v236, v132, v133, v134
v_max3_f32 v236, v236, v135, v144
v_max3_f32 v236, v236, v145, v146
v_max_f32 v236, v236, v147
v_mov_b32 v237, v236
s_nop 1
v_permlane32_swap_b32 v236, v237
v_max_f32 v236, v236, v237
v_mov_b32 v237, v236
s_nop 1
v_permlane16_swap_b32 v236, v237
v_max_f32 v236, v236, v237
v_ceil_f32 v236, v236
v_max_f32 v236, 0, v236
v_exp_f32 v254, -v236
v_sub_f32 v228, v228, v236
v_sub_f32 v229, v229, v236
v_sub_f32 v230, v230, v236
v_sub_f32 v231, v231, v236
v_sub_f32 v132, v132, v236
v_sub_f32 v133, v133, v236
v_sub_f32 v134, v134, v236
v_sub_f32 v135, v135, v236
v_sub_f32 v144, v144, v236
v_sub_f32 v145, v145, v236
v_sub_f32 v146, v146, v236
v_sub_f32 v147, v147, v236
v_sub_f32 v156, v156, v236
v_sub_f32 v157, v157, v236
v_sub_f32 v158, v158, v236
v_sub_f32 v159, v159, v236
v_sub_f32 v168, v168, v236
v_sub_f32 v169, v169, v236
v_sub_f32 v170, v170, v236
v_sub_f32 v171, v171, v236
v_lshlrev_b32 v238, 16, v216
v_and_b32 v239, 0xffff0000, v216
v_mul_f32 v238, v238, v254
v_mul_f32 v239, v239, v254
v_cvt_pk_bf16_f32 v216, v238, v239
v_lshlrev_b32 v238, 16, v217
v_and_b32 v239, 0xffff0000, v217
v_mul_f32 v238, v238, v254
v_mul_f32 v239, v239, v254
v_cvt_pk_bf16_f32 v217, v238, v239
v_lshlrev_b32 v238, 16, v218
v_and_b32 v239, 0xffff0000, v218
v_mul_f32 v238, v238, v254
v_mul_f32 v239, v239, v254
v_cvt_pk_bf16_f32 v218, v238, v239
v_lshlrev_b32 v238, 16, v219
v_and_b32 v239, 0xffff0000, v219
v_mul_f32 v238, v238, v254
v_mul_f32 v239, v239, v254
v_cvt_pk_bf16_f32 v219, v238, v239
v_mov_b32 v245, 0
v_exp_f32 v238, v132
v_exp_f32 v239, v133
s_nop 0
v_cvt_pk_bf16_f32 v180, v238, v239
v_add_f32 v245, v238, v245
v_add_f32 v245, v239, v245
v_exp_f32 v238, v134
v_exp_f32 v239, v135
s_nop 0
v_cvt_pk_bf16_f32 v181, v238, v239
v_add_f32 v245, v238, v245
v_add_f32 v245, v239, v245
v_exp_f32 v238, v144
v_exp_f32 v239, v145
s_nop 0
v_cvt_pk_bf16_f32 v182, v238, v239
v_add_f32 v245, v238, v245
v_add_f32 v245, v239, v245
v_exp_f32 v238, v146
v_exp_f32 v239, v147
s_nop 0
v_cvt_pk_bf16_f32 v183, v238, v239
v_add_f32 v245, v238, v245
v_add_f32 v245, v239, v245
v_mov_b32 v255, 1.0
s_mov_b32 s56, 10
s_branch L_slow_tail
L_slow_29:
s_nop 15
v_max3_f32 v236, v152, v153, v154
v_max3_f32 v236, v236, v155, v164
v_max3_f32 v236, v236, v165, v166
v_max_f32 v236, v236, v167
v_mov_b32 v237, v236
s_nop 1
v_permlane32_swap_b32 v236, v237
v_max_f32 v236, v236, v237
v_mov_b32 v237, v236
s_nop 1
v_permlane16_swap_b32 v236, v237
v_max_f32 v236, v236, v237
v_ceil_f32 v236, v236
v_max_f32 v236, 0, v236
v_exp_f32 v253, -v236
v_sub_f32 v224, v224, v236
v_sub_f32 v225, v225, v236
v_sub_f32 v226, v226, v236
v_sub_f32 v227, v227, v236
v_sub_f32 v152, v152, v236
v_sub_f32 v153, v153, v236
v_sub_f32 v154, v154, v236
v_sub_f32 v155, v155, v236
v_sub_f32 v164, v164, v236
v_sub_f32 v165, v165, v236
v_sub_f32 v166, v166, v236
v_sub_f32 v167, v167, v236
v_sub_f32 v128, v128, v236
v_sub_f32 v129, v129, v236
v_sub_f32 v130, v130, v236
v_sub_f32 v131, v131, v236
v_sub_f32 v140, v140, v236
v_sub_f32 v141, v141, v236
v_sub_f32 v142, v142, v236
v_sub_f32 v143, v143, v236
v_lshlrev_b32 v238, 16, v176
v_and_b32 v239, 0xffff0000, v176
v_mul_f32 v238, v238, v253
v_mul_f32 v239, v239, v253
v_cvt_pk_bf16_f32 v176, v238, v239
v_lshlrev_b32 v238, 16, v177
v_and_b32 v239, 0xffff0000, v177
v_mul_f32 v238, v238, v253
v_mul_f32 v239, v239, v253
v_cvt_pk_bf16_f32 v177, v238, v239
v_lshlrev_b32 v238, 16, v178
v_and_b32 v239, 0xffff0000, v178
v_mul_f32 v238, v238, v253
v_mul_f32 v239, v239, v253
v_cvt_pk_bf16_f32 v178, v238, v239
v_lshlrev_b32 v238, 16, v179
v_and_b32 v239, 0xffff0000, v179
v_mul_f32 v238, v238, v253
v_mul_f32 v239, v239, v253
v_cvt_pk_bf16_f32 v179, v238, v239
v_mov_b32 v247, 0
v_exp_f32 v238, v152
v_exp_f32 v239, v153
s_nop 0
v_cvt_pk_bf16_f32 v188, v238, v239
v_add_f32 v247, v238, v247
v_add_f32 v247, v239, v247
v_exp_f32 v238, v154
v_exp_f32 v239, v155
s_nop 0
v_cvt_pk_bf16_f32 v189, v238, v239
v_add_f32 v247, v238, v247
v_add_f32 v247, v239, v247
v_exp_f32 v238, v164
v_exp_f32 v239, v165
s_nop 0
v_cvt_pk_bf16_f32 v190, v238, v239
v_add_f32 v247, v238, v247
v_add_f32 v247, v239, v247
v_exp_f32 v238, v166
v_exp_f32 v239, v167
s_nop 0
v_cvt_pk_bf16_f32 v191, v238, v239
v_add_f32 v247, v238, v247
v_add_f32 v247, v239, v247
v_max3_f32 v236, v156, v157, v158
v_max3_f32 v236, v236, v159, v168
v_max3_f32 v236, v236, v169, v170
v_max_f32 v236, v236, v171
v_mov_b32 v237, v236
s_nop 1
v_permlane32_swap_b32 v236, v237
v_max_f32 v236, v236, v237
v_mov_b32 v237, v236
s_nop 1
v_permlane16_swap_b32 v236, v237
v_max_f32 v236, v236, v237
v_ceil_f32 v236, v236
v_max_f32 v236, 0, v236
v_exp_f32 v254, -v236
v_sub_f32 v228, v228, v236
v_sub_f32 v229, v229, v236
v_sub_f32 v230, v230, v236
v_sub_f32 v231, v231, v236
v_sub_f32 v156, v156, v236
v_sub_f32 v157, v157, v236
v_sub_f32 v158, v158, v236
v_sub_f32 v159, v159, v236
v_sub_f32 v168, v168, v236
v_sub_f32 v169, v169, v236
v_sub_f32 v170, v170, v236
v_sub_f32 v171, v171, v236
v_sub_f32 v132, v132, v236
v_sub_f32 v133, v133, v236
v_sub_f32 v134, v134, v236
v_sub_f32 v135, v135, v236
v_sub_f32 v144, v144, v236
v_sub_f32 v145, v145, v236
v_sub_f32 v146, v146, v236
v_sub_f32 v147, v147, v236
v_lshlrev_b32 v238, 16, v180
v_and_b32 v239, 0xffff0000, v180
v_mul_f32 v238, v238, v254
v_mul_f32 v239, v239, v254
v_cvt_pk_bf16_f32 v180, v238, v239
v_lshlrev_b32 v238, 16, v181
v_and_b32 v239, 0xffff0000, v181
v_mul_f32 v238, v238, v254
v_mul_f32 v239, v239, v254
v_cvt_pk_bf16_f32 v181, v238, v239
v_lshlrev_b32 v238, 16, v182
v_and_b32 v239, 0xffff0000, v182
v_mul_f32 v238, v238, v254
v_mul_f32 v239, v239, v254
v_cvt_pk_bf16_f32 v182, v238, v239
v_lshlrev_b32 v238, 16, v183
v_and_b32 v239, 0xffff0000, v183
v_mul_f32 v238, v238, v254
v_mul_f32 v239, v239, v254
v_cvt_pk_bf16_f32 v183, v238, v239
v_mov_b32 v248, 0
v_exp_f32 v238, v156
v_exp_f32 v239, v157
s_nop 0
v_cvt_pk_bf16_f32 v192, v238, v239
v_add_f32 v248, v238, v248
v_add_f32 v248, v239, v248
v_exp_f32 v238, v158
v_exp_f32 v239, v159
s_nop 0
v_cvt_pk_bf16_f32 v193, v238, v239
v_add_f32 v248, v238, v248
v_add_f32 v248, v239, v248
v_exp_f32 v238, v168
v_exp_f32 v239, v169
s_nop 0
v_cvt_pk_bf16_f32 v194, v238, v239
v_add_f32 v248, v238, v248
v_add_f32 v248, v239, v248
v_exp_f32 v238, v170
v_exp_f32 v239, v171
s_nop 0
v_cvt_pk_bf16_f32 v195, v238, v239
v_add_f32 v248, v238, v248
v_add_f32 v248, v239, v248
v_max3_f32 v236, v160, v161, v162
v_max3_f32 v236, v236, v163, v172
v_max3_f32 v236, v236, v173, v174
v_max_f32 v236, v236, v175
v_mov_b32 v237, v236
s_nop 1
v_permlane32_swap_b32 v236, v237
v_max_f32 v236, v236, v237
v_mov_b32 v237, v236
s_nop 1
v_permlane16_swap_b32 v236, v237
v_max_f32 v236, v236, v237
v_ceil_f32 v236, v236
v_max_f32 v236, 0, v236
v_exp_f32 v255, -v236
v_sub_f32 v232, v232, v236
v_sub_f32 v233, v233, v236
v_sub_f32 v234, v234, v236
v_sub_f32 v235, v235, v236
v_sub_f32 v160, v160, v236
v_sub_f32 v161, v161, v236
v_sub_f32 v162, v162, v236
v_sub_f32 v163, v163, v236
v_sub_f32 v172, v172, v236
v_sub_f32 v173, v173, v236
v_sub_f32 v174, v174, v236
v_sub_f32 v175, v175, v236
v_mov_b32 v249, 0
v_exp_f32 v238, v160
v_exp_f32 v239, v161
s_nop 0
v_cvt_pk_bf16_f32 v196, v238, v239
v_add_f32 v249, v238, v249
v_add_f32 v249, v239, v249
v_exp_f32 v238, v162
v_exp_f32 v239, v163
s_nop 0
v_cvt_pk_bf16_f32 v197, v238, v239
v_add_f32 v249, v238, v249
v_add_f32 v249, v239, v249
v_exp_f32 v238, v172
v_exp_f32 v239, v173
s_nop 0
v_cvt_pk_bf16_f32 v198, v238, v239
v_add_f32 v249, v238, v249
v_add_f32 v249, v239, v249
v_exp_f32 v238, v174
v_exp_f32 v239, v175
s_nop 0
v_cvt_pk_bf16_f32 v199, v238, v239
v_add_f32 v249, v238, v249
v_add_f32 v249, v239, v249
s_mov_b32 s56, 11
s_branch L_slow_tail
L_slow_30:
s_nop 15
v_max3_f32 v236, v128, v129, v130
v_max3_f32 v236, v236, v131, v140
v_max3_f32 v236, v236, v141, v142
v_max_f32 v236, v236, v143
v_mov_b32 v237, v236
s_nop 1
v_permlane32_swap_b32 v236, v237
v_max_f32 v236, v236, v237
v_mov_b32 v237, v236
s_nop 1
v_permlane16_swap_b32 v236, v237
v_max_f32 v236, v236, v237
v_ceil_f32 v236, v236
v_max_f32 v236, 0, v236
v_exp_f32 v253, -v236
v_sub_f32 v224, v224, v236
v_sub_f32 v225, v225, v236
v_sub_f32 v226, v226, v236
v_sub_f32 v227, v227, v236
v_sub_f32 v128, v128, v236
v_sub_f32 v129, v129, v236
v_sub_f32 v130, v130, v236
v_sub_f32 v131, v131, v236
v_sub_f32 v140, v140, v236
v_sub_f32 v141, v141, v236
v_sub_f32 v142, v142, v236
v_sub_f32 v143, v143, v236
v_sub_f32 v152, v152, v236
v_sub_f32 v153, v153, v236
v_sub_f32 v154, v154, v236
v_sub_f32 v155, v155, v236
v_sub_f32 v164, v164, v236
v_sub_f32 v165, v165, v236
v_sub_f32 v166, v166, v236
v_sub_f32 v167, v167, v236
v_lshlrev_b32 v238, 16, v188
v_and_b32 v239, 0xffff0000, v188
v_mul_f32 v238, v238, v253
v_mul_f32 v239, v239, v253
v_cvt_pk_bf16_f32 v188, v238, v239
v_lshlrev_b32 v238, 16, v189
v_and_b32 v239, 0xffff0000, v189
v_mul_f32 v238, v238, v253
v_mul_f32 v239, v239, v253
v_cvt_pk_bf16_f32 v189, v238, v239
v_lshlrev_b32 v238, 16, v190
v_and_b32 v239, 0xffff0000, v190
v_mul_f32 v238, v238, v253
v_mul_f32 v239, v239, v253
v_cvt_pk_bf16_f32 v190, v238, v239
v_lshlrev_b32 v238, 16, v191
v_and_b32 v239, 0xffff0000, v191
v_mul_f32 v238, v238, v253
v_mul_f32 v239, v239, v253
v_cvt_pk_bf16_f32 v191, v238, v239
v_mov_b32 v244, 0
v_exp_f32 v238, v128
v_exp_f32 v239, v129
s_nop 0
v_cvt_pk_bf16_f32 v200, v238, v239
v_add_f32 v244, v238, v244
v_add_f32 v244, v239, v244
v_exp_f32 v238, v130
v_exp_f32 v239, v131
s_nop 0
v_cvt_pk_bf16_f32 v201, v238, v239
v_add_f32 v244, v238, v244
v_add_f32 v244, v239, v244
v_exp_f32 v238, v140
v_exp_f32 v239, v141
s_nop 0
v_cvt_pk_bf16_f32 v202, v238, v239
v_add_f32 v244, v238, v244
v_add_f32 v244, v239, v244
v_exp_f32 v238, v142
v_exp_f32 v239, v143
s_nop 0
v_cvt_pk_bf16_f32 v203, v238, v239
v_add_f32 v244, v238, v244
v_add_f32 v244, v239, v244
v_max3_f32 v236, v132, v133, v134
v_max3_f32 v236, v236, v135, v144
v_max3_f32 v236, v236, v145, v146
v_max_f32 v236, v236, v147
v_mov_b32 v237, v236
s_nop 1
v_permlane32_swap_b32 v236, v237
v_max_f32 v236, v236, v237
v_mov_b32 v237, v236
s_nop 1
v_permlane16_swap_b32 v236, v237
v_max_f32 v236, v236, v237
v_ceil_f32 v236, v236
v_max_f32 v236, 0, v236
v_exp_f32 v254, -v236
v_sub_f32 v228, v228, v236
v_sub_f32 v229, v229, v236
v_sub_f32 v230, v230, v236
v_sub_f32 v231, v231, v236
v_sub_f32 v132, v132, v236
v_sub_f32 v133, v133, v236
v_sub_f32 v134, v134, v236
v_sub_f32 v135, v135, v236
v_sub_f32 v144, v144, v236
v_sub_f32 v145, v145, v236
v_sub_f32 v146, v146, v236
v_sub_f32 v147, v147, v236
v_sub_f32 v156, v156, v236
v_sub_f32 v157, v157, v236
v_sub_f32 v158, v158, v236
v_sub_f32 v159, v159, v236
v_sub_f32 v168, v168, v236
v_sub_f32 v169, v169, v236
v_sub_f32 v170, v170, v236
v_sub_f32 v171, v171, v236
v_lshlrev_b32 v238, 16, v192
v_and_b32 v239, 0xffff0000, v192
v_mul_f32 v238, v238, v254
v_mul_f32 v239, v239, v254
v_cvt_pk_bf16_f32 v192, v238, v239
v_lshlrev_b32 v238, 16, v193
v_and_b32 v239, 0xffff0000, v193
v_mul_f32 v238, v238, v254
v_mul_f32 v239, v239, v254
v_cvt_pk_bf16_f32 v193, v238, v239
v_lshlrev_b32 v238, 16, v194
v_and_b32 v239, 0xffff0000, v194
v_mul_f32 v238, v238, v254
v_mul_f32 v239, v239, v254
v_cvt_pk_bf16_f32 v194, v238, v239
v_lshlrev_b32 v238, 16, v195
v_and_b32 v239, 0xffff0000, v195
v_mul_f32 v238, v238, v254
v_mul_f32 v239, v239, v254
v_cvt_pk_bf16_f32 v195, v238, v239
v_mov_b32 v245, 0
v_exp_f32 v238, v132
v_exp_f32 v239, v133
s_nop 0
v_cvt_pk_bf16_f32 v204, v238, v239
v_add_f32 v245, v238, v245
v_add_f32 v245, v239, v245
v_exp_f32 v238, v134
v_exp_f32 v239, v135
s_nop 0
v_cvt_pk_bf16_f32 v205, v238, v239
v_add_f32 v245, v238, v245
v_add_f32 v245, v239, v245
v_exp_f32 v238, v144
v_exp_f32 v239, v145
s_nop 0
v_cvt_pk_bf16_f32 v206, v238, v239
v_add_f32 v245, v238, v245
v_add_f32 v245, v239, v245
v_exp_f32 v238, v146
v_exp_f32 v239, v147
s_nop 0
v_cvt_pk_bf16_f32 v207, v238, v239
v_add_f32 v245, v238, v245
v_add_f32 v245, v239, v245
v_mov_b32 v255, 1.0
s_mov_b32 s56, 12
s_branch L_slow_tail
L_slow_31:
s_nop 15
v_max3_f32 v236, v152, v153, v154
v_max3_f32 v236, v236, v155, v164
v_max3_f32 v236, v236, v165, v166
v_max_f32 v236, v236, v167
v_mov_b32 v237, v236
s_nop 1
v_permlane32_swap_b32 v236, v237
v_max_f32 v236, v236, v237
v_mov_b32 v237, v236
s_nop 1
v_permlane16_swap_b32 v236, v237
v_max_f32 v236, v236, v237
v_ceil_f32 v236, v236
v_max_f32 v236, 0, v236
v_exp_f32 v253, -v236
v_sub_f32 v224, v224, v236
v_sub_f32 v225, v225, v236
v_sub_f32 v226, v226, v236
v_sub_f32 v227, v227, v236
v_sub_f32 v152, v152, v236
v_sub_f32 v153, v153, v236
v_sub_f32 v154, v154, v236
v_sub_f32 v155, v155, v236
v_sub_f32 v164, v164, v236
v_sub_f32 v165, v165, v236
v_sub_f32 v166, v166, v236
v_sub_f32 v167, v167, v236
v_lshlrev_b32 v238, 16, v200
v_and_b32 v239, 0xffff0000, v200
v_mul_f32 v238, v238, v253
v_mul_f32 v239, v239, v253
v_cvt_pk_bf16_f32 v200, v238, v239
v_lshlrev_b32 v238, 16, v201
v_and_b32 v239, 0xffff0000, v201
v_mul_f32 v238, v238, v253
v_mul_f32 v239, v239, v253
v_cvt_pk_bf16_f32 v201, v238, v239
v_lshlrev_b32 v238, 16, v202
v_and_b32 v239, 0xffff0000, v202
v_mul_f32 v238, v238, v253
v_mul_f32 v239, v239, v253
v_cvt_pk_bf16_f32 v202, v238, v239
v_lshlrev_b32 v238, 16, v203
v_and_b32 v239, 0xffff0000, v203
v_mul_f32 v238, v238, v253
v_mul_f32 v239, v239, v253
v_cvt_pk_bf16_f32 v203, v238, v239
v_mov_b32 v247, 0
v_exp_f32 v238, v152
v_exp_f32 v239, v153
s_nop 0
v_cvt_pk_bf16_f32 v212, v238, v239
v_add_f32 v247, v238, v247
v_add_f32 v247, v239, v247
v_exp_f32 v238, v154
v_exp_f32 v239, v155
s_nop 0
v_cvt_pk_bf16_f32 v213, v238, v239
v_add_f32 v247, v238, v247
v_add_f32 v247, v239, v247
v_exp_f32 v238, v164
v_exp_f32 v239, v165
s_nop 0
v_cvt_pk_bf16_f32 v214, v238, v239
v_add_f32 v247, v238, v247
v_add_f32 v247, v239, v247
v_exp_f32 v238, v166
v_exp_f32 v239, v167
s_nop 0
v_cvt_pk_bf16_f32 v215, v238, v239
v_add_f32 v247, v238, v247
v_add_f32 v247, v239, v247
v_max3_f32 v236, v156, v157, v158
v_max3_f32 v236, v236, v159, v168
v_max3_f32 v236, v236, v169, v170
v_max_f32 v236, v236, v171
v_mov_b32 v237, v236
s_nop 1
v_permlane32_swap_b32 v236, v237
v_max_f32 v236, v236, v237
v_mov_b32 v237, v236
s_nop 1
v_permlane16_swap_b32 v236, v237
v_max_f32 v236, v236, v237
v_ceil_f32 v236, v236
v_max_f32 v236, 0, v236
v_exp_f32 v254, -v236
v_sub_f32 v228, v228, v236
v_sub_f32 v229, v229, v236
v_sub_f32 v230, v230, v236
v_sub_f32 v231, v231, v236
v_sub_f32 v156, v156, v236
v_sub_f32 v157, v157, v236
v_sub_f32 v158, v158, v236
v_sub_f32 v159, v159, v236
v_sub_f32 v168, v168, v236
v_sub_f32 v169, v169, v236
v_sub_f32 v170, v170, v236
v_sub_f32 v171, v171, v236
v_lshlrev_b32 v238, 16, v204
v_and_b32 v239, 0xffff0000, v204
v_mul_f32 v238, v238, v254
v_mul_f32 v239, v239, v254
v_cvt_pk_bf16_f32 v204, v238, v239
v_lshlrev_b32 v238, 16, v205
v_and_b32 v239, 0xffff0000, v205
v_mul_f32 v238, v238, v254
v_mul_f32 v239, v239, v254
v_cvt_pk_bf16_f32 v205, v238, v239
v_lshlrev_b32 v238, 16, v206
v_and_b32 v239, 0xffff0000, v206
v_mul_f32 v238, v238, v254
v_mul_f32 v239, v239, v254
v_cvt_pk_bf16_f32 v206, v238, v239
v_lshlrev_b32 v238, 16, v207
v_and_b32 v239, 0xffff0000, v207
v_mul_f32 v238, v238, v254
v_mul_f32 v239, v239, v254
v_cvt_pk_bf16_f32 v207, v238, v239
v_mov_b32 v248, 0
v_exp_f32 v238, v156
v_exp_f32 v239, v157
s_nop 0
v_cvt_pk_bf16_f32 v216, v238, v239
v_add_f32 v248, v238, v248
v_add_f32 v248, v239, v248
v_exp_f32 v238, v158
v_exp_f32 v239, v159
s_nop 0
v_cvt_pk_bf16_f32 v217, v238, v239
v_add_f32 v248, v238, v248
v_add_f32 v248, v239, v248
v_exp_f32 v238, v168
v_exp_f32 v239, v169
s_nop 0
v_cvt_pk_bf16_f32 v218, v238, v239
v_add_f32 v248, v238, v248
v_add_f32 v248, v239, v248
v_exp_f32 v238, v170
v_exp_f32 v239, v171
s_nop 0
v_cvt_pk_bf16_f32 v219, v238, v239
v_add_f32 v248, v238, v248
v_add_f32 v248, v239, v248
v_max3_f32 v236, v160, v161, v162
v_max3_f32 v236, v236, v163, v172
v_max3_f32 v236, v236, v173, v174
v_max_f32 v236, v236, v175
v_mov_b32 v237, v236
s_nop 1
v_permlane32_swap_b32 v236, v237
v_max_f32 v236, v236, v237
v_mov_b32 v237, v236
s_nop 1
v_permlane16_swap_b32 v236, v237
v_max_f32 v236, v236, v237
v_ceil_f32 v236, v236
v_max_f32 v236, 0, v236
v_exp_f32 v255, -v236
v_sub_f32 v232, v232, v236
v_sub_f32 v233, v233, v236
v_sub_f32 v234, v234, v236
v_sub_f32 v235, v235, v236
v_sub_f32 v160, v160, v236
v_sub_f32 v161, v161, v236
v_sub_f32 v162, v162, v236
v_sub_f32 v163, v163, v236
v_sub_f32 v172, v172, v236
v_sub_f32 v173, v173, v236
v_sub_f32 v174, v174, v236
v_sub_f32 v175, v175, v236
v_mov_b32 v249, 0
v_exp_f32 v238, v160
v_exp_f32 v239, v161
s_nop 0
v_cvt_pk_bf16_f32 v220, v238, v239
v_add_f32 v249, v238, v249
v_add_f32 v249, v239, v249
v_exp_f32 v238, v162
v_exp_f32 v239, v163
s_nop 0
v_cvt_pk_bf16_f32 v221, v238, v239
v_add_f32 v249, v238, v249
v_add_f32 v249, v239, v249
v_exp_f32 v238, v172
v_exp_f32 v239, v173
s_nop 0
v_cvt_pk_bf16_f32 v222, v238, v239
v_add_f32 v249, v238, v249
v_add_f32 v249, v239, v249
v_exp_f32 v238, v174
v_exp_f32 v239, v175
s_nop 0
v_cvt_pk_bf16_f32 v223, v238, v239
v_add_f32 v249, v238, v249
v_add_f32 v249, v239, v249
s_mov_b32 s56, 13
s_branch L_slow_tail
L_slow_tail:
v_mul_f32 v250, v250, v253
v_accvgpr_read_b32 v236, a0
v_accvgpr_read_b32 v237, a1
v_accvgpr_read_b32 v238, a2
v_accvgpr_read_b32 v239, a3
v_mul_f32 v236, v236, v253
v_mul_f32 v237, v237, v253
v_mul_f32 v238, v238, v253
v_mul_f32 v239, v239, v253
v_accvgpr_write_b32 a0, v236
v_accvgpr_write_b32 a1, v237
v_accvgpr_write_b32 a2, v238
v_accvgpr_write_b32 a3, v239
v_accvgpr_read_b32 v236, a4
v_accvgpr_read_b32 v237, a5
v_accvgpr_read_b32 v238, a6
v_accvgpr_read_b32 v239, a7
v_mul_f32 v236, v236, v253
v_mul_f32 v237, v237, v253
v_mul_f32 v238, v238, v253
v_mul_f32 v239, v239, v253
v_accvgpr_write_b32 a4, v236
v_accvgpr_write_b32 a5, v237
v_accvgpr_write_b32 a6, v238
v_accvgpr_write_b32 a7, v239
v_accvgpr_read_b32 v236, a8
v_accvgpr_read_b32 v237, a9
v_accvgpr_read_b32 v238, a10
v_accvgpr_read_b32 v239, a11
v_mul_f32 v236, v236, v253
v_mul_f32 v237, v237, v253
v_mul_f32 v238, v238, v253
v_mul_f32 v239, v239, v253
v_accvgpr_write_b32 a8, v236
v_accvgpr_write_b32 a9, v237
v_accvgpr_write_b32 a10, v238
v_accvgpr_write_b32 a11, v239
v_accvgpr_read_b32 v236, a12
v_accvgpr_read_b32 v237, a13
v_accvgpr_read_b32 v238, a14
v_accvgpr_read_b32 v239, a15
v_mul_f32 v236, v236, v253
v_mul_f32 v237, v237, v253
v_mul_f32 v238, v238, v253
v_mul_f32 v239, v239, v253
v_accvgpr_write_b32 a12, v236
v_accvgpr_write_b32 a13, v237
v_accvgpr_write_b32 a14, v238
v_accvgpr_write_b32 a15, v239
v_accvgpr_read_b32 v236, a16
v_accvgpr_read_b32 v237, a17
v_accvgpr_read_b32 v238, a18
v_accvgpr_read_b32 v239, a19
v_mul_f32 v236, v236, v253
v_mul_f32 v237, v237, v253
v_mul_f32 v238, v238, v253
v_mul_f32 v239, v239, v253
v_accvgpr_write_b32 a16, v236
v_accvgpr_write_b32 a17, v237
v_accvgpr_write_b32 a18, v238
v_accvgpr_write_b32 a19, v239
v_accvgpr_read_b32 v236, a20
v_accvgpr_read_b32 v237, a21
v_accvgpr_read_b32 v238, a22
v_accvgpr_read_b32 v239, a23
v_mul_f32 v236, v236, v253
v_mul_f32 v237, v237, v253
v_mul_f32 v238, v238, v253
v_mul_f32 v239, v239, v253
v_accvgpr_write_b32 a20, v236
v_accvgpr_write_b32 a21, v237
v_accvgpr_write_b32 a22, v238
v_accvgpr_write_b32 a23, v239
v_accvgpr_read_b32 v236, a24
v_accvgpr_read_b32 v237, a25
v_accvgpr_read_b32 v238, a26
v_accvgpr_read_b32 v239, a27
v_mul_f32 v236, v236, v253
v_mul_f32 v237, v237, v253
v_mul_f32 v238, v238, v253
v_mul_f32 v239, v239, v253
v_accvgpr_write_b32 a24, v236
v_accvgpr_write_b32 a25, v237
v_accvgpr_write_b32 a26, v238
v_accvgpr_write_b32 a27, v239
v_accvgpr_read_b32 v236, a28
v_accvgpr_read_b32 v237, a29
v_accvgpr_read_b32 v238, a30
v_accvgpr_read_b32 v239, a31
v_mul_f32 v236, v236, v253
v_mul_f32 v237, v237, v253
v_mul_f32 v238, v238, v253
v_mul_f32 v239, v239, v253
v_accvgpr_write_b32 a28, v236
v_accvgpr_write_b32 a29, v237
v_accvgpr_write_b32 a30, v238
v_accvgpr_write_b32 a31, v239
v_accvgpr_read_b32 v236, a32
v_accvgpr_read_b32 v237, a33
v_accvgpr_read_b32 v238, a34
v_accvgpr_read_b32 v239, a35
v_mul_f32 v236, v236, v253
v_mul_f32 v237, v237, v253
v_mul_f32 v238, v238, v253
v_mul_f32 v239, v239, v253
v_accvgpr_write_b32 a32, v236
v_accvgpr_write_b32 a33, v237
v_accvgpr_write_b32 a34, v238
v_accvgpr_write_b32 a35, v239
v_accvgpr_read_b32 v236, a36
v_accvgpr_read_b32 v237, a37
v_accvgpr_read_b32 v238, a38
v_accvgpr_read_b32 v239, a39
v_mul_f32 v236, v236, v253
v_mul_f32 v237, v237, v253
v_mul_f32 v238, v238, v253
v_mul_f32 v239, v239, v253
v_accvgpr_write_b32 a36, v236
v_accvgpr_write_b32 a37, v237
v_accvgpr_write_b32 a38, v238
v_accvgpr_write_b32 a39, v239
v_accvgpr_read_b32 v236, a40
v_accvgpr_read_b32 v237, a41
v_accvgpr_read_b32 v238, a42
v_accvgpr_read_b32 v239, a43
v_mul_f32 v236, v236, v253
v_mul_f32 v237, v237, v253
v_mul_f32 v238, v238, v253
v_mul_f32 v239, v239, v253
v_accvgpr_write_b32 a40, v236
v_accvgpr_write_b32 a41, v237
v_accvgpr_write_b32 a42, v238
v_accvgpr_write_b32 a43, v239
v_accvgpr_read_b32 v236, a44
v_accvgpr_read_b32 v237, a45
v_accvgpr_read_b32 v238, a46
v_accvgpr_read_b32 v239, a47
v_mul_f32 v236, v236, v253
v_mul_f32 v237, v237, v253
v_mul_f32 v238, v238, v253
v_mul_f32 v239, v239, v253
v_accvgpr_write_b32 a44, v236
v_accvgpr_write_b32 a45, v237
v_accvgpr_write_b32 a46, v238
v_accvgpr_write_b32 a47, v239
v_accvgpr_read_b32 v236, a48
v_accvgpr_read_b32 v237, a49
v_accvgpr_read_b32 v238, a50
v_accvgpr_read_b32 v239, a51
v_mul_f32 v236, v236, v253
v_mul_f32 v237, v237, v253
v_mul_f32 v238, v238, v253
v_mul_f32 v239, v239, v253
v_accvgpr_write_b32 a48, v236
v_accvgpr_write_b32 a49, v237
v_accvgpr_write_b32 a50, v238
v_accvgpr_write_b32 a51, v239
v_accvgpr_read_b32 v236, a52
v_accvgpr_read_b32 v237, a53
v_accvgpr_read_b32 v238, a54
v_accvgpr_read_b32 v239, a55
v_mul_f32 v236, v236, v253
v_mul_f32 v237, v237, v253
v_mul_f32 v238, v238, v253
v_mul_f32 v239, v239, v253
v_accvgpr_write_b32 a52, v236
v_accvgpr_write_b32 a53, v237
v_accvgpr_write_b32 a54, v238
v_accvgpr_write_b32 a55, v239
v_accvgpr_read_b32 v236, a56
v_accvgpr_read_b32 v237, a57
v_accvgpr_read_b32 v238, a58
v_accvgpr_read_b32 v239, a59
v_mul_f32 v236, v236, v253
v_mul_f32 v237, v237, v253
v_mul_f32 v238, v238, v253
v_mul_f32 v239, v239, v253
v_accvgpr_write_b32 a56, v236
v_accvgpr_write_b32 a57, v237
v_accvgpr_write_b32 a58, v238
v_accvgpr_write_b32 a59, v239
v_accvgpr_read_b32 v236, a60
v_accvgpr_read_b32 v237, a61
v_accvgpr_read_b32 v238, a62
v_accvgpr_read_b32 v239, a63
v_mul_f32 v236, v236, v253
v_mul_f32 v237, v237, v253
v_mul_f32 v238, v238, v253
v_mul_f32 v239, v239, v253
v_accvgpr_write_b32 a60, v236
v_accvgpr_write_b32 a61, v237
v_accvgpr_write_b32 a62, v238
v_accvgpr_write_b32 a63, v239
v_mul_f32 v251, v251, v254
v_accvgpr_read_b32 v236, a64
v_accvgpr_read_b32 v237, a65
v_accvgpr_read_b32 v238, a66
v_accvgpr_read_b32 v239, a67
v_mul_f32 v236, v236, v254
v_mul_f32 v237, v237, v254
v_mul_f32 v238, v238, v254
v_mul_f32 v239, v239, v254
v_accvgpr_write_b32 a64, v236
v_accvgpr_write_b32 a65, v237
v_accvgpr_write_b32 a66, v238
v_accvgpr_write_b32 a67, v239
v_accvgpr_read_b32 v236, a68
v_accvgpr_read_b32 v237, a69
v_accvgpr_read_b32 v238, a70
v_accvgpr_read_b32 v239, a71
v_mul_f32 v236, v236, v254
v_mul_f32 v237, v237, v254
v_mul_f32 v238, v238, v254
v_mul_f32 v239, v239, v254
v_accvgpr_write_b32 a68, v236
v_accvgpr_write_b32 a69, v237
v_accvgpr_write_b32 a70, v238
v_accvgpr_write_b32 a71, v239
v_accvgpr_read_b32 v236, a72
v_accvgpr_read_b32 v237, a73
v_accvgpr_read_b32 v238, a74
v_accvgpr_read_b32 v239, a75
v_mul_f32 v236, v236, v254
v_mul_f32 v237, v237, v254
v_mul_f32 v238, v238, v254
v_mul_f32 v239, v239, v254
v_accvgpr_write_b32 a72, v236
v_accvgpr_write_b32 a73, v237
v_accvgpr_write_b32 a74, v238
v_accvgpr_write_b32 a75, v239
v_accvgpr_read_b32 v236, a76
v_accvgpr_read_b32 v237, a77
v_accvgpr_read_b32 v238, a78
v_accvgpr_read_b32 v239, a79
v_mul_f32 v236, v236, v254
v_mul_f32 v237, v237, v254
v_mul_f32 v238, v238, v254
v_mul_f32 v239, v239, v254
v_accvgpr_write_b32 a76, v236
v_accvgpr_write_b32 a77, v237
v_accvgpr_write_b32 a78, v238
v_accvgpr_write_b32 a79, v239
v_accvgpr_read_b32 v236, a80
v_accvgpr_read_b32 v237, a81
v_accvgpr_read_b32 v238, a82
v_accvgpr_read_b32 v239, a83
v_mul_f32 v236, v236, v254
v_mul_f32 v237, v237, v254
v_mul_f32 v238, v238, v254
v_mul_f32 v239, v239, v254
v_accvgpr_write_b32 a80, v236
v_accvgpr_write_b32 a81, v237
v_accvgpr_write_b32 a82, v238
v_accvgpr_write_b32 a83, v239
v_accvgpr_read_b32 v236, a84
v_accvgpr_read_b32 v237, a85
v_accvgpr_read_b32 v238, a86
v_accvgpr_read_b32 v239, a87
v_mul_f32 v236, v236, v254
v_mul_f32 v237, v237, v254
v_mul_f32 v238, v238, v254
v_mul_f32 v239, v239, v254
v_accvgpr_write_b32 a84, v236
v_accvgpr_write_b32 a85, v237
v_accvgpr_write_b32 a86, v238
v_accvgpr_write_b32 a87, v239
v_accvgpr_read_b32 v236, a88
v_accvgpr_read_b32 v237, a89
v_accvgpr_read_b32 v238, a90
v_accvgpr_read_b32 v239, a91
v_mul_f32 v236, v236, v254
v_mul_f32 v237, v237, v254
v_mul_f32 v238, v238, v254
v_mul_f32 v239, v239, v254
v_accvgpr_write_b32 a88, v236
v_accvgpr_write_b32 a89, v237
v_accvgpr_write_b32 a90, v238
v_accvgpr_write_b32 a91, v239
v_accvgpr_read_b32 v236, a92
v_accvgpr_read_b32 v237, a93
v_accvgpr_read_b32 v238, a94
v_accvgpr_read_b32 v239, a95
v_mul_f32 v236, v236, v254
v_mul_f32 v237, v237, v254
v_mul_f32 v238, v238, v254
v_mul_f32 v239, v239, v254
v_accvgpr_write_b32 a92, v236
v_accvgpr_write_b32 a93, v237
v_accvgpr_write_b32 a94, v238
v_accvgpr_write_b32 a95, v239
v_accvgpr_read_b32 v236, a96
v_accvgpr_read_b32 v237, a97
v_accvgpr_read_b32 v238, a98
v_accvgpr_read_b32 v239, a99
v_mul_f32 v236, v236, v254
v_mul_f32 v237, v237, v254
v_mul_f32 v238, v238, v254
v_mul_f32 v239, v239, v254
v_accvgpr_write_b32 a96, v236
v_accvgpr_write_b32 a97, v237
v_accvgpr_write_b32 a98, v238
v_accvgpr_write_b32 a99, v239
v_accvgpr_read_b32 v236, a100
v_accvgpr_read_b32 v237, a101
v_accvgpr_read_b32 v238, a102
v_accvgpr_read_b32 v239, a103
v_mul_f32 v236, v236, v254
v_mul_f32 v237, v237, v254
v_mul_f32 v238, v238, v254
v_mul_f32 v239, v239, v254
v_accvgpr_write_b32 a100, v236
v_accvgpr_write_b32 a101, v237
v_accvgpr_write_b32 a102, v238
v_accvgpr_write_b32 a103, v239
v_accvgpr_read_b32 v236, a104
v_accvgpr_read_b32 v237, a105
v_accvgpr_read_b32 v238, a106
v_accvgpr_read_b32 v239, a107
v_mul_f32 v236, v236, v254
v_mul_f32 v237, v237, v254
v_mul_f32 v238, v238, v254
v_mul_f32 v239, v239, v254
v_accvgpr_write_b32 a104, v236
v_accvgpr_write_b32 a105, v237
v_accvgpr_write_b32 a106, v238
v_accvgpr_write_b32 a107, v239
v_accvgpr_read_b32 v236, a108
v_accvgpr_read_b32 v237, a109
v_accvgpr_read_b32 v238, a110
v_accvgpr_read_b32 v239, a111
v_mul_f32 v236, v236, v254
v_mul_f32 v237, v237, v254
v_mul_f32 v238, v238, v254
v_mul_f32 v239, v239, v254
v_accvgpr_write_b32 a108, v236
v_accvgpr_write_b32 a109, v237
v_accvgpr_write_b32 a110, v238
v_accvgpr_write_b32 a111, v239
v_accvgpr_read_b32 v236, a112
v_accvgpr_read_b32 v237, a113
v_accvgpr_read_b32 v238, a114
v_accvgpr_read_b32 v239, a115
v_mul_f32 v236, v236, v254
v_mul_f32 v237, v237, v254
v_mul_f32 v238, v238, v254
v_mul_f32 v239, v239, v254
v_accvgpr_write_b32 a112, v236
v_accvgpr_write_b32 a113, v237
v_accvgpr_write_b32 a114, v238
v_accvgpr_write_b32 a115, v239
v_accvgpr_read_b32 v236, a116
v_accvgpr_read_b32 v237, a117
v_accvgpr_read_b32 v238, a118
v_accvgpr_read_b32 v239, a119
v_mul_f32 v236, v236, v254
v_mul_f32 v237, v237, v254
v_mul_f32 v238, v238, v254
v_mul_f32 v239, v239, v254
v_accvgpr_write_b32 a116, v236
v_accvgpr_write_b32 a117, v237
v_accvgpr_write_b32 a118, v238
v_accvgpr_write_b32 a119, v239
v_accvgpr_read_b32 v236, a120
v_accvgpr_read_b32 v237, a121
v_accvgpr_read_b32 v238, a122
v_accvgpr_read_b32 v239, a123
v_mul_f32 v236, v236, v254
v_mul_f32 v237, v237, v254
v_mul_f32 v238, v238, v254
v_mul_f32 v239, v239, v254
v_accvgpr_write_b32 a120, v236
v_accvgpr_write_b32 a121, v237
v_accvgpr_write_b32 a122, v238
v_accvgpr_write_b32 a123, v239
v_accvgpr_read_b32 v236, a124
v_accvgpr_read_b32 v237, a125
v_accvgpr_read_b32 v238, a126
v_accvgpr_read_b32 v239, a127
v_mul_f32 v236, v236, v254
v_mul_f32 v237, v237, v254
v_mul_f32 v238, v238, v254
v_mul_f32 v239, v239, v254
v_accvgpr_write_b32 a124, v236
v_accvgpr_write_b32 a125, v237
v_accvgpr_write_b32 a126, v238
v_accvgpr_write_b32 a127, v239
v_mul_f32 v252, v252, v255
v_accvgpr_read_b32 v236, a128
v_accvgpr_read_b32 v237, a129
v_accvgpr_read_b32 v238, a130
v_accvgpr_read_b32 v239, a131
v_mul_f32 v236, v236, v255
v_mul_f32 v237, v237, v255
v_mul_f32 v238, v238, v255
v_mul_f32 v239, v239, v255
v_accvgpr_write_b32 a128, v236
v_accvgpr_write_b32 a129, v237
v_accvgpr_write_b32 a130, v238
v_accvgpr_write_b32 a131, v239
v_accvgpr_read_b32 v236, a132
v_accvgpr_read_b32 v237, a133
v_accvgpr_read_b32 v238, a134
v_accvgpr_read_b32 v239, a135
v_mul_f32 v236, v236, v255
v_mul_f32 v237, v237, v255
v_mul_f32 v238, v238, v255
v_mul_f32 v239, v239, v255
v_accvgpr_write_b32 a132, v236
v_accvgpr_write_b32 a133, v237
v_accvgpr_write_b32 a134, v238
v_accvgpr_write_b32 a135, v239
v_accvgpr_read_b32 v236, a136
v_accvgpr_read_b32 v237, a137
v_accvgpr_read_b32 v238, a138
v_accvgpr_read_b32 v239, a139
v_mul_f32 v236, v236, v255
v_mul_f32 v237, v237, v255
v_mul_f32 v238, v238, v255
v_mul_f32 v239, v239, v255
v_accvgpr_write_b32 a136, v236
v_accvgpr_write_b32 a137, v237
v_accvgpr_write_b32 a138, v238
v_accvgpr_write_b32 a139, v239
v_accvgpr_read_b32 v236, a140
v_accvgpr_read_b32 v237, a141
v_accvgpr_read_b32 v238, a142
v_accvgpr_read_b32 v239, a143
v_mul_f32 v236, v236, v255
v_mul_f32 v237, v237, v255
v_mul_f32 v238, v238, v255
v_mul_f32 v239, v239, v255
v_accvgpr_write_b32 a140, v236
v_accvgpr_write_b32 a141, v237
v_accvgpr_write_b32 a142, v238
v_accvgpr_write_b32 a143, v239
v_accvgpr_read_b32 v236, a144
v_accvgpr_read_b32 v237, a145
v_accvgpr_read_b32 v238, a146
v_accvgpr_read_b32 v239, a147
v_mul_f32 v236, v236, v255
v_mul_f32 v237, v237, v255
v_mul_f32 v238, v238, v255
v_mul_f32 v239, v239, v255
v_accvgpr_write_b32 a144, v236
v_accvgpr_write_b32 a145, v237
v_accvgpr_write_b32 a146, v238
v_accvgpr_write_b32 a147, v239
v_accvgpr_read_b32 v236, a148
v_accvgpr_read_b32 v237, a149
v_accvgpr_read_b32 v238, a150
v_accvgpr_read_b32 v239, a151
v_mul_f32 v236, v236, v255
v_mul_f32 v237, v237, v255
v_mul_f32 v238, v238, v255
v_mul_f32 v239, v239, v255
v_accvgpr_write_b32 a148, v236
v_accvgpr_write_b32 a149, v237
v_accvgpr_write_b32 a150, v238
v_accvgpr_write_b32 a151, v239
v_accvgpr_read_b32 v236, a152
v_accvgpr_read_b32 v237, a153
v_accvgpr_read_b32 v238, a154
v_accvgpr_read_b32 v239, a155
v_mul_f32 v236, v236, v255
v_mul_f32 v237, v237, v255
v_mul_f32 v238, v238, v255
v_mul_f32 v239, v239, v255
v_accvgpr_write_b32 a152, v236
v_accvgpr_write_b32 a153, v237
v_accvgpr_write_b32 a154, v238
v_accvgpr_write_b32 a155, v239
v_accvgpr_read_b32 v236, a156
v_accvgpr_read_b32 v237, a157
v_accvgpr_read_b32 v238, a158
v_accvgpr_read_b32 v239, a159
v_mul_f32 v236, v236, v255
v_mul_f32 v237, v237, v255
v_mul_f32 v238, v238, v255
v_mul_f32 v239, v239, v255
v_accvgpr_write_b32 a156, v236
v_accvgpr_write_b32 a157, v237
v_accvgpr_write_b32 a158, v238
v_accvgpr_write_b32 a159, v239
v_accvgpr_read_b32 v236, a160
v_accvgpr_read_b32 v237, a161
v_accvgpr_read_b32 v238, a162
v_accvgpr_read_b32 v239, a163
v_mul_f32 v236, v236, v255
v_mul_f32 v237, v237, v255
v_mul_f32 v238, v238, v255
v_mul_f32 v239, v239, v255
v_accvgpr_write_b32 a160, v236
v_accvgpr_write_b32 a161, v237
v_accvgpr_write_b32 a162, v238
v_accvgpr_write_b32 a163, v239
v_accvgpr_read_b32 v236, a164
v_accvgpr_read_b32 v237, a165
v_accvgpr_read_b32 v238, a166
v_accvgpr_read_b32 v239, a167
v_mul_f32 v236, v236, v255
v_mul_f32 v237, v237, v255
v_mul_f32 v238, v238, v255
v_mul_f32 v239, v239, v255
v_accvgpr_write_b32 a164, v236
v_accvgpr_write_b32 a165, v237
v_accvgpr_write_b32 a166, v238
v_accvgpr_write_b32 a167, v239
v_accvgpr_read_b32 v236, a168
v_accvgpr_read_b32 v237, a169
v_accvgpr_read_b32 v238, a170
v_accvgpr_read_b32 v239, a171
v_mul_f32 v236, v236, v255
v_mul_f32 v237, v237, v255
v_mul_f32 v238, v238, v255
v_mul_f32 v239, v239, v255
v_accvgpr_write_b32 a168, v236
v_accvgpr_write_b32 a169, v237
v_accvgpr_write_b32 a170, v238
v_accvgpr_write_b32 a171, v239
v_accvgpr_read_b32 v236, a172
v_accvgpr_read_b32 v237, a173
v_accvgpr_read_b32 v238, a174
v_accvgpr_read_b32 v239, a175
v_mul_f32 v236, v236, v255
v_mul_f32 v237, v237, v255
v_mul_f32 v238, v238, v255
v_mul_f32 v239, v239, v255
v_accvgpr_write_b32 a172, v236
v_accvgpr_write_b32 a173, v237
v_accvgpr_write_b32 a174, v238
v_accvgpr_write_b32 a175, v239
v_accvgpr_read_b32 v236, a176
v_accvgpr_read_b32 v237, a177
v_accvgpr_read_b32 v238, a178
v_accvgpr_read_b32 v239, a179
v_mul_f32 v236, v236, v255
v_mul_f32 v237, v237, v255
v_mul_f32 v238, v238, v255
v_mul_f32 v239, v239, v255
v_accvgpr_write_b32 a176, v236
v_accvgpr_write_b32 a177, v237
v_accvgpr_write_b32 a178, v238
v_accvgpr_write_b32 a179, v239
v_accvgpr_read_b32 v236, a180
v_accvgpr_read_b32 v237, a181
v_accvgpr_read_b32 v238, a182
v_accvgpr_read_b32 v239, a183
v_mul_f32 v236, v236, v255
v_mul_f32 v237, v237, v255
v_mul_f32 v238, v238, v255
v_mul_f32 v239, v239, v255
v_accvgpr_write_b32 a180, v236
v_accvgpr_write_b32 a181, v237
v_accvgpr_write_b32 a182, v238
v_accvgpr_write_b32 a183, v239
v_accvgpr_read_b32 v236, a184
v_accvgpr_read_b32 v237, a185
v_accvgpr_read_b32 v238, a186
v_accvgpr_read_b32 v239, a187
v_mul_f32 v236, v236, v255
v_mul_f32 v237, v237, v255
v_mul_f32 v238, v238, v255
v_mul_f32 v239, v239, v255
v_accvgpr_write_b32 a184, v236
v_accvgpr_write_b32 a185, v237
v_accvgpr_write_b32 a186, v238
v_accvgpr_write_b32 a187, v239
v_accvgpr_read_b32 v236, a188
v_accvgpr_read_b32 v237, a189
v_accvgpr_read_b32 v238, a190
v_accvgpr_read_b32 v239, a191
v_mul_f32 v236, v236, v255
v_mul_f32 v237, v237, v255
v_mul_f32 v238, v238, v255
v_mul_f32 v239, v239, v255
v_accvgpr_write_b32 a188, v236
v_accvgpr_write_b32 a189, v237
v_accvgpr_write_b32 a190, v238
v_accvgpr_write_b32 a191, v239
s_nop 3
s_cmp_eq_u32 s56, 0
s_cbranch_scc1 L_ret_0
s_cmp_eq_u32 s56, 1
s_cbranch_scc1 L_ret_1
s_cmp_eq_u32 s56, 2
s_cbranch_scc1 L_ret_2
s_cmp_eq_u32 s56, 3
s_cbranch_scc1 L_ret_3
s_cmp_eq_u32 s56, 4
s_cbranch_scc1 L_ret_4
s_cmp_eq_u32 s56, 5
s_cbranch_scc1 L_ret_5
s_cmp_eq_u32 s56, 6
s_cbranch_scc1 L_ret_6
s_cmp_eq_u32 s56, 7
s_cbranch_scc1 L_ret_7
s_cmp_eq_u32 s56, 8
s_cbranch_scc1 L_ret_8
s_cmp_eq_u32 s56, 9
s_cbranch_scc1 L_ret_27
s_cmp_eq_u32 s56, 10
s_cbranch_scc1 L_ret_28
s_cmp_eq_u32 s56, 11
s_cbranch_scc1 L_ret_29
s_cmp_eq_u32 s56, 12
s_cbranch_scc1 L_ret_30
s_cmp_eq_u32 s56, 13
s_cbranch_scc1 L_ret_31
s_branch L_ret_31
.section .rodata,"a"
.p2align 6
.amdhsa_kernel standalone__gqa_block_cached__near_ridge_kernel
  .amdhsa_next_free_vgpr 512
  .amdhsa_next_free_sgpr 102
  .amdhsa_accum_offset 256
  .amdhsa_group_segment_fixed_size 0
  .amdhsa_kernarg_size 64
  .amdhsa_user_sgpr_count 2
  .amdhsa_user_sgpr_kernarg_segment_ptr 1
  .amdhsa_system_sgpr_workgroup_id_x 1
.end_amdhsa_kernel
```
